```python
import torch

def _softmax(x, axis=-1):
    return torch.softmax(x, dim=axis)
def _gelu(x):
    return torch.nn.functional.gelu(x, approximate="tanh")
def _silu(x):
    return torch.nn.functional.silu(x)
def _sigmoid(x):
    return torch.sigmoid(x)
def _layernorm(x, axis=-1, eps=1e-5):
    m = x.mean(dim=axis, keepdim=True)
    v = x.var(dim=axis, keepdim=True, unbiased=False)
    return (x - m) / torch.sqrt(v + eps)
def _scatter_add(tgt, idx, src, axis=0):
    return tgt.clone().index_add_(axis, idx, src)
def _segment_sum(src, seg, n):
    out = torch.zeros((n,) + src.shape[1:], dtype=src.dtype)
    return out.index_add_(0, seg, src)
def _pad(x, pw):
    flat = tuple(v for pair in reversed(pw) for v in pair)
    return torch.nn.functional.pad(x, flat)

kernel_name = 'parallel_sum__linear_kernel_hedgehog__swiglu_ffn__prompt'

def setup_inputs():

    _w = (lambda a: (lambda t: t.to(torch.bfloat16) if t.is_floating_point() else t)(torch.as_tensor(a)))
    def _A_setup():
        B, S, D, H = 1, 2048, 640, 32
        Dh = D // H
        return {
            "x": _w((lambda *s: torch.randn(*s, dtype=torch.bfloat16) * 0.05)(B, S, D)),
            "wqkv": _w((lambda *s: torch.randn(*s, dtype=torch.bfloat16) * 0.4)(D, 3 * D)),
            "w_phi": _w((lambda *s: torch.randn(*s, dtype=torch.bfloat16) * 0.4)(H, Dh, Dh) * (Dh ** -0.5)),
            "wo": _w((lambda *s: torch.randn(*s, dtype=torch.bfloat16) * 0.1)(D, D)),
        }
    _A_in = _A_setup()

    def _B_setup():
        B, S, D, F = 1, 2048, 640, 1536
        return {
            "x": _w((lambda *s: torch.randn(*s, dtype=torch.bfloat16) * 0.05)(B, S, D)),
            "w_gate": _w((lambda *s: torch.randn(*s, dtype=torch.bfloat16) * 0.05)(D, F)),
            "w_up": _w((lambda *s: torch.randn(*s, dtype=torch.bfloat16) * 0.05)(D, F)),
            "w_down": _w((lambda *s: torch.randn(*s, dtype=torch.bfloat16) * 0.05)(F, D)),
        }
    _B_in = _B_setup()

    return {
        "A_x": _A_in["x"],
        "A_wqkv": _A_in["wqkv"],
        "A_w_phi": _A_in["w_phi"],
        "A_wo": _A_in["wo"],
        "B_x": _B_in["x"],
        "B_w_gate": _B_in["w_gate"],
        "B_w_up": _B_in["w_up"],
        "B_w_down": _B_in["w_down"],
    }

def reference(A_x, A_wqkv, A_w_phi, A_wo, B_x, B_w_gate, B_w_up, B_w_down):
    def _A_ref(x, wqkv, w_phi, wo):
        B, S, D = x.shape
        H = 32; Dh = D // H
        qkv = (lambda x, *d: x.permute(*d))((x @ wqkv).reshape(B, S, 3, H, Dh), 2, 0, 3, 1, 4)
        q, k, v = qkv[0], qkv[1], qkv[2]
        pq = torch.einsum("bhsd,hdf->bhsf", q, w_phi)
        pk = torch.einsum("bhsd,hdf->bhsf", k, w_phi)
        phi_q = torch.concatenate([_softmax(pq, axis=-1), _softmax(-pq, axis=-1)], axis=-1)
        phi_k = torch.concatenate([_softmax(pk, axis=-1), _softmax(-pk, axis=-1)], axis=-1)
        kv = torch.einsum("bhsf,bhsd->bhfd", phi_k, v)
        z  = torch.einsum("bhsf->bhf", phi_k)
        num = torch.einsum("bhqf,bhfd->bhqd", phi_q, kv)
        den = torch.einsum("bhqf,bhf->bhq", phi_q, z)[..., None] + 1e-6
        o = num / den
        return (lambda x, *d: x.permute(*d))(o, 0, 2, 1, 3).reshape(B, S, D) @ wo

    def _B_ref(x, w_gate, w_up, w_down):
        g = _silu(x @ w_gate)
        u = x @ w_up
        return (g * u) @ w_down

    x = A_x
    xn = _layernorm(x, axis=-1)
    return x + _A_ref(xn, A_wqkv, A_w_phi, A_wo) + _B_ref(xn, B_w_gate, B_w_up, B_w_down)
```

```asm
; @launch kernel=k1_kernel grid=(256,1,1) block=(256,1,1) lds=163840
; @launch kernel=k2_kernel grid=(256,1,1) block=(512,1,1) lds=112704
.amdgcn_target "amdgcn-amd-amdhsa--gfx950"
.text
.globl k1_kernel
.p2align 8
.type k1_kernel,@function
k1_kernel:
s_cmp_ge_u32 s2, 256
s_cbranch_scc1 K1_end
s_load_dwordx16 s[64:79], s[0:1], 0
s_load_dwordx4 s[92:95], s[0:1], 72
v_lshrrev_b32 v1, 6, v0
v_and_b32 v255, 63, v0
v_readfirstlane_b32 s24, v1
s_and_b32 s30, s2, 7
s_lshr_b32 s31, s2, 3
s_lshr_b32 s32, s30, 2
s_and_b32 s33, s30, 3
s_waitcnt lgkmcnt(0)
s_mov_b32 s8, s64
s_and_b32 s9, s65, 0xffff
s_mov_b32 s10, 2621440
s_mov_b32 s11, 0x20000
s_mov_b32 s20, s94
s_and_b32 s21, s95, 0xffff
s_mov_b32 s22, 268435456
s_mov_b32 s23, 0x20000
s_mov_b32 s56, s92
s_and_b32 s57, s93, 0xffff
s_mov_b32 s58, 256
s_mov_b32 s59, 0x20000
s_cmp_ge_u32 s31, 28
s_cbranch_scc1 K1_q
s_cmp_ge_u32 s31, 20
s_cbranch_scc1 K1_kv
s_mul_i32 s35, s32, 20
s_add_u32 s34, s31, s35
s_cmp_ge_u32 s34, 39
s_cbranch_scc1 K1_idle
s_mul_hi_u32 s25, s34, 1431655766
s_mul_i32 s35, s25, 3
s_sub_u32 s35, s34, s35
s_mul_i32 s36, s33, 3
s_add_u32 s26, s35, s36
s_mul_i32 s37, s33, 39
s_add_u32 s37, s37, s34
s_mov_b32 s78, s34
s_mov_b32 s79, s33
s_branch FFN
K1_kv:
s_sub_u32 s31, s31, 20
s_lshl_b32 s34, s33, 1
s_and_b32 s35, s31, 1
s_add_u32 s26, s34, s35
s_lshl_b32 s34, s32, 2
s_lshr_b32 s35, s31, 1
s_add_u32 s25, s34, s35
s_mul_i32 s34, s26, 80
s_add_u32 s28, s34, 640
s_add_u32 s29, s34, 1280
s_mov_b32 s51, 1
s_branch ATT
K1_q:
s_mov_b32 s26, s33
s_lshl_b32 s34, s32, 2
s_sub_u32 s35, s31, 28
s_add_u32 s25, s34, s35
s_mul_i32 s28, s33, 160
s_add_u32 s29, s28, 80
s_mov_b32 s51, 0
s_branch ATT
K1_idle:
s_load_dwordx2 s[92:93], s[0:1], 56
s_load_dwordx2 s[94:95], s[0:1], 24
v_lshrrev_b32 v196, 3, v255
v_mul_u32_u24 v196, 1280, v196
v_and_b32 v197, 7, v255
v_lshlrev_b32 v197, 4, v197
v_add_u32 v196, v196, v197
v_lshrrev_b32 v3, 4, v255
v_and_b32 v4, 15, v255
v_lshrrev_b32 v5, 2, v4
v_and_b32 v6, 3, v4
v_lshlrev_b32 v3, 2, v3
v_add_u32 v3, v3, v5
v_lshlrev_b32 v3, 7, v3
v_lshlrev_b32 v6, 3, v6
v_add_u32 v3, v3, v6
s_lshl_b32 s70, s24, 12
v_add_u32 v3, s70, v3
v_lshlrev_b32 v7, 4, v255
s_and_b32 s68, s2, 7
s_sub_u32 s68, s68, 4
s_lshl_b32 s68, s68, 2
s_add_u32 s68, s68, s24
s_add_u32 s68, s68, 624
s_mov_b32 s69, 0
s_waitcnt lgkmcnt(0)
WFI_901_1:
s_mul_hi_u32 s71, s68, 429496730
s_mul_i32 s72, s71, 10
s_sub_u32 s72, s68, s72
s_mov_b32 s64, s94
s_and_b32 s65, s95, 0xffff
s_mov_b32 s66, 819200
s_mov_b32 s67, 0x20000
s_cmp_ge_u32 s68, 680
s_cselect_b32 s66, 0, s66
s_sub_u32 s73, s71, 48
s_mul_i32 s30, s73, 40960
s_lshl_b32 s31, s72, 7
s_add_u32 s30, s30, s31
s_add_u32 m0, s70, 0
s_nop 0
buffer_load_dwordx4 v196, s[64:67], s30 offen lds
s_add_u32 s30, s30, 10240
s_add_u32 m0, s70, 1024
s_nop 0
buffer_load_dwordx4 v196, s[64:67], s30 offen lds
s_add_u32 s30, s30, 10240
s_add_u32 m0, s70, 2048
s_nop 0
buffer_load_dwordx4 v196, s[64:67], s30 offen lds
s_add_u32 s30, s30, 10240
s_add_u32 m0, s70, 3072
s_nop 0
buffer_load_dwordx4 v196, s[64:67], s30 offen lds
s_waitcnt vmcnt(0)
ds_read_b64_tr_b16 v[16:17], v3 offset:0
ds_read_b64_tr_b16 v[18:19], v3 offset:2048
ds_read_b64_tr_b16 v[20:21], v3 offset:32
ds_read_b64_tr_b16 v[22:23], v3 offset:2080
ds_read_b64_tr_b16 v[24:25], v3 offset:64
ds_read_b64_tr_b16 v[26:27], v3 offset:2112
ds_read_b64_tr_b16 v[28:29], v3 offset:96
ds_read_b64_tr_b16 v[30:31], v3 offset:2144
s_waitcnt lgkmcnt(0)
s_lshl_b32 s30, s72, 2
s_add_u32 s30, s30, 0
s_mul_hi_u32 s31, s30, 858993460
s_mul_i32 s32, s31, 5
s_sub_u32 s32, s30, s32
s_mul_i32 s31, s31, 68
s_add_u32 s31, s31, s71
s_mul_i32 s31, s31, 5
s_add_u32 s31, s31, s32
s_lshl_b32 s31, s31, 10
s_add_u32 s31, s31, 131072
s_cmp_ge_u32 s68, 680
s_cselect_b32 s31, 0x7ffffff0, s31
buffer_store_dwordx4 v[16:19], v7, s[20:23], s31 offen
s_lshl_b32 s30, s72, 2
s_add_u32 s30, s30, 1
s_mul_hi_u32 s31, s30, 858993460
s_mul_i32 s32, s31, 5
s_sub_u32 s32, s30, s32
s_mul_i32 s31, s31, 68
s_add_u32 s31, s31, s71
s_mul_i32 s31, s31, 5
s_add_u32 s31, s31, s32
s_lshl_b32 s31, s31, 10
s_add_u32 s31, s31, 131072
s_cmp_ge_u32 s68, 680
s_cselect_b32 s31, 0x7ffffff0, s31
buffer_store_dwordx4 v[20:23], v7, s[20:23], s31 offen
s_lshl_b32 s30, s72, 2
s_add_u32 s30, s30, 2
s_mul_hi_u32 s31, s30, 858993460
s_mul_i32 s32, s31, 5
s_sub_u32 s32, s30, s32
s_mul_i32 s31, s31, 68
s_add_u32 s31, s31, s71
s_mul_i32 s31, s31, 5
s_add_u32 s31, s31, s32
s_lshl_b32 s31, s31, 10
s_add_u32 s31, s31, 131072
s_cmp_ge_u32 s68, 680
s_cselect_b32 s31, 0x7ffffff0, s31
buffer_store_dwordx4 v[24:27], v7, s[20:23], s31 offen
s_lshl_b32 s30, s72, 2
s_add_u32 s30, s30, 3
s_mul_hi_u32 s31, s30, 858993460
s_mul_i32 s32, s31, 5
s_sub_u32 s32, s30, s32
s_mul_i32 s31, s31, 68
s_add_u32 s31, s31, s71
s_mul_i32 s31, s31, 5
s_add_u32 s31, s31, s32
s_lshl_b32 s31, s31, 10
s_add_u32 s31, s31, 131072
s_cmp_ge_u32 s68, 680
s_cselect_b32 s31, 0x7ffffff0, s31
buffer_store_dwordx4 v[28:31], v7, s[20:23], s31 offen
s_add_u32 s68, s68, 16
s_add_u32 s69, s69, 1
s_cmp_lt_u32 s69, 4
s_cbranch_scc1 WFI_901_1
s_endpgm
FFN:
s_mov_b32 s38, 0
s_mul_i32 s27, s25, 160
s_mov_b32 s4, s74
s_mov_b32 s5, s75
s_mov_b32 s6, s76
s_mov_b32 s7, s77
s_mov_b32 s60, s66
s_mov_b32 s61, s67
v_lshrrev_b32 v200, 3, v255
v_lshrrev_b32 v201, 4, v255
v_and_b32 v202, 7, v255
s_mul_i32 s30, s24, 40
s_add_u32 s30, s30, s27
s_mul_i32 s31, s24, 20
v_add_u32 v204, s30, v200
v_mul_u32_u24 v204, 1280, v204
v_add_u32 v203, 0, v201
v_add_u32 v203, s31, v203
v_and_b32 v203, 7, v203
v_xor_b32 v203, v203, v202
v_lshlrev_b32 v203, 4, v203
v_add_u32 v205, v203, v204
v_add_u32 v203, 4, v201
v_add_u32 v203, s31, v203
v_and_b32 v203, 7, v203
v_xor_b32 v203, v203, v202
v_lshlrev_b32 v203, 4, v203
v_add_u32 v206, v203, v204
v_add_u32 v164, 0, v205
v_add_u32 v165, 10240, v206
v_add_u32 v166, 20480, v205
v_add_u32 v167, 30720, v206
v_add_u32 v168, 40960, v205
s_mul_i32 s34, s24, 5120
s_mov_b32 s40, 0
s_mov_b32 s39, s38
s_lshl_b32 s41, s39, 7
s_mul_i32 s42, s39, 196608
s_mov_b32 s48, s34
s_add_u32 m0, s48, 0
s_nop 0
buffer_load_dwordx4 v164, s[8:11], s41 offen lds
s_add_u32 m0, s48, 1024
s_nop 0
buffer_load_dwordx4 v165, s[8:11], s41 offen lds
s_add_u32 m0, s48, 2048
s_nop 0
buffer_load_dwordx4 v166, s[8:11], s41 offen lds
s_add_u32 m0, s48, 3072
s_nop 0
buffer_load_dwordx4 v167, s[8:11], s41 offen lds
s_add_u32 m0, s48, 4096
s_nop 0
buffer_load_dwordx4 v168, s[8:11], s41 offen lds
v_lshrrev_b32 v200, 4, v255
v_and_b32 v201, 15, v255
v_lshlrev_b32 v202, 1, v200
s_lshl_b32 s31, s26, 8
s_lshl_b32 s32, s24, 4
v_add_u32 v204, s32, v200
v_mul_u32_u24 v204, 3072, v204
v_add_u32 v204, s31, v204
v_xor_b32 v203, 0, v202
v_xor_b32 v203, v203, v201
v_lshlrev_b32 v203, 4, v203
v_add_u32 v205, v203, v204
v_xor_b32 v203, 8, v202
v_xor_b32 v203, v203, v201
v_lshlrev_b32 v203, 4, v203
v_add_u32 v206, v203, v204
v_add_u32 v169, 0, v205
v_add_u32 v170, 12288, v205
v_add_u32 v171, 24576, v206
v_add_u32 v172, 36864, v206
s_lshl_b32 s35, s24, 12
s_add_u32 s36, s35, 36864
s_add_u32 s35, s35, 20480
s_mov_b32 s12, s4
s_and_b32 s13, s5, 0xffff
s_mov_b32 s14, 1966080
s_mov_b32 s15, 0x20000
s_mov_b32 s16, s6
s_and_b32 s17, s7, 0xffff
s_mov_b32 s18, 1966080
s_mov_b32 s19, 0x20000
s_mov_b32 s49, s35
s_mov_b32 s50, s36
s_add_u32 m0, s49, 0
s_nop 0
buffer_load_dwordx4 v169, s[12:15], s42 offen lds
s_add_u32 m0, s50, 0
s_nop 0
buffer_load_dwordx4 v169, s[16:19], s42 offen lds
s_add_u32 m0, s49, 1024
s_nop 0
buffer_load_dwordx4 v170, s[12:15], s42 offen lds
s_add_u32 m0, s50, 1024
s_nop 0
buffer_load_dwordx4 v170, s[16:19], s42 offen lds
s_add_u32 m0, s49, 2048
s_nop 0
buffer_load_dwordx4 v171, s[12:15], s42 offen lds
s_add_u32 m0, s50, 2048
s_nop 0
buffer_load_dwordx4 v171, s[16:19], s42 offen lds
s_add_u32 m0, s49, 3072
s_nop 0
buffer_load_dwordx4 v172, s[12:15], s42 offen lds
s_add_u32 m0, s50, 3072
s_nop 0
buffer_load_dwordx4 v172, s[16:19], s42 offen lds
s_add_u32 s39, s39, 1
s_cmp_ge_u32 s39, 10
s_cselect_b32 s39, 0, s39
s_lshl_b32 s41, s39, 7
s_mul_i32 s42, s39, 196608
s_add_u32 s40, s40, 53248
s_cmp_ge_u32 s40, 159744
s_cselect_b32 s43, 159744, 0
s_sub_u32 s40, s40, s43
s_add_u32 s48, s40, s34
s_add_u32 s49, s40, s35
s_add_u32 s50, s40, s36
s_cmp_ge_u32 s78, 20
s_cselect_b32 s30, 20, 0
s_cselect_b32 s32, 1024, 0
s_sub_u32 s30, s78, s30
s_cmp_ge_u32 s30, 16
s_cselect_b32 s62, 0x40000000, 0
s_lshl_b32 s31, s79, 4
s_add_u32 s30, s30, s31
s_lshl_b32 s30, s30, 4
s_add_u32 s30, s30, s32
s_lshl_b32 s31, s24, 2
s_add_u32 s30, s30, s31
v_lshrrev_b32 v200, 5, v255
v_add_u32 v196, s30, v200
v_and_b32 v197, 31, v255
v_mul_u32_u24 v201, 1280, v196
v_lshlrev_b32 v202, 3, v197
v_add_u32 v201, v201, v202
s_mov_b32 s31, s62
s_add_u32 s32, s31, 2560
buffer_load_dwordx2 v[0:1], v201, s[8:11], s31 offen offset:0
buffer_load_dwordx2 v[2:3], v201, s[8:11], s31 offen offset:256
buffer_load_dwordx2 v[4:5], v201, s[8:11], s31 offen offset:512
buffer_load_dwordx2 v[6:7], v201, s[8:11], s31 offen offset:768
buffer_load_dwordx2 v[8:9], v201, s[8:11], s31 offen offset:1024
buffer_load_dwordx2 v[10:11], v201, s[8:11], s32 offen offset:0
buffer_load_dwordx2 v[12:13], v201, s[8:11], s32 offen offset:256
buffer_load_dwordx2 v[14:15], v201, s[8:11], s32 offen offset:512
buffer_load_dwordx2 v[16:17], v201, s[8:11], s32 offen offset:768
buffer_load_dwordx2 v[18:19], v201, s[8:11], s32 offen offset:1024
s_cmp_ge_u32 s78, 24
s_cbranch_scc1 FFN_uq
s_lshr_b32 s30, s78, 1
s_and_b32 s63, s78, 1
s_mul_i32 s31, s79, 6
s_add_u32 s31, s31, s30
s_cmp_ge_u32 s30, 6
s_cselect_b32 s30, 48, 30
s_add_u32 s30, s30, s31
s_branch FFN_ud
FFN_uq:
s_mul_i32 s31, s79, 15
s_add_u32 s31, s31, s78
s_sub_u32 s31, s31, 24
s_and_b32 s63, s31, 1
s_lshr_b32 s31, s31, 1
s_mul_hi_u32 s30, s31, 1431655766
s_mul_i32 s33, s30, 3
s_sub_u32 s33, s31, s33
s_mul_i32 s33, s33, 10
s_add_u32 s30, s30, s33
FFN_ud:
s_mov_b32 s77, s30
s_mov_b32 s64, s60
s_and_b32 s65, s61, 0xffff
s_mov_b32 s66, 2457600
s_mov_b32 s67, 0x20000
s_mov_b32 s33, 3840
s_mov_b32 s32, s30
s_cmp_ge_u32 s30, 30
s_cbranch_scc0 FFN_msel
s_mov_b32 s64, s4
s_and_b32 s65, s5, 0xffff
s_mov_b32 s66, 1966080
s_mov_b32 s33, 3072
s_sub_u32 s32, s30, 30
s_cmp_ge_u32 s30, 54
s_cbranch_scc0 FFN_msel
s_mov_b32 s64, s6
s_and_b32 s65, s7, 0xffff
s_sub_u32 s32, s30, 54
FFN_msel:
s_mul_i32 s31, s63, 320
s_lshl_b32 s53, s24, 3
s_add_u32 s31, s31, s53
v_lshrrev_b32 v200, 3, v255
v_add_u32 v200, s31, v200
v_mul_lo_u32 v200, v200, s33
v_and_b32 v201, 7, v255
v_lshlrev_b32 v201, 4, v201
s_lshl_b32 s32, s32, 7
v_add_u32 v201, s32, v201
v_add_u32 v200, v200, v201
s_lshl_b32 s33, s33, 5
s_mov_b32 s31, 0
buffer_load_dwordx4 v[20:23], v200, s[64:67], s31 offen
s_add_u32 s31, s31, s33
buffer_load_dwordx4 v[24:27], v200, s[64:67], s31 offen
s_add_u32 s31, s31, s33
buffer_load_dwordx4 v[28:31], v200, s[64:67], s31 offen
s_add_u32 s31, s31, s33
buffer_load_dwordx4 v[32:35], v200, s[64:67], s31 offen
s_add_u32 s31, s31, s33
buffer_load_dwordx4 v[36:39], v200, s[64:67], s31 offen
s_add_u32 s31, s31, s33
buffer_load_dwordx4 v[40:43], v200, s[64:67], s31 offen
s_add_u32 s31, s31, s33
buffer_load_dwordx4 v[44:47], v200, s[64:67], s31 offen
s_add_u32 s31, s31, s33
buffer_load_dwordx4 v[48:51], v200, s[64:67], s31 offen
s_add_u32 s31, s31, s33
buffer_load_dwordx4 v[52:55], v200, s[64:67], s31 offen
s_add_u32 s31, s31, s33
buffer_load_dwordx4 v[56:59], v200, s[64:67], s31 offen
s_add_u32 m0, s48, 0
s_nop 0
buffer_load_dwordx4 v164, s[8:11], s41 offen lds
s_add_u32 m0, s49, 0
s_nop 0
buffer_load_dwordx4 v169, s[12:15], s42 offen lds
s_add_u32 m0, s50, 0
s_nop 0
buffer_load_dwordx4 v169, s[16:19], s42 offen lds
s_add_u32 m0, s48, 1024
s_nop 0
buffer_load_dwordx4 v165, s[8:11], s41 offen lds
s_add_u32 m0, s49, 1024
s_nop 0
buffer_load_dwordx4 v170, s[12:15], s42 offen lds
s_add_u32 m0, s50, 1024
s_nop 0
buffer_load_dwordx4 v170, s[16:19], s42 offen lds
s_add_u32 m0, s48, 2048
s_nop 0
buffer_load_dwordx4 v166, s[8:11], s41 offen lds
s_add_u32 m0, s49, 2048
s_nop 0
buffer_load_dwordx4 v171, s[12:15], s42 offen lds
s_add_u32 m0, s50, 2048
s_nop 0
buffer_load_dwordx4 v171, s[16:19], s42 offen lds
s_add_u32 m0, s48, 3072
s_nop 0
buffer_load_dwordx4 v167, s[8:11], s41 offen lds
s_add_u32 m0, s49, 3072
s_nop 0
buffer_load_dwordx4 v172, s[12:15], s42 offen lds
s_add_u32 m0, s50, 3072
s_nop 0
buffer_load_dwordx4 v172, s[16:19], s42 offen lds
s_add_u32 m0, s48, 4096
s_nop 0
buffer_load_dwordx4 v168, s[8:11], s41 offen lds
s_add_u32 s39, s39, 1
s_cmp_ge_u32 s39, 10
s_cselect_b32 s39, 0, s39
s_lshl_b32 s41, s39, 7
s_mul_i32 s42, s39, 196608
s_add_u32 s40, s40, 53248
s_cmp_ge_u32 s40, 159744
s_cselect_b32 s43, 159744, 0
s_sub_u32 s40, s40, s43
s_add_u32 s48, s40, s34
s_add_u32 s49, s40, s35
s_add_u32 s50, s40, s36
s_mov_b32 s30, 0
v_and_b32 v200, 15, v255
v_lshrrev_b32 v201, 4, v255
v_lshrrev_b32 v202, 1, v200
v_xor_b32 v202, v202, v201
v_and_b32 v202, 7, v202
v_lshlrev_b32 v202, 4, v202
v_lshlrev_b32 v203, 7, v200
v_add_u32 v203, v203, v202
v_add_u32 v160, s30, v203
v_xor_b32 v161, 64, v160
v_and_b32 v200, 15, v255
v_lshrrev_b32 v201, 4, v255
v_lshrrev_b32 v202, 2, v200
v_and_b32 v203, 3, v200
v_lshlrev_b32 v204, 3, v201
v_add_u32 v204, v204, v202
v_lshlrev_b32 v204, 8, v204
v_lshlrev_b32 v205, 1, v202
v_and_b32 v206, 1, v201
v_lshlrev_b32 v206, 3, v206
v_or_b32 v205, v205, v206
v_lshrrev_b32 v206, 1, v203
s_lshl_b32 s30, s24, 2
v_add_u32 v206, s30, v206
v_and_b32 v207, 1, v203
v_lshlrev_b32 v207, 3, v207
v_add_u32 v199, 0, v206
v_xor_b32 v199, v199, v205
v_lshlrev_b32 v199, 4, v199
v_add_u32 v199, v199, v207
v_add_u32 v199, v199, v204
v_add_u32 v162, 20480, v199
v_add_u32 v199, 2, v206
v_xor_b32 v199, v199, v205
v_lshlrev_b32 v199, 4, v199
v_add_u32 v199, v199, v207
v_add_u32 v199, v199, v204
v_add_u32 v163, 20480, v199
s_lshl_b32 s30, s26, 2
s_add_u32 s30, s30, s24
s_mul_i32 s31, s25, 10
s_add_u32 s32, s31, 0
s_lshr_b32 s33, s32, 2
s_mul_i32 s33, s33, 68
s_add_u32 s33, s33, s30
s_lshl_b32 s33, s33, 2
s_and_b32 s53, s32, 3
s_add_u32 s33, s33, s53
s_lshl_b32 s33, s33, 10
s_add_u32 s33, s33, 3145728
s_cmp_ge_u32 s32, 128
s_cselect_b32 s80, 0x7ffffff0, s33
s_add_u32 s32, s31, 1
s_lshr_b32 s33, s32, 2
s_mul_i32 s33, s33, 68
s_add_u32 s33, s33, s30
s_lshl_b32 s33, s33, 2
s_and_b32 s53, s32, 3
s_add_u32 s33, s33, s53
s_lshl_b32 s33, s33, 10
s_add_u32 s33, s33, 3145728
s_cmp_ge_u32 s32, 128
s_cselect_b32 s81, 0x7ffffff0, s33
s_add_u32 s32, s31, 2
s_lshr_b32 s33, s32, 2
s_mul_i32 s33, s33, 68
s_add_u32 s33, s33, s30
s_lshl_b32 s33, s33, 2
s_and_b32 s53, s32, 3
s_add_u32 s33, s33, s53
s_lshl_b32 s33, s33, 10
s_add_u32 s33, s33, 3145728
s_cmp_ge_u32 s32, 128
s_cselect_b32 s82, 0x7ffffff0, s33
s_add_u32 s32, s31, 3
s_lshr_b32 s33, s32, 2
s_mul_i32 s33, s33, 68
s_add_u32 s33, s33, s30
s_lshl_b32 s33, s33, 2
s_and_b32 s53, s32, 3
s_add_u32 s33, s33, s53
s_lshl_b32 s33, s33, 10
s_add_u32 s33, s33, 3145728
s_cmp_ge_u32 s32, 128
s_cselect_b32 s83, 0x7ffffff0, s33
s_add_u32 s32, s31, 4
s_lshr_b32 s33, s32, 2
s_mul_i32 s33, s33, 68
s_add_u32 s33, s33, s30
s_lshl_b32 s33, s33, 2
s_and_b32 s53, s32, 3
s_add_u32 s33, s33, s53
s_lshl_b32 s33, s33, 10
s_add_u32 s33, s33, 3145728
s_cmp_ge_u32 s32, 128
s_cselect_b32 s84, 0x7ffffff0, s33
s_add_u32 s32, s31, 5
s_lshr_b32 s33, s32, 2
s_mul_i32 s33, s33, 68
s_add_u32 s33, s33, s30
s_lshl_b32 s33, s33, 2
s_and_b32 s53, s32, 3
s_add_u32 s33, s33, s53
s_lshl_b32 s33, s33, 10
s_add_u32 s33, s33, 3145728
s_cmp_ge_u32 s32, 128
s_cselect_b32 s85, 0x7ffffff0, s33
s_add_u32 s32, s31, 6
s_lshr_b32 s33, s32, 2
s_mul_i32 s33, s33, 68
s_add_u32 s33, s33, s30
s_lshl_b32 s33, s33, 2
s_and_b32 s53, s32, 3
s_add_u32 s33, s33, s53
s_lshl_b32 s33, s33, 10
s_add_u32 s33, s33, 3145728
s_cmp_ge_u32 s32, 128
s_cselect_b32 s86, 0x7ffffff0, s33
s_add_u32 s32, s31, 7
s_lshr_b32 s33, s32, 2
s_mul_i32 s33, s33, 68
s_add_u32 s33, s33, s30
s_lshl_b32 s33, s33, 2
s_and_b32 s53, s32, 3
s_add_u32 s33, s33, s53
s_lshl_b32 s33, s33, 10
s_add_u32 s33, s33, 3145728
s_cmp_ge_u32 s32, 128
s_cselect_b32 s87, 0x7ffffff0, s33
s_add_u32 s32, s31, 8
s_lshr_b32 s33, s32, 2
s_mul_i32 s33, s33, 68
s_add_u32 s33, s33, s30
s_lshl_b32 s33, s33, 2
s_and_b32 s53, s32, 3
s_add_u32 s33, s33, s53
s_lshl_b32 s33, s33, 10
s_add_u32 s33, s33, 3145728
s_cmp_ge_u32 s32, 128
s_cselect_b32 s88, 0x7ffffff0, s33
s_add_u32 s32, s31, 9
s_lshr_b32 s33, s32, 2
s_mul_i32 s33, s33, 68
s_add_u32 s33, s33, s30
s_lshl_b32 s33, s33, 2
s_and_b32 s53, s32, 3
s_add_u32 s33, s33, s53
s_lshl_b32 s33, s33, 10
s_add_u32 s33, s33, 3145728
s_cmp_ge_u32 s32, 128
s_cselect_b32 s89, 0x7ffffff0, s33
v_mov_b32 v60, 0
v_mov_b32 v61, 0
v_mov_b32 v62, 0
v_mov_b32 v63, 0
v_mov_b32 v64, 0
v_mov_b32 v65, 0
v_mov_b32 v66, 0
v_mov_b32 v67, 0
v_mov_b32 v68, 0
v_mov_b32 v69, 0
v_mov_b32 v70, 0
v_mov_b32 v71, 0
v_mov_b32 v72, 0
v_mov_b32 v73, 0
v_mov_b32 v74, 0
v_mov_b32 v75, 0
v_mov_b32 v76, 0
v_mov_b32 v77, 0
v_mov_b32 v78, 0
v_mov_b32 v79, 0
v_mov_b32 v80, 0
v_mov_b32 v81, 0
v_mov_b32 v82, 0
v_mov_b32 v83, 0
v_mov_b32 v84, 0
v_mov_b32 v85, 0
v_mov_b32 v86, 0
v_mov_b32 v87, 0
v_mov_b32 v88, 0
v_mov_b32 v89, 0
v_mov_b32 v90, 0
v_mov_b32 v91, 0
v_mov_b32 v92, 0
v_mov_b32 v93, 0
v_mov_b32 v94, 0
v_mov_b32 v95, 0
v_mov_b32 v96, 0
v_mov_b32 v97, 0
v_mov_b32 v98, 0
v_mov_b32 v99, 0
v_mov_b32 v100, 0
v_mov_b32 v101, 0
v_mov_b32 v102, 0
v_mov_b32 v103, 0
v_mov_b32 v104, 0
v_mov_b32 v105, 0
v_mov_b32 v106, 0
v_mov_b32 v107, 0
v_mov_b32 v108, 0
v_mov_b32 v109, 0
v_mov_b32 v110, 0
v_mov_b32 v111, 0
v_mov_b32 v112, 0
v_mov_b32 v113, 0
v_mov_b32 v114, 0
v_mov_b32 v115, 0
v_mov_b32 v116, 0
v_mov_b32 v117, 0
v_mov_b32 v118, 0
v_mov_b32 v119, 0
v_mov_b32 v120, 0
v_mov_b32 v121, 0
v_mov_b32 v122, 0
v_mov_b32 v123, 0
v_mov_b32 v124, 0
v_mov_b32 v125, 0
v_mov_b32 v126, 0
v_mov_b32 v127, 0
v_mov_b32 v128, 0
v_mov_b32 v129, 0
v_mov_b32 v130, 0
v_mov_b32 v131, 0
v_mov_b32 v132, 0
v_mov_b32 v133, 0
v_mov_b32 v134, 0
v_mov_b32 v135, 0
v_mov_b32 v136, 0
v_mov_b32 v137, 0
v_mov_b32 v138, 0
v_mov_b32 v139, 0
v_mov_b32 v140, 0
v_mov_b32 v141, 0
v_mov_b32 v142, 0
v_mov_b32 v143, 0
v_mov_b32 v144, 0
v_mov_b32 v145, 0
v_mov_b32 v146, 0
v_mov_b32 v147, 0
v_mov_b32 v148, 0
v_mov_b32 v149, 0
v_mov_b32 v150, 0
v_mov_b32 v151, 0
v_mov_b32 v152, 0
v_mov_b32 v153, 0
v_mov_b32 v154, 0
v_mov_b32 v155, 0
v_mov_b32 v156, 0
v_mov_b32 v157, 0
v_mov_b32 v158, 0
v_mov_b32 v159, 0
s_waitcnt vmcnt(13)
v_mov_b32 v200, 0
v_mov_b32 v202, 0
v_mov_b32 v201, 0
v_mov_b32 v203, 0
v_dot2c_f32_bf16 v200, 0x3f803f80, v0
v_dot2c_f32_bf16 v202, 0x3f803f80, v10
v_dot2c_f32_bf16 v201, v0, v0
v_dot2c_f32_bf16 v203, v10, v10
v_dot2c_f32_bf16 v200, 0x3f803f80, v1
v_dot2c_f32_bf16 v202, 0x3f803f80, v11
v_dot2c_f32_bf16 v201, v1, v1
v_dot2c_f32_bf16 v203, v11, v11
v_dot2c_f32_bf16 v200, 0x3f803f80, v2
v_dot2c_f32_bf16 v202, 0x3f803f80, v12
v_dot2c_f32_bf16 v201, v2, v2
v_dot2c_f32_bf16 v203, v12, v12
v_dot2c_f32_bf16 v200, 0x3f803f80, v3
v_dot2c_f32_bf16 v202, 0x3f803f80, v13
v_dot2c_f32_bf16 v201, v3, v3
v_dot2c_f32_bf16 v203, v13, v13
v_dot2c_f32_bf16 v200, 0x3f803f80, v4
v_dot2c_f32_bf16 v202, 0x3f803f80, v14
v_dot2c_f32_bf16 v201, v4, v4
v_dot2c_f32_bf16 v203, v14, v14
v_dot2c_f32_bf16 v200, 0x3f803f80, v5
v_dot2c_f32_bf16 v202, 0x3f803f80, v15
v_dot2c_f32_bf16 v201, v5, v5
v_dot2c_f32_bf16 v203, v15, v15
v_dot2c_f32_bf16 v200, 0x3f803f80, v6
v_dot2c_f32_bf16 v202, 0x3f803f80, v16
v_dot2c_f32_bf16 v201, v6, v6
v_dot2c_f32_bf16 v203, v16, v16
v_dot2c_f32_bf16 v200, 0x3f803f80, v7
v_dot2c_f32_bf16 v202, 0x3f803f80, v17
v_dot2c_f32_bf16 v201, v7, v7
v_dot2c_f32_bf16 v203, v17, v17
v_dot2c_f32_bf16 v200, 0x3f803f80, v8
v_dot2c_f32_bf16 v202, 0x3f803f80, v18
v_dot2c_f32_bf16 v201, v8, v8
v_dot2c_f32_bf16 v203, v18, v18
v_dot2c_f32_bf16 v200, 0x3f803f80, v9
v_dot2c_f32_bf16 v202, 0x3f803f80, v19
v_dot2c_f32_bf16 v201, v9, v9
v_dot2c_f32_bf16 v203, v19, v19
v_add_f32_dpp v200, v200, v200 row_shr:1 row_mask:0xf bank_mask:0xf bound_ctrl:0
v_add_f32_dpp v202, v202, v202 row_shr:1 row_mask:0xf bank_mask:0xf bound_ctrl:0
v_add_f32_dpp v201, v201, v201 row_shr:1 row_mask:0xf bank_mask:0xf bound_ctrl:0
v_add_f32_dpp v203, v203, v203 row_shr:1 row_mask:0xf bank_mask:0xf bound_ctrl:0
v_add_f32_dpp v200, v200, v200 row_shr:2 row_mask:0xf bank_mask:0xf bound_ctrl:0
v_add_f32_dpp v202, v202, v202 row_shr:2 row_mask:0xf bank_mask:0xf bound_ctrl:0
v_add_f32_dpp v201, v201, v201 row_shr:2 row_mask:0xf bank_mask:0xf bound_ctrl:0
v_add_f32_dpp v203, v203, v203 row_shr:2 row_mask:0xf bank_mask:0xf bound_ctrl:0
v_add_f32_dpp v200, v200, v200 row_shr:4 row_mask:0xf bank_mask:0xf bound_ctrl:0
v_add_f32_dpp v202, v202, v202 row_shr:4 row_mask:0xf bank_mask:0xf bound_ctrl:0
v_add_f32_dpp v201, v201, v201 row_shr:4 row_mask:0xf bank_mask:0xf bound_ctrl:0
v_add_f32_dpp v203, v203, v203 row_shr:4 row_mask:0xf bank_mask:0xf bound_ctrl:0
v_add_f32_dpp v200, v200, v200 row_shr:8 row_mask:0xf bank_mask:0xf bound_ctrl:0
v_add_f32_dpp v202, v202, v202 row_shr:8 row_mask:0xf bank_mask:0xf bound_ctrl:0
v_add_f32_dpp v201, v201, v201 row_shr:8 row_mask:0xf bank_mask:0xf bound_ctrl:0
v_add_f32_dpp v203, v203, v203 row_shr:8 row_mask:0xf bank_mask:0xf bound_ctrl:0
v_add_f32_dpp v200, v200, v200 row_bcast:15 row_mask:0xa bank_mask:0xf
v_add_f32_dpp v202, v202, v202 row_bcast:15 row_mask:0xa bank_mask:0xf
v_add_f32_dpp v201, v201, v201 row_bcast:15 row_mask:0xa bank_mask:0xf
v_add_f32_dpp v203, v203, v203 row_bcast:15 row_mask:0xa bank_mask:0xf
v_mul_f32 v200, 0.0015625, v200
v_mul_f32 v202, 0.0015625, v202
v_mul_f32 v201, 0.0015625, v201
v_mul_f32 v203, 0.0015625, v203
v_fma_f32 v201, -v200, v200, v201
v_fma_f32 v203, -v202, v202, v203
v_max_f32 v201, 0, v201
v_max_f32 v203, 0, v203
v_add_f32 v201, 1e-05, v201
v_add_f32 v203, 1e-05, v203
v_rsq_f32 v201, v201
v_rsq_f32 v203, v203
v_mov_b32 v204, 0
v_mov_b32 v205, 0
v_mov_b32 v206, 0
v_mov_b32 v207, 0
v_mov_b32 v208, 0
v_mov_b32 v209, 0
v_mov_b32 v210, 0
v_mov_b32 v211, 0
v_lshlrev_b32 v212, 16, v20
v_and_b32 v213, 0xffff0000, v20
v_pk_add_f32 v[204:205], v[204:205], v[212:213]
v_lshlrev_b32 v212, 16, v21
v_and_b32 v213, 0xffff0000, v21
v_pk_add_f32 v[206:207], v[206:207], v[212:213]
v_lshlrev_b32 v212, 16, v22
v_and_b32 v213, 0xffff0000, v22
v_pk_add_f32 v[208:209], v[208:209], v[212:213]
v_lshlrev_b32 v212, 16, v23
v_and_b32 v213, 0xffff0000, v23
v_pk_add_f32 v[210:211], v[210:211], v[212:213]
v_lshlrev_b32 v212, 16, v24
v_and_b32 v213, 0xffff0000, v24
v_pk_add_f32 v[204:205], v[204:205], v[212:213]
v_lshlrev_b32 v212, 16, v25
v_and_b32 v213, 0xffff0000, v25
v_pk_add_f32 v[206:207], v[206:207], v[212:213]
v_lshlrev_b32 v212, 16, v26
v_and_b32 v213, 0xffff0000, v26
v_pk_add_f32 v[208:209], v[208:209], v[212:213]
v_lshlrev_b32 v212, 16, v27
v_and_b32 v213, 0xffff0000, v27
v_pk_add_f32 v[210:211], v[210:211], v[212:213]
v_lshlrev_b32 v212, 16, v28
v_and_b32 v213, 0xffff0000, v28
v_pk_add_f32 v[204:205], v[204:205], v[212:213]
v_lshlrev_b32 v212, 16, v29
v_and_b32 v213, 0xffff0000, v29
v_pk_add_f32 v[206:207], v[206:207], v[212:213]
v_lshlrev_b32 v212, 16, v30
v_and_b32 v213, 0xffff0000, v30
v_pk_add_f32 v[208:209], v[208:209], v[212:213]
v_lshlrev_b32 v212, 16, v31
v_and_b32 v213, 0xffff0000, v31
v_pk_add_f32 v[210:211], v[210:211], v[212:213]
v_lshlrev_b32 v212, 16, v32
v_and_b32 v213, 0xffff0000, v32
v_pk_add_f32 v[204:205], v[204:205], v[212:213]
v_lshlrev_b32 v212, 16, v33
v_and_b32 v213, 0xffff0000, v33
v_pk_add_f32 v[206:207], v[206:207], v[212:213]
v_lshlrev_b32 v212, 16, v34
v_and_b32 v213, 0xffff0000, v34
v_pk_add_f32 v[208:209], v[208:209], v[212:213]
v_lshlrev_b32 v212, 16, v35
v_and_b32 v213, 0xffff0000, v35
v_pk_add_f32 v[210:211], v[210:211], v[212:213]
v_lshlrev_b32 v212, 16, v36
v_and_b32 v213, 0xffff0000, v36
v_pk_add_f32 v[204:205], v[204:205], v[212:213]
v_lshlrev_b32 v212, 16, v37
v_and_b32 v213, 0xffff0000, v37
v_pk_add_f32 v[206:207], v[206:207], v[212:213]
v_lshlrev_b32 v212, 16, v38
v_and_b32 v213, 0xffff0000, v38
v_pk_add_f32 v[208:209], v[208:209], v[212:213]
v_lshlrev_b32 v212, 16, v39
v_and_b32 v213, 0xffff0000, v39
v_pk_add_f32 v[210:211], v[210:211], v[212:213]
v_lshlrev_b32 v212, 16, v40
v_and_b32 v213, 0xffff0000, v40
v_pk_add_f32 v[204:205], v[204:205], v[212:213]
v_lshlrev_b32 v212, 16, v41
v_and_b32 v213, 0xffff0000, v41
v_pk_add_f32 v[206:207], v[206:207], v[212:213]
v_lshlrev_b32 v212, 16, v42
v_and_b32 v213, 0xffff0000, v42
v_pk_add_f32 v[208:209], v[208:209], v[212:213]
v_lshlrev_b32 v212, 16, v43
v_and_b32 v213, 0xffff0000, v43
v_pk_add_f32 v[210:211], v[210:211], v[212:213]
v_lshlrev_b32 v212, 16, v44
v_and_b32 v213, 0xffff0000, v44
v_pk_add_f32 v[204:205], v[204:205], v[212:213]
v_lshlrev_b32 v212, 16, v45
v_and_b32 v213, 0xffff0000, v45
v_pk_add_f32 v[206:207], v[206:207], v[212:213]
v_lshlrev_b32 v212, 16, v46
v_and_b32 v213, 0xffff0000, v46
v_pk_add_f32 v[208:209], v[208:209], v[212:213]
v_lshlrev_b32 v212, 16, v47
v_and_b32 v213, 0xffff0000, v47
v_pk_add_f32 v[210:211], v[210:211], v[212:213]
v_lshlrev_b32 v212, 16, v48
v_and_b32 v213, 0xffff0000, v48
v_pk_add_f32 v[204:205], v[204:205], v[212:213]
v_lshlrev_b32 v212, 16, v49
v_and_b32 v213, 0xffff0000, v49
v_pk_add_f32 v[206:207], v[206:207], v[212:213]
v_lshlrev_b32 v212, 16, v50
v_and_b32 v213, 0xffff0000, v50
v_pk_add_f32 v[208:209], v[208:209], v[212:213]
v_lshlrev_b32 v212, 16, v51
v_and_b32 v213, 0xffff0000, v51
v_pk_add_f32 v[210:211], v[210:211], v[212:213]
v_lshlrev_b32 v212, 16, v52
v_and_b32 v213, 0xffff0000, v52
v_pk_add_f32 v[204:205], v[204:205], v[212:213]
v_lshlrev_b32 v212, 16, v53
v_and_b32 v213, 0xffff0000, v53
v_pk_add_f32 v[206:207], v[206:207], v[212:213]
v_lshlrev_b32 v212, 16, v54
v_and_b32 v213, 0xffff0000, v54
v_pk_add_f32 v[208:209], v[208:209], v[212:213]
v_lshlrev_b32 v212, 16, v55
v_and_b32 v213, 0xffff0000, v55
v_pk_add_f32 v[210:211], v[210:211], v[212:213]
v_lshlrev_b32 v212, 16, v56
v_and_b32 v213, 0xffff0000, v56
v_pk_add_f32 v[204:205], v[204:205], v[212:213]
v_lshlrev_b32 v212, 16, v57
v_and_b32 v213, 0xffff0000, v57
v_pk_add_f32 v[206:207], v[206:207], v[212:213]
v_lshlrev_b32 v212, 16, v58
v_and_b32 v213, 0xffff0000, v58
v_pk_add_f32 v[208:209], v[208:209], v[212:213]
v_lshlrev_b32 v212, 16, v59
v_and_b32 v213, 0xffff0000, v59
v_pk_add_f32 v[210:211], v[210:211], v[212:213]
s_lshl_b32 s30, s24, 11
v_lshlrev_b32 v214, 5, v255
v_add_u32 v214, s30, v214
v_add_u32 v214, 106496, v214
ds_write_b128 v214, v[204:207]
ds_write_b128 v214, v[208:211] offset:16
v_lshlrev_b32 v196, 3, v196
s_add_u32 s31, s62, 0
s_add_u32 s32, s31, 16
v_cmp_eq_u32 vcc, 31, v197
s_nop 0
s_mov_b64 exec, vcc
buffer_store_dwordx2 v[200:201], v196, s[20:23], s31 offen sc1
buffer_store_dwordx2 v[202:203], v196, s[20:23], s32 offen sc1
s_mov_b64 exec, -1
v_mov_b32 v0, 0
v_mov_b32 v1, 0
v_mov_b32 v2, 0
v_mov_b32 v3, 0
v_mov_b32 v4, 0
v_mov_b32 v5, 0
v_mov_b32 v6, 0
v_mov_b32 v7, 0
v_mov_b32 v8, 0
v_mov_b32 v9, 0
v_mov_b32 v10, 0
v_mov_b32 v11, 0
v_mov_b32 v12, 0
v_mov_b32 v13, 0
v_mov_b32 v14, 0
v_mov_b32 v15, 0
v_mov_b32 v16, 0
v_mov_b32 v17, 0
v_mov_b32 v18, 0
v_mov_b32 v19, 0
v_mov_b32 v20, 0
v_mov_b32 v21, 0
v_mov_b32 v22, 0
v_mov_b32 v23, 0
v_mov_b32 v24, 0
v_mov_b32 v25, 0
v_mov_b32 v26, 0
v_mov_b32 v27, 0
v_mov_b32 v28, 0
v_mov_b32 v29, 0
v_mov_b32 v30, 0
v_mov_b32 v31, 0
v_mov_b32 v32, 0
v_mov_b32 v33, 0
v_mov_b32 v34, 0
v_mov_b32 v35, 0
v_mov_b32 v36, 0
v_mov_b32 v37, 0
v_mov_b32 v38, 0
v_mov_b32 v39, 0
v_mov_b32 v40, 0
v_mov_b32 v41, 0
v_mov_b32 v42, 0
v_mov_b32 v43, 0
v_mov_b32 v44, 0
v_mov_b32 v45, 0
v_mov_b32 v46, 0
v_mov_b32 v47, 0
v_mov_b32 v48, 0
v_mov_b32 v49, 0
v_mov_b32 v50, 0
v_mov_b32 v51, 0
v_mov_b32 v52, 0
v_mov_b32 v53, 0
v_mov_b32 v54, 0
v_mov_b32 v55, 0
v_mov_b32 v56, 0
v_mov_b32 v57, 0
v_mov_b32 v58, 0
v_mov_b32 v59, 0
s_waitcnt lgkmcnt(0)
s_barrier
v_and_b32 v200, 15, v255
s_lshl_b32 s30, s24, 4
v_add_u32 v200, s30, v200
v_lshrrev_b32 v201, 3, v200
v_lshlrev_b32 v201, 5, v201
v_and_b32 v202, 7, v200
v_lshlrev_b32 v202, 2, v202
v_add_u32 v201, v201, v202
v_lshrrev_b32 v202, 4, v255
v_lshlrev_b32 v202, 11, v202
v_add_u32 v201, v201, v202
v_add_u32 v201, 106496, v201
ds_read_b32 v204, v201 offset:0
ds_read_b32 v205, v201 offset:256
ds_read_b32 v206, v201 offset:512
ds_read_b32 v207, v201 offset:768
ds_read_b32 v208, v201 offset:1024
ds_read_b32 v209, v201 offset:1280
ds_read_b32 v210, v201 offset:1536
ds_read_b32 v211, v201 offset:1792
s_waitcnt lgkmcnt(0)
v_add_f32 v204, v204, v205
v_add_f32 v206, v206, v207
v_add_f32 v208, v208, v209
v_add_f32 v210, v210, v211
v_add_f32 v204, v204, v206
v_add_f32 v208, v208, v210
v_add_f32 v204, v204, v208
v_mov_b32 v205, v204
s_nop 1
v_permlane16_swap_b32 v204, v205
v_add_f32 v204, v204, v205
v_mov_b32 v205, v204
s_nop 1
v_permlane32_swap_b32 v204, v205
v_add_f32 v204, v204, v205
s_mul_i32 s30, s63, 4992
s_lshl_b32 s31, s77, 6
s_add_u32 s30, s30, s31
s_lshl_b32 s30, s30, 2
s_add_u32 s30, s30, 16384
v_lshlrev_b32 v200, 2, v200
s_mov_b64 exec, 0xffff
buffer_store_dword v204, v200, s[20:23], s30 offen sc1
s_mov_b64 exec, -1
s_getpc_b64 s[54:55]
PC_901_2:
s_sub_u32 s54, s54, PC_901_2-k1_kernel
s_subb_u32 s55, s55, 0
s_lshr_b32 s53, s2, 3
s_lshl_b32 s53, s53, 11
s_min_u32 s53, s53, CODE_END-k1_kernel-2048
s_lshl_b32 s60, s24, 9
s_add_u32 s53, s53, s60
v_lshlrev_b32 v200, 4, v255
v_add_u32 v200, s53, v200
s_mov_b32 exec_hi, 0
global_load_dwordx4 a[252:255], v200, s[54:55]
s_mov_b64 exec, -1
s_barrier
s_add_u32 m0, s48, 0
s_nop 0
buffer_load_dwordx4 v164, s[8:11], s41 offen lds
s_add_u32 m0, s49, 0
s_nop 0
buffer_load_dwordx4 v169, s[12:15], s42 offen lds
s_add_u32 m0, s50, 0
s_nop 0
buffer_load_dwordx4 v169, s[16:19], s42 offen lds
s_add_u32 m0, s48, 1024
s_nop 0
buffer_load_dwordx4 v165, s[8:11], s41 offen lds
s_add_u32 m0, s49, 1024
s_nop 0
buffer_load_dwordx4 v170, s[12:15], s42 offen lds
s_add_u32 m0, s50, 1024
s_nop 0
buffer_load_dwordx4 v170, s[16:19], s42 offen lds
v_lshlrev_b32 v195, 7, v255
v_mov_b32 v194, 0
ds_read_b128 a[0:3], v160 offset:0
ds_read_b64_tr_b16 a[80:81], v162 offset:0
ds_read_b64_tr_b16 a[82:83], v162 offset:1024
ds_read_b64_tr_b16 a[84:85], v163 offset:0
ds_read_b64_tr_b16 a[86:87], v163 offset:1024
ds_read_b64_tr_b16 a[88:89], v162 offset:16384
ds_read_b64_tr_b16 a[90:91], v162 offset:17408
ds_read_b64_tr_b16 a[92:93], v163 offset:16384
ds_read_b64_tr_b16 a[94:95], v163 offset:17408
ds_read_b128 a[4:7], v160 offset:2048
ds_read_b128 a[8:11], v160 offset:4096
ds_read_b128 a[12:15], v160 offset:6144
ds_read_b128 a[16:19], v160 offset:8192
ds_read_b128 a[20:23], v160 offset:10240
ds_read_b128 a[24:27], v160 offset:12288
ds_read_b128 a[28:31], v160 offset:14336
ds_read_b128 a[32:35], v160 offset:16384
ds_read_b128 a[36:39], v160 offset:18432
s_cmp_eq_u32 s24, 0
s_cselect_b32 s33, 1, 99
s_waitcnt lgkmcnt(0)
s_mov_b32 s44, 0
s_mov_b32 s45, 0
s_mov_b32 s52, 4
FFN_loop:
v_mfma_f32_16x16x32_bf16 v[0:3], a[80:83], a[0:3], v[0:3]
ds_read_b128 a[40:43], v161 offset:0
v_mfma_f32_16x16x32_bf16 v[4:7], a[84:87], a[0:3], v[4:7]
ds_read_b64_tr_b16 a[96:97], v162 offset:8192
s_add_u32 s46, s45, 53248
v_mfma_f32_16x16x32_bf16 v[8:11], a[88:91], a[0:3], v[8:11]
v_mfma_f32_16x16x32_bf16 v[12:15], a[92:95], a[0:3], v[12:15]
ds_read_b64_tr_b16 a[98:99], v162 offset:9216
s_cmp_ge_u32 s46, 159744
s_cselect_b32 s47, 159744, 0
v_mfma_f32_16x16x32_bf16 v[16:19], a[80:83], a[4:7], v[16:19]
ds_read_b64_tr_b16 a[100:101], v163 offset:8192
s_add_u32 m0, s48, 2048
v_mfma_f32_16x16x32_bf16 v[20:23], a[84:87], a[4:7], v[20:23]
buffer_load_dwordx4 v166, s[8:11], s41 offen lds
v_mfma_f32_16x16x32_bf16 v[24:27], a[88:91], a[4:7], v[24:27]
ds_read_b64_tr_b16 a[102:103], v163 offset:9216
s_sub_u32 s46, s46, s47
v_mfma_f32_16x16x32_bf16 v[28:31], a[92:95], a[4:7], v[28:31]
ds_read_b64_tr_b16 a[104:105], v162 offset:24576
v_mfma_f32_16x16x32_bf16 v[32:35], a[80:83], a[8:11], v[32:35]
ds_read_b64_tr_b16 a[106:107], v162 offset:25600
s_add_u32 m0, s49, 2048
s_sub_u32 s47, s46, s45
v_mfma_f32_16x16x32_bf16 v[36:39], a[84:87], a[8:11], v[36:39]
buffer_load_dwordx4 v171, s[12:15], s42 offen lds
v_mfma_f32_16x16x32_bf16 v[40:43], a[88:91], a[8:11], v[40:43]
ds_read_b64_tr_b16 a[108:109], v163 offset:24576
s_mov_b32 s45, s46
v_mfma_f32_16x16x32_bf16 v[44:47], a[92:95], a[8:11], v[44:47]
ds_read_b64_tr_b16 a[110:111], v163 offset:25600
v_mfma_f32_16x16x32_bf16 v[48:51], a[80:83], a[12:15], v[48:51]
ds_read_b128 a[44:47], v161 offset:2048
v_mfma_f32_16x16x32_bf16 v[52:55], a[84:87], a[12:15], v[52:55]
s_add_u32 m0, s50, 2048
v_mfma_f32_16x16x32_bf16 v[56:59], a[88:91], a[12:15], v[56:59]
buffer_load_dwordx4 v171, s[16:19], s42 offen lds
ds_read_b128 a[48:51], v161 offset:4096
v_mfma_f32_16x16x32_bf16 v[60:63], a[92:95], a[12:15], v[60:63]
ds_read_b128 a[52:55], v161 offset:6144
v_mfma_f32_16x16x32_bf16 v[64:67], a[80:83], a[16:19], v[64:67]
ds_read_b128 a[56:59], v161 offset:8192
v_mfma_f32_16x16x32_bf16 v[68:71], a[84:87], a[16:19], v[68:71]
v_mfma_f32_16x16x32_bf16 v[72:75], a[88:91], a[16:19], v[72:75]
ds_read_b128 a[60:63], v161 offset:10240
s_add_u32 m0, s48, 3072
v_mfma_f32_16x16x32_bf16 v[76:79], a[92:95], a[16:19], v[76:79]
buffer_load_dwordx4 v167, s[8:11], s41 offen lds
ds_read_b128 a[64:67], v161 offset:12288
v_mfma_f32_16x16x32_bf16 v[80:83], a[80:83], a[20:23], v[80:83]
ds_read_b128 a[68:71], v161 offset:14336
v_mfma_f32_16x16x32_bf16 v[84:87], a[84:87], a[20:23], v[84:87]
v_mfma_f32_16x16x32_bf16 v[88:91], a[88:91], a[20:23], v[88:91]
ds_read_b128 a[72:75], v161 offset:16384
s_add_u32 m0, s49, 3072
v_mfma_f32_16x16x32_bf16 v[92:95], a[92:95], a[20:23], v[92:95]
buffer_load_dwordx4 v172, s[12:15], s42 offen lds
ds_read_b128 a[76:79], v161 offset:18432
v_mfma_f32_16x16x32_bf16 v[96:99], a[80:83], a[24:27], v[96:99]
v_mfma_f32_16x16x32_bf16 v[100:103], a[84:87], a[24:27], v[100:103]
v_mfma_f32_16x16x32_bf16 v[104:107], a[88:91], a[24:27], v[104:107]
v_add_u32 v160, s47, v160
v_mfma_f32_16x16x32_bf16 v[108:111], a[92:95], a[24:27], v[108:111]
s_add_u32 m0, s50, 3072
v_mfma_f32_16x16x32_bf16 v[112:115], a[80:83], a[28:31], v[112:115]
buffer_load_dwordx4 v172, s[16:19], s42 offen lds
v_mfma_f32_16x16x32_bf16 v[116:119], a[84:87], a[28:31], v[116:119]
v_mfma_f32_16x16x32_bf16 v[120:123], a[88:91], a[28:31], v[120:123]
v_add_u32 v161, s47, v161
v_mfma_f32_16x16x32_bf16 v[124:127], a[92:95], a[28:31], v[124:127]
s_add_u32 m0, s48, 4096
v_mfma_f32_16x16x32_bf16 v[128:131], a[80:83], a[32:35], v[128:131]
buffer_load_dwordx4 v168, s[8:11], s41 offen lds
v_mfma_f32_16x16x32_bf16 v[132:135], a[84:87], a[32:35], v[132:135]
v_add_u32 v162, s47, v162
v_mfma_f32_16x16x32_bf16 v[136:139], a[88:91], a[32:35], v[136:139]
v_mfma_f32_16x16x32_bf16 v[140:143], a[92:95], a[32:35], v[140:143]
s_add_u32 s39, s39, 1
s_cmp_ge_u32 s39, 10
s_cselect_b32 s39, 0, s39
v_mfma_f32_16x16x32_bf16 v[144:147], a[80:83], a[36:39], v[144:147]
s_lshl_b32 s41, s39, 7
s_mul_i32 s42, s39, 196608
v_mfma_f32_16x16x32_bf16 v[148:151], a[84:87], a[36:39], v[148:151]
v_add_u32 v163, s47, v163
s_add_u32 s40, s40, 53248
s_cmp_ge_u32 s40, 159744
s_cselect_b32 s43, 159744, 0
v_mfma_f32_16x16x32_bf16 v[152:155], a[88:91], a[36:39], v[152:155]
s_sub_u32 s40, s40, s43
s_add_u32 s48, s40, s34
v_mfma_f32_16x16x32_bf16 v[156:159], a[92:95], a[36:39], v[156:159]
s_add_u32 s49, s40, s35
s_add_u32 s50, s40, s36
s_cmp_eq_u32 s52, 0
s_cbranch_scc0 FFN_wxa
s_waitcnt vmcnt(13) lgkmcnt(0)
FFN_w0a:
s_barrier
s_cmp_eq_u32 s44, s33
s_cbranch_scc1 FFN_hook
FFN_go:
v_mfma_f32_16x16x32_bf16 v[0:3], a[96:99], a[40:43], v[0:3]
ds_read_b128 a[0:3], v160 offset:0
v_mfma_f32_16x16x32_bf16 v[4:7], a[100:103], a[40:43], v[4:7]
ds_read_b64_tr_b16 a[80:81], v162 offset:0
v_mfma_f32_16x16x32_bf16 v[8:11], a[104:107], a[40:43], v[8:11]
v_mfma_f32_16x16x32_bf16 v[12:15], a[108:111], a[40:43], v[12:15]
ds_read_b64_tr_b16 a[82:83], v162 offset:1024
v_mfma_f32_16x16x32_bf16 v[16:19], a[96:99], a[44:47], v[16:19]
ds_read_b64_tr_b16 a[84:85], v163 offset:0
s_add_u32 m0, s48, 0
v_mfma_f32_16x16x32_bf16 v[20:23], a[100:103], a[44:47], v[20:23]
buffer_load_dwordx4 v164, s[8:11], s41 offen lds
v_mfma_f32_16x16x32_bf16 v[24:27], a[104:107], a[44:47], v[24:27]
ds_read_b64_tr_b16 a[86:87], v163 offset:1024
v_mfma_f32_16x16x32_bf16 v[28:31], a[108:111], a[44:47], v[28:31]
ds_read_b64_tr_b16 a[88:89], v162 offset:16384
v_mfma_f32_16x16x32_bf16 v[32:35], a[96:99], a[48:51], v[32:35]
ds_read_b64_tr_b16 a[90:91], v162 offset:17408
v_mfma_f32_16x16x32_bf16 v[36:39], a[100:103], a[48:51], v[36:39]
v_mfma_f32_16x16x32_bf16 v[40:43], a[104:107], a[48:51], v[40:43]
ds_read_b64_tr_b16 a[92:93], v163 offset:16384
s_add_u32 m0, s49, 0
v_mfma_f32_16x16x32_bf16 v[44:47], a[108:111], a[48:51], v[44:47]
buffer_load_dwordx4 v169, s[12:15], s42 offen lds
ds_read_b64_tr_b16 a[94:95], v163 offset:17408
v_mfma_f32_16x16x32_bf16 v[48:51], a[96:99], a[52:55], v[48:51]
ds_read_b128 a[4:7], v160 offset:2048
v_mfma_f32_16x16x32_bf16 v[52:55], a[100:103], a[52:55], v[52:55]
v_mfma_f32_16x16x32_bf16 v[56:59], a[104:107], a[52:55], v[56:59]
ds_read_b128 a[8:11], v160 offset:4096
v_mfma_f32_16x16x32_bf16 v[60:63], a[108:111], a[52:55], v[60:63]
ds_read_b128 a[12:15], v160 offset:6144
s_add_u32 m0, s50, 0
v_mfma_f32_16x16x32_bf16 v[64:67], a[96:99], a[56:59], v[64:67]
buffer_load_dwordx4 v169, s[16:19], s42 offen lds
ds_read_b128 a[16:19], v160 offset:8192
v_mfma_f32_16x16x32_bf16 v[68:71], a[100:103], a[56:59], v[68:71]
v_mfma_f32_16x16x32_bf16 v[72:75], a[104:107], a[56:59], v[72:75]
ds_read_b128 a[20:23], v160 offset:10240
v_mfma_f32_16x16x32_bf16 v[76:79], a[108:111], a[56:59], v[76:79]
ds_read_b128 a[24:27], v160 offset:12288
v_mfma_f32_16x16x32_bf16 v[80:83], a[96:99], a[60:63], v[80:83]
ds_read_b128 a[28:31], v160 offset:14336
s_add_u32 m0, s48, 1024
v_mfma_f32_16x16x32_bf16 v[84:87], a[100:103], a[60:63], v[84:87]
buffer_load_dwordx4 v165, s[8:11], s41 offen lds
v_mfma_f32_16x16x32_bf16 v[88:91], a[104:107], a[60:63], v[88:91]
ds_read_b128 a[32:35], v160 offset:16384
v_mfma_f32_16x16x32_bf16 v[92:95], a[108:111], a[60:63], v[92:95]
ds_read_b128 a[36:39], v160 offset:18432
v_mfma_f32_16x16x32_bf16 v[96:99], a[96:99], a[64:67], v[96:99]
v_mfma_f32_16x16x32_bf16 v[100:103], a[100:103], a[64:67], v[100:103]
v_mfma_f32_16x16x32_bf16 v[104:107], a[104:107], a[64:67], v[104:107]
s_add_u32 m0, s49, 1024
v_mfma_f32_16x16x32_bf16 v[108:111], a[108:111], a[64:67], v[108:111]
buffer_load_dwordx4 v170, s[12:15], s42 offen lds
v_mfma_f32_16x16x32_bf16 v[112:115], a[96:99], a[68:71], v[112:115]
v_mfma_f32_16x16x32_bf16 v[116:119], a[100:103], a[68:71], v[116:119]
v_mfma_f32_16x16x32_bf16 v[120:123], a[104:107], a[68:71], v[120:123]
v_mfma_f32_16x16x32_bf16 v[124:127], a[108:111], a[68:71], v[124:127]
s_add_u32 m0, s50, 1024
v_mfma_f32_16x16x32_bf16 v[128:131], a[96:99], a[72:75], v[128:131]
buffer_load_dwordx4 v170, s[16:19], s42 offen lds
v_mfma_f32_16x16x32_bf16 v[132:135], a[100:103], a[72:75], v[132:135]
v_mfma_f32_16x16x32_bf16 v[136:139], a[104:107], a[72:75], v[136:139]
v_mfma_f32_16x16x32_bf16 v[140:143], a[108:111], a[72:75], v[140:143]
v_mfma_f32_16x16x32_bf16 v[144:147], a[96:99], a[76:79], v[144:147]
v_mfma_f32_16x16x32_bf16 v[148:151], a[100:103], a[76:79], v[148:151]
s_add_u32 s44, s44, 1
v_mfma_f32_16x16x32_bf16 v[152:155], a[104:107], a[76:79], v[152:155]
v_mfma_f32_16x16x32_bf16 v[156:159], a[108:111], a[76:79], v[156:159]
s_cmp_lt_u32 s44, 7
s_waitcnt lgkmcnt(0)
s_cbranch_scc1 FFN_loop
v_mfma_f32_16x16x32_bf16 v[0:3], a[80:83], a[0:3], v[0:3]
ds_read_b128 a[40:43], v161 offset:0
v_mfma_f32_16x16x32_bf16 v[4:7], a[84:87], a[0:3], v[4:7]
ds_read_b64_tr_b16 a[96:97], v162 offset:8192
s_add_u32 s46, s45, 53248
v_mfma_f32_16x16x32_bf16 v[8:11], a[88:91], a[0:3], v[8:11]
v_mfma_f32_16x16x32_bf16 v[12:15], a[92:95], a[0:3], v[12:15]
ds_read_b64_tr_b16 a[98:99], v162 offset:9216
s_cmp_ge_u32 s46, 159744
s_cselect_b32 s47, 159744, 0
v_mfma_f32_16x16x32_bf16 v[16:19], a[80:83], a[4:7], v[16:19]
ds_read_b64_tr_b16 a[100:101], v163 offset:8192
s_add_u32 m0, s48, 2048
v_mfma_f32_16x16x32_bf16 v[20:23], a[84:87], a[4:7], v[20:23]
buffer_load_dwordx4 v166, s[8:11], s41 offen lds
v_mfma_f32_16x16x32_bf16 v[24:27], a[88:91], a[4:7], v[24:27]
ds_read_b64_tr_b16 a[102:103], v163 offset:9216
s_sub_u32 s46, s46, s47
v_mfma_f32_16x16x32_bf16 v[28:31], a[92:95], a[4:7], v[28:31]
ds_read_b64_tr_b16 a[104:105], v162 offset:24576
v_mfma_f32_16x16x32_bf16 v[32:35], a[80:83], a[8:11], v[32:35]
ds_read_b64_tr_b16 a[106:107], v162 offset:25600
s_add_u32 m0, s49, 2048
s_sub_u32 s47, s46, s45
v_mfma_f32_16x16x32_bf16 v[36:39], a[84:87], a[8:11], v[36:39]
buffer_load_dwordx4 v171, s[12:15], s42 offen lds
v_mfma_f32_16x16x32_bf16 v[40:43], a[88:91], a[8:11], v[40:43]
ds_read_b64_tr_b16 a[108:109], v163 offset:24576
s_mov_b32 s45, s46
v_mfma_f32_16x16x32_bf16 v[44:47], a[92:95], a[8:11], v[44:47]
ds_read_b64_tr_b16 a[110:111], v163 offset:25600
v_mfma_f32_16x16x32_bf16 v[48:51], a[80:83], a[12:15], v[48:51]
ds_read_b128 a[44:47], v161 offset:2048
v_mfma_f32_16x16x32_bf16 v[52:55], a[84:87], a[12:15], v[52:55]
s_add_u32 m0, s50, 2048
v_mfma_f32_16x16x32_bf16 v[56:59], a[88:91], a[12:15], v[56:59]
buffer_load_dwordx4 v171, s[16:19], s42 offen lds
ds_read_b128 a[48:51], v161 offset:4096
v_mfma_f32_16x16x32_bf16 v[60:63], a[92:95], a[12:15], v[60:63]
ds_read_b128 a[52:55], v161 offset:6144
v_mfma_f32_16x16x32_bf16 v[64:67], a[80:83], a[16:19], v[64:67]
ds_read_b128 a[56:59], v161 offset:8192
v_mfma_f32_16x16x32_bf16 v[68:71], a[84:87], a[16:19], v[68:71]
v_mfma_f32_16x16x32_bf16 v[72:75], a[88:91], a[16:19], v[72:75]
ds_read_b128 a[60:63], v161 offset:10240
s_add_u32 m0, s48, 3072
v_mfma_f32_16x16x32_bf16 v[76:79], a[92:95], a[16:19], v[76:79]
buffer_load_dwordx4 v167, s[8:11], s41 offen lds
ds_read_b128 a[64:67], v161 offset:12288
v_mfma_f32_16x16x32_bf16 v[80:83], a[80:83], a[20:23], v[80:83]
ds_read_b128 a[68:71], v161 offset:14336
v_mfma_f32_16x16x32_bf16 v[84:87], a[84:87], a[20:23], v[84:87]
v_mfma_f32_16x16x32_bf16 v[88:91], a[88:91], a[20:23], v[88:91]
ds_read_b128 a[72:75], v161 offset:16384
s_add_u32 m0, s49, 3072
v_mfma_f32_16x16x32_bf16 v[92:95], a[92:95], a[20:23], v[92:95]
buffer_load_dwordx4 v172, s[12:15], s42 offen lds
ds_read_b128 a[76:79], v161 offset:18432
v_mfma_f32_16x16x32_bf16 v[96:99], a[80:83], a[24:27], v[96:99]
v_mfma_f32_16x16x32_bf16 v[100:103], a[84:87], a[24:27], v[100:103]
v_mfma_f32_16x16x32_bf16 v[104:107], a[88:91], a[24:27], v[104:107]
v_add_u32 v160, s47, v160
v_mfma_f32_16x16x32_bf16 v[108:111], a[92:95], a[24:27], v[108:111]
s_add_u32 m0, s50, 3072
v_mfma_f32_16x16x32_bf16 v[112:115], a[80:83], a[28:31], v[112:115]
buffer_load_dwordx4 v172, s[16:19], s42 offen lds
v_mfma_f32_16x16x32_bf16 v[116:119], a[84:87], a[28:31], v[116:119]
v_mfma_f32_16x16x32_bf16 v[120:123], a[88:91], a[28:31], v[120:123]
v_add_u32 v161, s47, v161
v_mfma_f32_16x16x32_bf16 v[124:127], a[92:95], a[28:31], v[124:127]
s_add_u32 m0, s48, 4096
v_mfma_f32_16x16x32_bf16 v[128:131], a[80:83], a[32:35], v[128:131]
buffer_load_dwordx4 v168, s[8:11], s41 offen lds
v_mfma_f32_16x16x32_bf16 v[132:135], a[84:87], a[32:35], v[132:135]
v_add_u32 v162, s47, v162
v_mfma_f32_16x16x32_bf16 v[136:139], a[88:91], a[32:35], v[136:139]
v_mfma_f32_16x16x32_bf16 v[140:143], a[92:95], a[32:35], v[140:143]
v_mfma_f32_16x16x32_bf16 v[144:147], a[80:83], a[36:39], v[144:147]
v_mfma_f32_16x16x32_bf16 v[148:151], a[84:87], a[36:39], v[148:151]
v_add_u32 v163, s47, v163
v_mfma_f32_16x16x32_bf16 v[152:155], a[88:91], a[36:39], v[152:155]
v_mfma_f32_16x16x32_bf16 v[156:159], a[92:95], a[36:39], v[156:159]
s_cmp_eq_u32 s52, 0
s_cbranch_scc0 FFN_wxb
s_waitcnt vmcnt(13) lgkmcnt(0)
FFN_w0b:
s_cmp_eq_u32 s24, 0
s_cbranch_scc1 FFN_chk
FFN_bar7:
s_barrier
v_and_b32 v194, 15, v255
v_add_u32 v194, s27, v194
v_lshlrev_b32 v194, 3, v194
v_lshrrev_b32 v195, 4, v255
v_lshlrev_b32 v195, 4, v195
s_lshl_b32 s30, s26, 7
s_lshl_b32 s31, s24, 5
s_add_u32 s30, s30, s31
s_lshl_b32 s30, s30, 2
v_add_u32 v195, s30, v195
v_mfma_f32_16x16x32_bf16 v[0:3], a[96:99], a[40:43], v[0:3]
ds_read_b128 a[0:3], v160 offset:0
v_mfma_f32_16x16x32_bf16 v[4:7], a[100:103], a[40:43], v[4:7]
ds_read_b64_tr_b16 a[80:81], v162 offset:0
v_mfma_f32_16x16x32_bf16 v[8:11], a[104:107], a[40:43], v[8:11]
v_mfma_f32_16x16x32_bf16 v[12:15], a[108:111], a[40:43], v[12:15]
ds_read_b64_tr_b16 a[82:83], v162 offset:1024
v_mfma_f32_16x16x32_bf16 v[16:19], a[96:99], a[44:47], v[16:19]
ds_read_b64_tr_b16 a[84:85], v163 offset:0
buffer_load_dwordx2 v[174:175], v194, s[20:23], 0 offen offset:0 sc1
v_mfma_f32_16x16x32_bf16 v[20:23], a[100:103], a[44:47], v[20:23]
v_mfma_f32_16x16x32_bf16 v[24:27], a[104:107], a[44:47], v[24:27]
ds_read_b64_tr_b16 a[86:87], v163 offset:1024
v_mfma_f32_16x16x32_bf16 v[28:31], a[108:111], a[44:47], v[28:31]
ds_read_b64_tr_b16 a[88:89], v162 offset:16384
v_mfma_f32_16x16x32_bf16 v[32:35], a[96:99], a[48:51], v[32:35]
ds_read_b64_tr_b16 a[90:91], v162 offset:17408
v_mfma_f32_16x16x32_bf16 v[36:39], a[100:103], a[48:51], v[36:39]
v_mfma_f32_16x16x32_bf16 v[40:43], a[104:107], a[48:51], v[40:43]
ds_read_b64_tr_b16 a[92:93], v163 offset:16384
buffer_load_dwordx2 v[176:177], v194, s[20:23], 0 offen offset:128 sc1
v_mfma_f32_16x16x32_bf16 v[44:47], a[108:111], a[48:51], v[44:47]
ds_read_b64_tr_b16 a[94:95], v163 offset:17408
v_mfma_f32_16x16x32_bf16 v[48:51], a[96:99], a[52:55], v[48:51]
ds_read_b128 a[4:7], v160 offset:2048
v_mfma_f32_16x16x32_bf16 v[52:55], a[100:103], a[52:55], v[52:55]
v_mfma_f32_16x16x32_bf16 v[56:59], a[104:107], a[52:55], v[56:59]
ds_read_b128 a[8:11], v160 offset:4096
v_mfma_f32_16x16x32_bf16 v[60:63], a[108:111], a[52:55], v[60:63]
ds_read_b128 a[12:15], v160 offset:6144
v_mfma_f32_16x16x32_bf16 v[64:67], a[96:99], a[56:59], v[64:67]
ds_read_b128 a[16:19], v160 offset:8192
buffer_load_dwordx2 v[178:179], v194, s[20:23], 0 offen offset:256 sc1
v_mfma_f32_16x16x32_bf16 v[68:71], a[100:103], a[56:59], v[68:71]
v_mfma_f32_16x16x32_bf16 v[72:75], a[104:107], a[56:59], v[72:75]
ds_read_b128 a[20:23], v160 offset:10240
v_mfma_f32_16x16x32_bf16 v[76:79], a[108:111], a[56:59], v[76:79]
ds_read_b128 a[24:27], v160 offset:12288
v_mfma_f32_16x16x32_bf16 v[80:83], a[96:99], a[60:63], v[80:83]
ds_read_b128 a[28:31], v160 offset:14336
v_mfma_f32_16x16x32_bf16 v[84:87], a[100:103], a[60:63], v[84:87]
buffer_load_dwordx2 v[180:181], v194, s[20:23], 0 offen offset:384 sc1
v_mfma_f32_16x16x32_bf16 v[88:91], a[104:107], a[60:63], v[88:91]
ds_read_b128 a[32:35], v160 offset:16384
v_mfma_f32_16x16x32_bf16 v[92:95], a[108:111], a[60:63], v[92:95]
ds_read_b128 a[36:39], v160 offset:18432
v_mfma_f32_16x16x32_bf16 v[96:99], a[96:99], a[64:67], v[96:99]
v_mfma_f32_16x16x32_bf16 v[100:103], a[100:103], a[64:67], v[100:103]
v_mfma_f32_16x16x32_bf16 v[104:107], a[104:107], a[64:67], v[104:107]
v_mfma_f32_16x16x32_bf16 v[108:111], a[108:111], a[64:67], v[108:111]
buffer_load_dwordx2 v[182:183], v194, s[20:23], 0 offen offset:512 sc1
v_mfma_f32_16x16x32_bf16 v[112:115], a[96:99], a[68:71], v[112:115]
v_mfma_f32_16x16x32_bf16 v[116:119], a[100:103], a[68:71], v[116:119]
v_mfma_f32_16x16x32_bf16 v[120:123], a[104:107], a[68:71], v[120:123]
v_mfma_f32_16x16x32_bf16 v[124:127], a[108:111], a[68:71], v[124:127]
v_mfma_f32_16x16x32_bf16 v[128:131], a[96:99], a[72:75], v[128:131]
v_mfma_f32_16x16x32_bf16 v[132:135], a[100:103], a[72:75], v[132:135]
buffer_load_dwordx2 v[184:185], v194, s[20:23], 0 offen offset:640 sc1
v_mfma_f32_16x16x32_bf16 v[136:139], a[104:107], a[72:75], v[136:139]
v_mfma_f32_16x16x32_bf16 v[140:143], a[108:111], a[72:75], v[140:143]
v_mfma_f32_16x16x32_bf16 v[144:147], a[96:99], a[76:79], v[144:147]
v_mfma_f32_16x16x32_bf16 v[148:151], a[100:103], a[76:79], v[148:151]
v_mfma_f32_16x16x32_bf16 v[152:155], a[104:107], a[76:79], v[152:155]
v_mfma_f32_16x16x32_bf16 v[156:159], a[108:111], a[76:79], v[156:159]
s_waitcnt lgkmcnt(0)
v_mfma_f32_16x16x32_bf16 v[0:3], a[80:83], a[0:3], v[0:3]
ds_read_b128 a[40:43], v161 offset:0
v_mfma_f32_16x16x32_bf16 v[4:7], a[84:87], a[0:3], v[4:7]
ds_read_b64_tr_b16 a[96:97], v162 offset:8192
s_add_u32 s46, s45, 53248
v_mfma_f32_16x16x32_bf16 v[8:11], a[88:91], a[0:3], v[8:11]
v_mfma_f32_16x16x32_bf16 v[12:15], a[92:95], a[0:3], v[12:15]
ds_read_b64_tr_b16 a[98:99], v162 offset:9216
s_cmp_ge_u32 s46, 159744
s_cselect_b32 s47, 159744, 0
v_mfma_f32_16x16x32_bf16 v[16:19], a[80:83], a[4:7], v[16:19]
ds_read_b64_tr_b16 a[100:101], v163 offset:8192
buffer_load_dwordx2 v[186:187], v194, s[20:23], 0 offen offset:768 sc1
v_mfma_f32_16x16x32_bf16 v[20:23], a[84:87], a[4:7], v[20:23]
v_mfma_f32_16x16x32_bf16 v[24:27], a[88:91], a[4:7], v[24:27]
ds_read_b64_tr_b16 a[102:103], v163 offset:9216
s_sub_u32 s46, s46, s47
v_mfma_f32_16x16x32_bf16 v[28:31], a[92:95], a[4:7], v[28:31]
ds_read_b64_tr_b16 a[104:105], v162 offset:24576
v_mfma_f32_16x16x32_bf16 v[32:35], a[80:83], a[8:11], v[32:35]
ds_read_b64_tr_b16 a[106:107], v162 offset:25600
s_sub_u32 s47, s46, s45
v_mfma_f32_16x16x32_bf16 v[36:39], a[84:87], a[8:11], v[36:39]
buffer_load_dwordx2 v[188:189], v194, s[20:23], 0 offen offset:896 sc1
v_mfma_f32_16x16x32_bf16 v[40:43], a[88:91], a[8:11], v[40:43]
ds_read_b64_tr_b16 a[108:109], v163 offset:24576
s_mov_b32 s45, s46
v_mfma_f32_16x16x32_bf16 v[44:47], a[92:95], a[8:11], v[44:47]
ds_read_b64_tr_b16 a[110:111], v163 offset:25600
v_mfma_f32_16x16x32_bf16 v[48:51], a[80:83], a[12:15], v[48:51]
ds_read_b128 a[44:47], v161 offset:2048
v_mfma_f32_16x16x32_bf16 v[52:55], a[84:87], a[12:15], v[52:55]
v_mfma_f32_16x16x32_bf16 v[56:59], a[88:91], a[12:15], v[56:59]
ds_read_b128 a[48:51], v161 offset:4096
buffer_load_dwordx2 v[190:191], v194, s[20:23], 0 offen offset:1024 sc1
v_mfma_f32_16x16x32_bf16 v[60:63], a[92:95], a[12:15], v[60:63]
ds_read_b128 a[52:55], v161 offset:6144
v_mfma_f32_16x16x32_bf16 v[64:67], a[80:83], a[16:19], v[64:67]
ds_read_b128 a[56:59], v161 offset:8192
v_mfma_f32_16x16x32_bf16 v[68:71], a[84:87], a[16:19], v[68:71]
v_mfma_f32_16x16x32_bf16 v[72:75], a[88:91], a[16:19], v[72:75]
ds_read_b128 a[60:63], v161 offset:10240
v_mfma_f32_16x16x32_bf16 v[76:79], a[92:95], a[16:19], v[76:79]
ds_read_b128 a[64:67], v161 offset:12288
buffer_load_dwordx2 v[192:193], v194, s[20:23], 0 offen offset:1152 sc1
v_mfma_f32_16x16x32_bf16 v[80:83], a[80:83], a[20:23], v[80:83]
ds_read_b128 a[68:71], v161 offset:14336
v_mfma_f32_16x16x32_bf16 v[84:87], a[84:87], a[20:23], v[84:87]
v_mfma_f32_16x16x32_bf16 v[88:91], a[88:91], a[20:23], v[88:91]
ds_read_b128 a[72:75], v161 offset:16384
s_mov_b32 s31, 24064
v_mfma_f32_16x16x32_bf16 v[92:95], a[92:95], a[20:23], v[92:95]
ds_read_b128 a[76:79], v161 offset:18432
buffer_load_dwordx4 a[112:115], v195, s[20:23], s31 offen sc1
v_mfma_f32_16x16x32_bf16 v[96:99], a[80:83], a[24:27], v[96:99]
v_mfma_f32_16x16x32_bf16 v[100:103], a[84:87], a[24:27], v[100:103]
v_mfma_f32_16x16x32_bf16 v[104:107], a[88:91], a[24:27], v[104:107]
v_add_u32 v160, s47, v160
v_mfma_f32_16x16x32_bf16 v[108:111], a[92:95], a[24:27], v[108:111]
s_mov_b32 s31, 24128
v_mfma_f32_16x16x32_bf16 v[112:115], a[80:83], a[28:31], v[112:115]
buffer_load_dwordx4 a[116:119], v195, s[20:23], s31 offen sc1
v_mfma_f32_16x16x32_bf16 v[116:119], a[84:87], a[28:31], v[116:119]
v_mfma_f32_16x16x32_bf16 v[120:123], a[88:91], a[28:31], v[120:123]
v_add_u32 v161, s47, v161
v_mfma_f32_16x16x32_bf16 v[124:127], a[92:95], a[28:31], v[124:127]
v_mfma_f32_16x16x32_bf16 v[128:131], a[80:83], a[32:35], v[128:131]
s_mov_b32 s31, 30208
v_mfma_f32_16x16x32_bf16 v[132:135], a[84:87], a[32:35], v[132:135]
buffer_load_dwordx4 a[120:123], v195, s[20:23], s31 offen sc1
v_add_u32 v162, s47, v162
v_mfma_f32_16x16x32_bf16 v[136:139], a[88:91], a[32:35], v[136:139]
v_mfma_f32_16x16x32_bf16 v[140:143], a[92:95], a[32:35], v[140:143]
v_mfma_f32_16x16x32_bf16 v[144:147], a[80:83], a[36:39], v[144:147]
v_mfma_f32_16x16x32_bf16 v[148:151], a[84:87], a[36:39], v[148:151]
v_add_u32 v163, s47, v163
v_mfma_f32_16x16x32_bf16 v[152:155], a[88:91], a[36:39], v[152:155]
v_mfma_f32_16x16x32_bf16 v[156:159], a[92:95], a[36:39], v[156:159]
s_waitcnt vmcnt(13) lgkmcnt(0)
s_barrier
v_mfma_f32_16x16x32_bf16 v[0:3], a[96:99], a[40:43], v[0:3]
ds_read_b128 a[0:3], v160 offset:0
v_mfma_f32_16x16x32_bf16 v[4:7], a[100:103], a[40:43], v[4:7]
ds_read_b64_tr_b16 a[80:81], v162 offset:0
v_mfma_f32_16x16x32_bf16 v[8:11], a[104:107], a[40:43], v[8:11]
v_mfma_f32_16x16x32_bf16 v[12:15], a[108:111], a[40:43], v[12:15]
ds_read_b64_tr_b16 a[82:83], v162 offset:1024
v_mfma_f32_16x16x32_bf16 v[16:19], a[96:99], a[44:47], v[16:19]
ds_read_b64_tr_b16 a[84:85], v163 offset:0
s_mov_b32 s31, 30272
v_mfma_f32_16x16x32_bf16 v[20:23], a[100:103], a[44:47], v[20:23]
buffer_load_dwordx4 a[124:127], v195, s[20:23], s31 offen sc1
v_mfma_f32_16x16x32_bf16 v[24:27], a[104:107], a[44:47], v[24:27]
ds_read_b64_tr_b16 a[86:87], v163 offset:1024
v_mfma_f32_16x16x32_bf16 v[28:31], a[108:111], a[44:47], v[28:31]
ds_read_b64_tr_b16 a[88:89], v162 offset:16384
v_mfma_f32_16x16x32_bf16 v[32:35], a[96:99], a[48:51], v[32:35]
ds_read_b64_tr_b16 a[90:91], v162 offset:17408
v_mfma_f32_16x16x32_bf16 v[36:39], a[100:103], a[48:51], v[36:39]
v_mfma_f32_16x16x32_bf16 v[40:43], a[104:107], a[48:51], v[40:43]
ds_read_b64_tr_b16 a[92:93], v163 offset:16384
v_mfma_f32_16x16x32_bf16 v[44:47], a[108:111], a[48:51], v[44:47]
ds_read_b64_tr_b16 a[94:95], v163 offset:17408
s_mov_b32 s31, 44032
v_mfma_f32_16x16x32_bf16 v[48:51], a[96:99], a[52:55], v[48:51]
ds_read_b128 a[4:7], v160 offset:2048
buffer_load_dwordx4 a[128:131], v195, s[20:23], s31 offen sc1
v_mfma_f32_16x16x32_bf16 v[52:55], a[100:103], a[52:55], v[52:55]
v_mfma_f32_16x16x32_bf16 v[56:59], a[104:107], a[52:55], v[56:59]
ds_read_b128 a[8:11], v160 offset:4096
v_mfma_f32_16x16x32_bf16 v[60:63], a[108:111], a[52:55], v[60:63]
ds_read_b128 a[12:15], v160 offset:6144
v_mfma_f32_16x16x32_bf16 v[64:67], a[96:99], a[56:59], v[64:67]
ds_read_b128 a[16:19], v160 offset:8192
v_mfma_f32_16x16x32_bf16 v[68:71], a[100:103], a[56:59], v[68:71]
v_mfma_f32_16x16x32_bf16 v[72:75], a[104:107], a[56:59], v[72:75]
ds_read_b128 a[20:23], v160 offset:10240
s_mov_b32 s31, 44096
v_mfma_f32_16x16x32_bf16 v[76:79], a[108:111], a[56:59], v[76:79]
ds_read_b128 a[24:27], v160 offset:12288
buffer_load_dwordx4 a[132:135], v195, s[20:23], s31 offen sc1
v_mfma_f32_16x16x32_bf16 v[80:83], a[96:99], a[60:63], v[80:83]
ds_read_b128 a[28:31], v160 offset:14336
v_mfma_f32_16x16x32_bf16 v[84:87], a[100:103], a[60:63], v[84:87]
v_mfma_f32_16x16x32_bf16 v[88:91], a[104:107], a[60:63], v[88:91]
ds_read_b128 a[32:35], v160 offset:16384
v_mfma_f32_16x16x32_bf16 v[92:95], a[108:111], a[60:63], v[92:95]
ds_read_b128 a[36:39], v160 offset:18432
v_mfma_f32_16x16x32_bf16 v[96:99], a[96:99], a[64:67], v[96:99]
s_mov_b32 s31, 50176
v_mfma_f32_16x16x32_bf16 v[100:103], a[100:103], a[64:67], v[100:103]
buffer_load_dwordx4 a[136:139], v195, s[20:23], s31 offen sc1
v_mfma_f32_16x16x32_bf16 v[104:107], a[104:107], a[64:67], v[104:107]
v_mfma_f32_16x16x32_bf16 v[108:111], a[108:111], a[64:67], v[108:111]
v_mfma_f32_16x16x32_bf16 v[112:115], a[96:99], a[68:71], v[112:115]
v_mfma_f32_16x16x32_bf16 v[116:119], a[100:103], a[68:71], v[116:119]
v_mfma_f32_16x16x32_bf16 v[120:123], a[104:107], a[68:71], v[120:123]
v_mfma_f32_16x16x32_bf16 v[124:127], a[108:111], a[68:71], v[124:127]
s_mov_b32 s31, 50240
v_mfma_f32_16x16x32_bf16 v[128:131], a[96:99], a[72:75], v[128:131]
buffer_load_dwordx4 a[140:143], v195, s[20:23], s31 offen sc1
v_mfma_f32_16x16x32_bf16 v[132:135], a[100:103], a[72:75], v[132:135]
v_mfma_f32_16x16x32_bf16 v[136:139], a[104:107], a[72:75], v[136:139]
v_mfma_f32_16x16x32_bf16 v[140:143], a[108:111], a[72:75], v[140:143]
v_mfma_f32_16x16x32_bf16 v[144:147], a[96:99], a[76:79], v[144:147]
v_mfma_f32_16x16x32_bf16 v[148:151], a[100:103], a[76:79], v[148:151]
v_mfma_f32_16x16x32_bf16 v[152:155], a[104:107], a[76:79], v[152:155]
v_mfma_f32_16x16x32_bf16 v[156:159], a[108:111], a[76:79], v[156:159]
s_waitcnt lgkmcnt(0)
v_mfma_f32_16x16x32_bf16 v[0:3], a[80:83], a[0:3], v[0:3]
ds_read_b128 a[40:43], v161 offset:0
v_mfma_f32_16x16x32_bf16 v[4:7], a[84:87], a[0:3], v[4:7]
ds_read_b64_tr_b16 a[96:97], v162 offset:8192
s_add_u32 s46, s45, 53248
v_mfma_f32_16x16x32_bf16 v[8:11], a[88:91], a[0:3], v[8:11]
v_mfma_f32_16x16x32_bf16 v[12:15], a[92:95], a[0:3], v[12:15]
ds_read_b64_tr_b16 a[98:99], v162 offset:9216
s_cmp_ge_u32 s46, 159744
s_cselect_b32 s47, 159744, 0
v_mfma_f32_16x16x32_bf16 v[16:19], a[80:83], a[4:7], v[16:19]
ds_read_b64_tr_b16 a[100:101], v163 offset:8192
v_mfma_f32_16x16x32_bf16 v[20:23], a[84:87], a[4:7], v[20:23]
v_mfma_f32_16x16x32_bf16 v[24:27], a[88:91], a[4:7], v[24:27]
ds_read_b64_tr_b16 a[102:103], v163 offset:9216
s_sub_u32 s46, s46, s47
v_mfma_f32_16x16x32_bf16 v[28:31], a[92:95], a[4:7], v[28:31]
ds_read_b64_tr_b16 a[104:105], v162 offset:24576
v_mfma_f32_16x16x32_bf16 v[32:35], a[80:83], a[8:11], v[32:35]
ds_read_b64_tr_b16 a[106:107], v162 offset:25600
s_sub_u32 s47, s46, s45
v_mfma_f32_16x16x32_bf16 v[36:39], a[84:87], a[8:11], v[36:39]
v_mfma_f32_16x16x32_bf16 v[40:43], a[88:91], a[8:11], v[40:43]
ds_read_b64_tr_b16 a[108:109], v163 offset:24576
s_mov_b32 s45, s46
v_mfma_f32_16x16x32_bf16 v[44:47], a[92:95], a[8:11], v[44:47]
ds_read_b64_tr_b16 a[110:111], v163 offset:25600
v_mfma_f32_16x16x32_bf16 v[48:51], a[80:83], a[12:15], v[48:51]
ds_read_b128 a[44:47], v161 offset:2048
v_mfma_f32_16x16x32_bf16 v[52:55], a[84:87], a[12:15], v[52:55]
v_mfma_f32_16x16x32_bf16 v[56:59], a[88:91], a[12:15], v[56:59]
ds_read_b128 a[48:51], v161 offset:4096
v_mfma_f32_16x16x32_bf16 v[60:63], a[92:95], a[12:15], v[60:63]
ds_read_b128 a[52:55], v161 offset:6144
v_mfma_f32_16x16x32_bf16 v[64:67], a[80:83], a[16:19], v[64:67]
ds_read_b128 a[56:59], v161 offset:8192
v_mfma_f32_16x16x32_bf16 v[68:71], a[84:87], a[16:19], v[68:71]
v_mfma_f32_16x16x32_bf16 v[72:75], a[88:91], a[16:19], v[72:75]
ds_read_b128 a[60:63], v161 offset:10240
v_mfma_f32_16x16x32_bf16 v[76:79], a[92:95], a[16:19], v[76:79]
ds_read_b128 a[64:67], v161 offset:12288
v_mfma_f32_16x16x32_bf16 v[80:83], a[80:83], a[20:23], v[80:83]
ds_read_b128 a[68:71], v161 offset:14336
v_mfma_f32_16x16x32_bf16 v[84:87], a[84:87], a[20:23], v[84:87]
v_mfma_f32_16x16x32_bf16 v[88:91], a[88:91], a[20:23], v[88:91]
ds_read_b128 a[72:75], v161 offset:16384
v_mfma_f32_16x16x32_bf16 v[92:95], a[92:95], a[20:23], v[92:95]
ds_read_b128 a[76:79], v161 offset:18432
v_mfma_f32_16x16x32_bf16 v[96:99], a[80:83], a[24:27], v[96:99]
v_mfma_f32_16x16x32_bf16 v[100:103], a[84:87], a[24:27], v[100:103]
v_mfma_f32_16x16x32_bf16 v[104:107], a[88:91], a[24:27], v[104:107]
v_add_u32 v160, s47, v160
v_mfma_f32_16x16x32_bf16 v[108:111], a[92:95], a[24:27], v[108:111]
v_mfma_f32_16x16x32_bf16 v[112:115], a[80:83], a[28:31], v[112:115]
v_mfma_f32_16x16x32_bf16 v[116:119], a[84:87], a[28:31], v[116:119]
v_mfma_f32_16x16x32_bf16 v[120:123], a[88:91], a[28:31], v[120:123]
v_add_u32 v161, s47, v161
v_mfma_f32_16x16x32_bf16 v[124:127], a[92:95], a[28:31], v[124:127]
v_mfma_f32_16x16x32_bf16 v[128:131], a[80:83], a[32:35], v[128:131]
v_mfma_f32_16x16x32_bf16 v[132:135], a[84:87], a[32:35], v[132:135]
v_add_u32 v162, s47, v162
v_mfma_f32_16x16x32_bf16 v[136:139], a[88:91], a[32:35], v[136:139]
v_mfma_f32_16x16x32_bf16 v[140:143], a[92:95], a[32:35], v[140:143]
v_mfma_f32_16x16x32_bf16 v[144:147], a[80:83], a[36:39], v[144:147]
v_mfma_f32_16x16x32_bf16 v[148:151], a[84:87], a[36:39], v[148:151]
v_add_u32 v163, s47, v163
v_mfma_f32_16x16x32_bf16 v[152:155], a[88:91], a[36:39], v[152:155]
v_mfma_f32_16x16x32_bf16 v[156:159], a[92:95], a[36:39], v[156:159]
s_waitcnt lgkmcnt(0)
v_mfma_f32_16x16x32_bf16 v[0:3], a[96:99], a[40:43], v[0:3]
v_mfma_f32_16x16x32_bf16 v[4:7], a[100:103], a[40:43], v[4:7]
v_mfma_f32_16x16x32_bf16 v[8:11], a[104:107], a[40:43], v[8:11]
v_mfma_f32_16x16x32_bf16 v[12:15], a[108:111], a[40:43], v[12:15]
v_mfma_f32_16x16x32_bf16 v[16:19], a[96:99], a[44:47], v[16:19]
v_mfma_f32_16x16x32_bf16 v[20:23], a[100:103], a[44:47], v[20:23]
v_mfma_f32_16x16x32_bf16 v[24:27], a[104:107], a[44:47], v[24:27]
v_mfma_f32_16x16x32_bf16 v[28:31], a[108:111], a[44:47], v[28:31]
v_mfma_f32_16x16x32_bf16 v[32:35], a[96:99], a[48:51], v[32:35]
v_mfma_f32_16x16x32_bf16 v[36:39], a[100:103], a[48:51], v[36:39]
v_mfma_f32_16x16x32_bf16 v[40:43], a[104:107], a[48:51], v[40:43]
v_mfma_f32_16x16x32_bf16 v[44:47], a[108:111], a[48:51], v[44:47]
v_mfma_f32_16x16x32_bf16 v[48:51], a[96:99], a[52:55], v[48:51]
v_mfma_f32_16x16x32_bf16 v[52:55], a[100:103], a[52:55], v[52:55]
v_mfma_f32_16x16x32_bf16 v[56:59], a[104:107], a[52:55], v[56:59]
v_mfma_f32_16x16x32_bf16 v[60:63], a[108:111], a[52:55], v[60:63]
v_mfma_f32_16x16x32_bf16 v[64:67], a[96:99], a[56:59], v[64:67]
v_mfma_f32_16x16x32_bf16 v[68:71], a[100:103], a[56:59], v[68:71]
v_mfma_f32_16x16x32_bf16 v[72:75], a[104:107], a[56:59], v[72:75]
v_mfma_f32_16x16x32_bf16 v[76:79], a[108:111], a[56:59], v[76:79]
v_mfma_f32_16x16x32_bf16 v[80:83], a[96:99], a[60:63], v[80:83]
v_mfma_f32_16x16x32_bf16 v[84:87], a[100:103], a[60:63], v[84:87]
v_mfma_f32_16x16x32_bf16 v[88:91], a[104:107], a[60:63], v[88:91]
v_mfma_f32_16x16x32_bf16 v[92:95], a[108:111], a[60:63], v[92:95]
v_mfma_f32_16x16x32_bf16 v[96:99], a[96:99], a[64:67], v[96:99]
v_mfma_f32_16x16x32_bf16 v[100:103], a[100:103], a[64:67], v[100:103]
v_mfma_f32_16x16x32_bf16 v[104:107], a[104:107], a[64:67], v[104:107]
v_mfma_f32_16x16x32_bf16 v[108:111], a[108:111], a[64:67], v[108:111]
v_mfma_f32_16x16x32_bf16 v[112:115], a[96:99], a[68:71], v[112:115]
v_mfma_f32_16x16x32_bf16 v[116:119], a[100:103], a[68:71], v[116:119]
v_mfma_f32_16x16x32_bf16 v[120:123], a[104:107], a[68:71], v[120:123]
v_mfma_f32_16x16x32_bf16 v[124:127], a[108:111], a[68:71], v[124:127]
v_mfma_f32_16x16x32_bf16 v[128:131], a[96:99], a[72:75], v[128:131]
v_mfma_f32_16x16x32_bf16 v[132:135], a[100:103], a[72:75], v[132:135]
v_mfma_f32_16x16x32_bf16 v[136:139], a[104:107], a[72:75], v[136:139]
v_mfma_f32_16x16x32_bf16 v[140:143], a[108:111], a[72:75], v[140:143]
v_mfma_f32_16x16x32_bf16 v[144:147], a[96:99], a[76:79], v[144:147]
v_mfma_f32_16x16x32_bf16 v[148:151], a[100:103], a[76:79], v[148:151]
v_mfma_f32_16x16x32_bf16 v[152:155], a[104:107], a[76:79], v[152:155]
v_mfma_f32_16x16x32_bf16 v[156:159], a[108:111], a[76:79], v[156:159]
s_branch FFN_done
FFN_wxa:
s_cmp_eq_u32 s52, 1
s_cbranch_scc0 FFN_x_901_3
s_waitcnt vmcnt(14) lgkmcnt(0)
s_mov_b32 s52, 0
s_branch FFN_w0a
FFN_x_901_3:
s_cmp_eq_u32 s52, 4
s_cbranch_scc0 FFN_x_901_4
s_waitcnt vmcnt(17) lgkmcnt(0)
s_mov_b32 s52, 0
s_branch FFN_w0a
FFN_x_901_4:
s_waitcnt vmcnt(13) lgkmcnt(0)
s_mov_b32 s52, 0
s_branch FFN_w0a
FFN_wxb:
s_cmp_eq_u32 s52, 1
s_cbranch_scc0 FFN_x_901_5
s_waitcnt vmcnt(14) lgkmcnt(0)
s_mov_b32 s52, 0
s_branch FFN_w0b
FFN_x_901_5:
s_waitcnt vmcnt(13) lgkmcnt(0)
s_mov_b32 s52, 0
s_branch FFN_w0b
FFN_chk:
s_mov_b32 s53, 0
FFN_chk2:
s_mov_b64 exec, 3
v_cmp_ne_u32 vcc, 78, v194
s_mov_b64 exec, -1
s_nop 1
s_cbranch_vccz FFN_bar7
s_add_u32 s53, s53, 1
s_cmp_ge_u32 s53, 0x40000
s_cbranch_scc1 FFN_bar7
s_sleep 8
s_mov_b64 exec, 3
buffer_load_dword v194, v195, s[56:59], 0 offen sc1
s_mov_b64 exec, -1
s_waitcnt vmcnt(0)
s_branch FFN_chk2
FFN_hook:
s_cmp_eq_u32 s44, 1
s_cbranch_scc0 FFN_poll
s_and_b32 s53, s37, 1
s_lshl_b32 s53, s53, 7
v_mov_b32 v195, s53
v_mov_b32 v194, 1
s_mov_b64 exec, 1
buffer_atomic_add v194, v195, s[56:59], 0 offen
s_mov_b64 exec, -1
s_mov_b32 s33, 5
s_mov_b32 s52, 1
s_branch FFN_go
FFN_poll:
v_lshlrev_b32 v195, 7, v255
s_mov_b64 exec, 3
buffer_load_dword v194, v195, s[56:59], 0 offen sc1
s_mov_b64 exec, -1
s_mov_b32 s33, 99
s_mov_b32 s52, 1
s_branch FFN_go
FFN_done:
s_nop 7
s_waitcnt vmcnt(0)
s_barrier
s_load_dwordx2 s[4:5], s[0:1], 56
s_load_dwordx2 s[6:7], s[0:1], 24
v_lshrrev_b32 v196, 3, v255
v_mul_u32_u24 v196, 1280, v196
v_and_b32 v197, 7, v255
v_lshlrev_b32 v197, 4, v197
v_add_u32 v196, v196, v197
s_waitcnt lgkmcnt(0)
s_lshl_b32 s68, s37, 2
s_add_u32 s68, s68, s24
s_mul_hi_u32 s69, s68, 429496730
s_mul_i32 s70, s69, 10
s_sub_u32 s70, s68, s70
s_mov_b32 s64, s4
s_and_b32 s65, s5, 0xffff
s_mov_b32 s66, 1966080
s_mov_b32 s67, 0x20000
s_mov_b32 s30, s69
s_cmp_ge_u32 s69, 48
s_cbranch_scc0 FFN_ws_901_6
s_mov_b32 s64, s6
s_and_b32 s65, s7, 0xffff
s_mov_b32 s66, 819200
s_sub_u32 s30, s69, 48
FFN_ws_901_6:
s_cmp_ge_u32 s68, 680
s_cselect_b32 s66, 0, s66
s_mul_i32 s30, s30, 40960
s_lshl_b32 s31, s70, 7
s_add_u32 s30, s30, s31
s_lshl_b32 s31, s24, 13
s_add_u32 s31, s31, 0
s_add_u32 m0, s31, 0
s_nop 0
buffer_load_dwordx4 v196, s[64:67], s30 offen lds
s_add_u32 s30, s30, 10240
s_add_u32 m0, s31, 1024
s_nop 0
buffer_load_dwordx4 v196, s[64:67], s30 offen lds
s_add_u32 s30, s30, 10240
s_add_u32 m0, s31, 2048
s_nop 0
buffer_load_dwordx4 v196, s[64:67], s30 offen lds
s_add_u32 s30, s30, 10240
s_add_u32 m0, s31, 3072
s_nop 0
buffer_load_dwordx4 v196, s[64:67], s30 offen lds
v_accvgpr_read_b32 v224, a112
v_accvgpr_read_b32 v225, a113
v_accvgpr_read_b32 v226, a114
v_accvgpr_read_b32 v227, a115
v_accvgpr_read_b32 v228, a116
v_accvgpr_read_b32 v229, a117
v_accvgpr_read_b32 v230, a118
v_accvgpr_read_b32 v231, a119
v_accvgpr_read_b32 v232, a120
v_accvgpr_read_b32 v233, a121
v_accvgpr_read_b32 v234, a122
v_accvgpr_read_b32 v235, a123
v_accvgpr_read_b32 v236, a124
v_accvgpr_read_b32 v237, a125
v_accvgpr_read_b32 v238, a126
v_accvgpr_read_b32 v239, a127
v_accvgpr_read_b32 v196, a128
v_accvgpr_read_b32 v197, a129
v_accvgpr_read_b32 v198, a130
v_accvgpr_read_b32 v199, a131
v_accvgpr_read_b32 v200, a132
v_accvgpr_read_b32 v201, a133
v_accvgpr_read_b32 v202, a134
v_accvgpr_read_b32 v203, a135
v_accvgpr_read_b32 v204, a136
v_accvgpr_read_b32 v205, a137
v_accvgpr_read_b32 v206, a138
v_accvgpr_read_b32 v207, a139
v_accvgpr_read_b32 v208, a140
v_accvgpr_read_b32 v209, a141
v_accvgpr_read_b32 v210, a142
v_accvgpr_read_b32 v211, a143
v_pk_add_f32 v[224:225], v[224:225], v[196:197]
v_pk_add_f32 v[226:227], v[226:227], v[198:199]
v_pk_add_f32 v[228:229], v[228:229], v[200:201]
v_pk_add_f32 v[230:231], v[230:231], v[202:203]
v_pk_add_f32 v[232:233], v[232:233], v[204:205]
v_pk_add_f32 v[234:235], v[234:235], v[206:207]
v_pk_add_f32 v[236:237], v[236:237], v[208:209]
v_pk_add_f32 v[238:239], v[238:239], v[210:211]
v_lshlrev_b32 v240, 4, v255
v_sub_f32 v196, 0, v174
v_sub_f32 v210, 0, v176
v_mul_f32 v198, -1.4426950408889634, v175
v_mul_f32 v212, -1.4426950408889634, v177
v_mul_f32 v200, v175, v175
v_mul_f32 v214, v177, v177
v_rcp_f32 v200, v200
v_rcp_f32 v214, v214
v_pk_fma_f32 v[0:1], v[224:225], v[196:197], v[0:1] op_sel_hi:[1,0,1]
v_pk_fma_f32 v[16:17], v[224:225], v[210:211], v[16:17] op_sel_hi:[1,0,1]
v_pk_fma_f32 v[2:3], v[226:227], v[196:197], v[2:3] op_sel_hi:[1,0,1]
v_pk_fma_f32 v[18:19], v[226:227], v[210:211], v[18:19] op_sel_hi:[1,0,1]
v_pk_fma_f32 v[4:5], v[228:229], v[196:197], v[4:5] op_sel_hi:[1,0,1]
v_pk_fma_f32 v[20:21], v[228:229], v[210:211], v[20:21] op_sel_hi:[1,0,1]
v_pk_fma_f32 v[6:7], v[230:231], v[196:197], v[6:7] op_sel_hi:[1,0,1]
v_pk_fma_f32 v[22:23], v[230:231], v[210:211], v[22:23] op_sel_hi:[1,0,1]
v_pk_fma_f32 v[8:9], v[232:233], v[196:197], v[8:9] op_sel_hi:[1,0,1]
v_pk_fma_f32 v[24:25], v[232:233], v[210:211], v[24:25] op_sel_hi:[1,0,1]
v_pk_fma_f32 v[10:11], v[234:235], v[196:197], v[10:11] op_sel_hi:[1,0,1]
v_pk_fma_f32 v[26:27], v[234:235], v[210:211], v[26:27] op_sel_hi:[1,0,1]
v_pk_fma_f32 v[12:13], v[236:237], v[196:197], v[12:13] op_sel_hi:[1,0,1]
v_pk_fma_f32 v[28:29], v[236:237], v[210:211], v[28:29] op_sel_hi:[1,0,1]
v_pk_fma_f32 v[14:15], v[238:239], v[196:197], v[14:15] op_sel_hi:[1,0,1]
v_pk_fma_f32 v[30:31], v[238:239], v[210:211], v[30:31] op_sel_hi:[1,0,1]
v_pk_mul_f32 v[202:203], v[0:1], v[198:199] op_sel_hi:[1,0]
v_pk_mul_f32 v[216:217], v[16:17], v[212:213] op_sel_hi:[1,0]
v_pk_mul_f32 v[204:205], v[2:3], v[198:199] op_sel_hi:[1,0]
v_pk_mul_f32 v[218:219], v[18:19], v[212:213] op_sel_hi:[1,0]
v_pk_mul_f32 v[206:207], v[4:5], v[198:199] op_sel_hi:[1,0]
v_pk_mul_f32 v[220:221], v[20:21], v[212:213] op_sel_hi:[1,0]
v_pk_mul_f32 v[208:209], v[6:7], v[198:199] op_sel_hi:[1,0]
v_pk_mul_f32 v[222:223], v[22:23], v[212:213] op_sel_hi:[1,0]
v_exp_f32 v202, v202
v_exp_f32 v216, v216
v_exp_f32 v203, v203
v_exp_f32 v217, v217
v_exp_f32 v204, v204
v_exp_f32 v218, v218
v_exp_f32 v205, v205
v_exp_f32 v219, v219
v_exp_f32 v206, v206
v_exp_f32 v220, v220
v_exp_f32 v207, v207
v_exp_f32 v221, v221
v_exp_f32 v208, v208
v_exp_f32 v222, v222
v_exp_f32 v209, v209
v_exp_f32 v223, v223
v_pk_mul_f32 v[0:1], v[0:1], v[8:9]
v_pk_mul_f32 v[16:17], v[16:17], v[24:25]
v_pk_mul_f32 v[2:3], v[2:3], v[10:11]
v_pk_mul_f32 v[18:19], v[18:19], v[26:27]
v_pk_mul_f32 v[4:5], v[4:5], v[12:13]
v_pk_mul_f32 v[20:21], v[20:21], v[28:29]
v_pk_mul_f32 v[6:7], v[6:7], v[14:15]
v_pk_mul_f32 v[22:23], v[22:23], v[30:31]
v_pk_fma_f32 v[202:203], v[202:203], v[200:201], v[200:201] op_sel_hi:[1,0,0]
v_pk_fma_f32 v[216:217], v[216:217], v[214:215], v[214:215] op_sel_hi:[1,0,0]
v_pk_fma_f32 v[204:205], v[204:205], v[200:201], v[200:201] op_sel_hi:[1,0,0]
v_pk_fma_f32 v[218:219], v[218:219], v[214:215], v[214:215] op_sel_hi:[1,0,0]
v_pk_fma_f32 v[206:207], v[206:207], v[200:201], v[200:201] op_sel_hi:[1,0,0]
v_pk_fma_f32 v[220:221], v[220:221], v[214:215], v[214:215] op_sel_hi:[1,0,0]
v_pk_fma_f32 v[208:209], v[208:209], v[200:201], v[200:201] op_sel_hi:[1,0,0]
v_pk_fma_f32 v[222:223], v[222:223], v[214:215], v[214:215] op_sel_hi:[1,0,0]
v_rcp_f32 v202, v202
v_rcp_f32 v216, v216
v_rcp_f32 v203, v203
v_rcp_f32 v217, v217
v_rcp_f32 v204, v204
v_rcp_f32 v218, v218
v_rcp_f32 v205, v205
v_rcp_f32 v219, v219
v_rcp_f32 v206, v206
v_rcp_f32 v220, v220
v_rcp_f32 v207, v207
v_rcp_f32 v221, v221
v_rcp_f32 v208, v208
v_rcp_f32 v222, v222
v_rcp_f32 v209, v209
v_rcp_f32 v223, v223
v_pk_mul_f32 v[0:1], v[0:1], v[202:203]
v_pk_mul_f32 v[16:17], v[16:17], v[216:217]
v_pk_mul_f32 v[2:3], v[2:3], v[204:205]
v_pk_mul_f32 v[18:19], v[18:19], v[218:219]
v_pk_mul_f32 v[4:5], v[4:5], v[206:207]
v_pk_mul_f32 v[20:21], v[20:21], v[220:221]
v_pk_mul_f32 v[6:7], v[6:7], v[208:209]
v_pk_mul_f32 v[22:23], v[22:23], v[222:223]
v_cvt_pk_bf16_f32 v8, v0, v1
v_cvt_pk_bf16_f32 v24, v16, v17
v_cvt_pk_bf16_f32 v9, v2, v3
v_cvt_pk_bf16_f32 v25, v18, v19
v_cvt_pk_bf16_f32 v10, v4, v5
v_cvt_pk_bf16_f32 v26, v20, v21
v_cvt_pk_bf16_f32 v11, v6, v7
v_cvt_pk_bf16_f32 v27, v22, v23
buffer_store_dwordx4 v[8:11], v240, s[20:23], s80 offen sc1
buffer_store_dwordx4 v[24:27], v240, s[20:23], s81 offen sc1
v_sub_f32 v196, 0, v178
v_sub_f32 v210, 0, v180
v_mul_f32 v198, -1.4426950408889634, v179
v_mul_f32 v212, -1.4426950408889634, v181
v_mul_f32 v200, v179, v179
v_mul_f32 v214, v181, v181
v_rcp_f32 v200, v200
v_rcp_f32 v214, v214
v_pk_fma_f32 v[32:33], v[224:225], v[196:197], v[32:33] op_sel_hi:[1,0,1]
v_pk_fma_f32 v[48:49], v[224:225], v[210:211], v[48:49] op_sel_hi:[1,0,1]
v_pk_fma_f32 v[34:35], v[226:227], v[196:197], v[34:35] op_sel_hi:[1,0,1]
v_pk_fma_f32 v[50:51], v[226:227], v[210:211], v[50:51] op_sel_hi:[1,0,1]
v_pk_fma_f32 v[36:37], v[228:229], v[196:197], v[36:37] op_sel_hi:[1,0,1]
v_pk_fma_f32 v[52:53], v[228:229], v[210:211], v[52:53] op_sel_hi:[1,0,1]
v_pk_fma_f32 v[38:39], v[230:231], v[196:197], v[38:39] op_sel_hi:[1,0,1]
v_pk_fma_f32 v[54:55], v[230:231], v[210:211], v[54:55] op_sel_hi:[1,0,1]
v_pk_fma_f32 v[40:41], v[232:233], v[196:197], v[40:41] op_sel_hi:[1,0,1]
v_pk_fma_f32 v[56:57], v[232:233], v[210:211], v[56:57] op_sel_hi:[1,0,1]
v_pk_fma_f32 v[42:43], v[234:235], v[196:197], v[42:43] op_sel_hi:[1,0,1]
v_pk_fma_f32 v[58:59], v[234:235], v[210:211], v[58:59] op_sel_hi:[1,0,1]
v_pk_fma_f32 v[44:45], v[236:237], v[196:197], v[44:45] op_sel_hi:[1,0,1]
v_pk_fma_f32 v[60:61], v[236:237], v[210:211], v[60:61] op_sel_hi:[1,0,1]
v_pk_fma_f32 v[46:47], v[238:239], v[196:197], v[46:47] op_sel_hi:[1,0,1]
v_pk_fma_f32 v[62:63], v[238:239], v[210:211], v[62:63] op_sel_hi:[1,0,1]
v_pk_mul_f32 v[202:203], v[32:33], v[198:199] op_sel_hi:[1,0]
v_pk_mul_f32 v[216:217], v[48:49], v[212:213] op_sel_hi:[1,0]
v_pk_mul_f32 v[204:205], v[34:35], v[198:199] op_sel_hi:[1,0]
v_pk_mul_f32 v[218:219], v[50:51], v[212:213] op_sel_hi:[1,0]
v_pk_mul_f32 v[206:207], v[36:37], v[198:199] op_sel_hi:[1,0]
v_pk_mul_f32 v[220:221], v[52:53], v[212:213] op_sel_hi:[1,0]
v_pk_mul_f32 v[208:209], v[38:39], v[198:199] op_sel_hi:[1,0]
v_pk_mul_f32 v[222:223], v[54:55], v[212:213] op_sel_hi:[1,0]
v_exp_f32 v202, v202
v_exp_f32 v216, v216
v_exp_f32 v203, v203
v_exp_f32 v217, v217
v_exp_f32 v204, v204
v_exp_f32 v218, v218
v_exp_f32 v205, v205
v_exp_f32 v219, v219
v_exp_f32 v206, v206
v_exp_f32 v220, v220
v_exp_f32 v207, v207
v_exp_f32 v221, v221
v_exp_f32 v208, v208
v_exp_f32 v222, v222
v_exp_f32 v209, v209
v_exp_f32 v223, v223
v_pk_mul_f32 v[32:33], v[32:33], v[40:41]
v_pk_mul_f32 v[48:49], v[48:49], v[56:57]
v_pk_mul_f32 v[34:35], v[34:35], v[42:43]
v_pk_mul_f32 v[50:51], v[50:51], v[58:59]
v_pk_mul_f32 v[36:37], v[36:37], v[44:45]
v_pk_mul_f32 v[52:53], v[52:53], v[60:61]
v_pk_mul_f32 v[38:39], v[38:39], v[46:47]
v_pk_mul_f32 v[54:55], v[54:55], v[62:63]
v_pk_fma_f32 v[202:203], v[202:203], v[200:201], v[200:201] op_sel_hi:[1,0,0]
v_pk_fma_f32 v[216:217], v[216:217], v[214:215], v[214:215] op_sel_hi:[1,0,0]
v_pk_fma_f32 v[204:205], v[204:205], v[200:201], v[200:201] op_sel_hi:[1,0,0]
v_pk_fma_f32 v[218:219], v[218:219], v[214:215], v[214:215] op_sel_hi:[1,0,0]
v_pk_fma_f32 v[206:207], v[206:207], v[200:201], v[200:201] op_sel_hi:[1,0,0]
v_pk_fma_f32 v[220:221], v[220:221], v[214:215], v[214:215] op_sel_hi:[1,0,0]
v_pk_fma_f32 v[208:209], v[208:209], v[200:201], v[200:201] op_sel_hi:[1,0,0]
v_pk_fma_f32 v[222:223], v[222:223], v[214:215], v[214:215] op_sel_hi:[1,0,0]
v_rcp_f32 v202, v202
v_rcp_f32 v216, v216
v_rcp_f32 v203, v203
v_rcp_f32 v217, v217
v_rcp_f32 v204, v204
v_rcp_f32 v218, v218
v_rcp_f32 v205, v205
v_rcp_f32 v219, v219
v_rcp_f32 v206, v206
v_rcp_f32 v220, v220
v_rcp_f32 v207, v207
v_rcp_f32 v221, v221
v_rcp_f32 v208, v208
v_rcp_f32 v222, v222
v_rcp_f32 v209, v209
v_rcp_f32 v223, v223
v_pk_mul_f32 v[32:33], v[32:33], v[202:203]
v_pk_mul_f32 v[48:49], v[48:49], v[216:217]
v_pk_mul_f32 v[34:35], v[34:35], v[204:205]
v_pk_mul_f32 v[50:51], v[50:51], v[218:219]
v_pk_mul_f32 v[36:37], v[36:37], v[206:207]
v_pk_mul_f32 v[52:53], v[52:53], v[220:221]
v_pk_mul_f32 v[38:39], v[38:39], v[208:209]
v_pk_mul_f32 v[54:55], v[54:55], v[222:223]
v_cvt_pk_bf16_f32 v40, v32, v33
v_cvt_pk_bf16_f32 v56, v48, v49
v_cvt_pk_bf16_f32 v41, v34, v35
v_cvt_pk_bf16_f32 v57, v50, v51
v_cvt_pk_bf16_f32 v42, v36, v37
v_cvt_pk_bf16_f32 v58, v52, v53
v_cvt_pk_bf16_f32 v43, v38, v39
v_cvt_pk_bf16_f32 v59, v54, v55
buffer_store_dwordx4 v[40:43], v240, s[20:23], s82 offen sc1
buffer_store_dwordx4 v[56:59], v240, s[20:23], s83 offen sc1
v_sub_f32 v196, 0, v182
v_sub_f32 v210, 0, v184
v_mul_f32 v198, -1.4426950408889634, v183
v_mul_f32 v212, -1.4426950408889634, v185
v_mul_f32 v200, v183, v183
v_mul_f32 v214, v185, v185
v_rcp_f32 v200, v200
v_rcp_f32 v214, v214
v_pk_fma_f32 v[64:65], v[224:225], v[196:197], v[64:65] op_sel_hi:[1,0,1]
v_pk_fma_f32 v[80:81], v[224:225], v[210:211], v[80:81] op_sel_hi:[1,0,1]
v_pk_fma_f32 v[66:67], v[226:227], v[196:197], v[66:67] op_sel_hi:[1,0,1]
v_pk_fma_f32 v[82:83], v[226:227], v[210:211], v[82:83] op_sel_hi:[1,0,1]
v_pk_fma_f32 v[68:69], v[228:229], v[196:197], v[68:69] op_sel_hi:[1,0,1]
v_pk_fma_f32 v[84:85], v[228:229], v[210:211], v[84:85] op_sel_hi:[1,0,1]
v_pk_fma_f32 v[70:71], v[230:231], v[196:197], v[70:71] op_sel_hi:[1,0,1]
v_pk_fma_f32 v[86:87], v[230:231], v[210:211], v[86:87] op_sel_hi:[1,0,1]
v_pk_fma_f32 v[72:73], v[232:233], v[196:197], v[72:73] op_sel_hi:[1,0,1]
v_pk_fma_f32 v[88:89], v[232:233], v[210:211], v[88:89] op_sel_hi:[1,0,1]
v_pk_fma_f32 v[74:75], v[234:235], v[196:197], v[74:75] op_sel_hi:[1,0,1]
v_pk_fma_f32 v[90:91], v[234:235], v[210:211], v[90:91] op_sel_hi:[1,0,1]
v_pk_fma_f32 v[76:77], v[236:237], v[196:197], v[76:77] op_sel_hi:[1,0,1]
v_pk_fma_f32 v[92:93], v[236:237], v[210:211], v[92:93] op_sel_hi:[1,0,1]
v_pk_fma_f32 v[78:79], v[238:239], v[196:197], v[78:79] op_sel_hi:[1,0,1]
v_pk_fma_f32 v[94:95], v[238:239], v[210:211], v[94:95] op_sel_hi:[1,0,1]
v_pk_mul_f32 v[202:203], v[64:65], v[198:199] op_sel_hi:[1,0]
v_pk_mul_f32 v[216:217], v[80:81], v[212:213] op_sel_hi:[1,0]
v_pk_mul_f32 v[204:205], v[66:67], v[198:199] op_sel_hi:[1,0]
v_pk_mul_f32 v[218:219], v[82:83], v[212:213] op_sel_hi:[1,0]
v_pk_mul_f32 v[206:207], v[68:69], v[198:199] op_sel_hi:[1,0]
v_pk_mul_f32 v[220:221], v[84:85], v[212:213] op_sel_hi:[1,0]
v_pk_mul_f32 v[208:209], v[70:71], v[198:199] op_sel_hi:[1,0]
v_pk_mul_f32 v[222:223], v[86:87], v[212:213] op_sel_hi:[1,0]
v_exp_f32 v202, v202
v_exp_f32 v216, v216
v_exp_f32 v203, v203
v_exp_f32 v217, v217
v_exp_f32 v204, v204
v_exp_f32 v218, v218
v_exp_f32 v205, v205
v_exp_f32 v219, v219
v_exp_f32 v206, v206
v_exp_f32 v220, v220
v_exp_f32 v207, v207
v_exp_f32 v221, v221
v_exp_f32 v208, v208
v_exp_f32 v222, v222
v_exp_f32 v209, v209
v_exp_f32 v223, v223
v_pk_mul_f32 v[64:65], v[64:65], v[72:73]
v_pk_mul_f32 v[80:81], v[80:81], v[88:89]
v_pk_mul_f32 v[66:67], v[66:67], v[74:75]
v_pk_mul_f32 v[82:83], v[82:83], v[90:91]
v_pk_mul_f32 v[68:69], v[68:69], v[76:77]
v_pk_mul_f32 v[84:85], v[84:85], v[92:93]
v_pk_mul_f32 v[70:71], v[70:71], v[78:79]
v_pk_mul_f32 v[86:87], v[86:87], v[94:95]
v_pk_fma_f32 v[202:203], v[202:203], v[200:201], v[200:201] op_sel_hi:[1,0,0]
v_pk_fma_f32 v[216:217], v[216:217], v[214:215], v[214:215] op_sel_hi:[1,0,0]
v_pk_fma_f32 v[204:205], v[204:205], v[200:201], v[200:201] op_sel_hi:[1,0,0]
v_pk_fma_f32 v[218:219], v[218:219], v[214:215], v[214:215] op_sel_hi:[1,0,0]
v_pk_fma_f32 v[206:207], v[206:207], v[200:201], v[200:201] op_sel_hi:[1,0,0]
v_pk_fma_f32 v[220:221], v[220:221], v[214:215], v[214:215] op_sel_hi:[1,0,0]
v_pk_fma_f32 v[208:209], v[208:209], v[200:201], v[200:201] op_sel_hi:[1,0,0]
v_pk_fma_f32 v[222:223], v[222:223], v[214:215], v[214:215] op_sel_hi:[1,0,0]
v_rcp_f32 v202, v202
v_rcp_f32 v216, v216
v_rcp_f32 v203, v203
v_rcp_f32 v217, v217
v_rcp_f32 v204, v204
v_rcp_f32 v218, v218
v_rcp_f32 v205, v205
v_rcp_f32 v219, v219
v_rcp_f32 v206, v206
v_rcp_f32 v220, v220
v_rcp_f32 v207, v207
v_rcp_f32 v221, v221
v_rcp_f32 v208, v208
v_rcp_f32 v222, v222
v_rcp_f32 v209, v209
v_rcp_f32 v223, v223
v_pk_mul_f32 v[64:65], v[64:65], v[202:203]
v_pk_mul_f32 v[80:81], v[80:81], v[216:217]
v_pk_mul_f32 v[66:67], v[66:67], v[204:205]
v_pk_mul_f32 v[82:83], v[82:83], v[218:219]
v_pk_mul_f32 v[68:69], v[68:69], v[206:207]
v_pk_mul_f32 v[84:85], v[84:85], v[220:221]
v_pk_mul_f32 v[70:71], v[70:71], v[208:209]
v_pk_mul_f32 v[86:87], v[86:87], v[222:223]
v_cvt_pk_bf16_f32 v72, v64, v65
v_cvt_pk_bf16_f32 v88, v80, v81
v_cvt_pk_bf16_f32 v73, v66, v67
v_cvt_pk_bf16_f32 v89, v82, v83
v_cvt_pk_bf16_f32 v74, v68, v69
v_cvt_pk_bf16_f32 v90, v84, v85
v_cvt_pk_bf16_f32 v75, v70, v71
v_cvt_pk_bf16_f32 v91, v86, v87
buffer_store_dwordx4 v[72:75], v240, s[20:23], s84 offen sc1
buffer_store_dwordx4 v[88:91], v240, s[20:23], s85 offen sc1
v_sub_f32 v196, 0, v186
v_sub_f32 v210, 0, v188
v_mul_f32 v198, -1.4426950408889634, v187
v_mul_f32 v212, -1.4426950408889634, v189
v_mul_f32 v200, v187, v187
v_mul_f32 v214, v189, v189
v_rcp_f32 v200, v200
v_rcp_f32 v214, v214
v_pk_fma_f32 v[96:97], v[224:225], v[196:197], v[96:97] op_sel_hi:[1,0,1]
v_pk_fma_f32 v[112:113], v[224:225], v[210:211], v[112:113] op_sel_hi:[1,0,1]
v_pk_fma_f32 v[98:99], v[226:227], v[196:197], v[98:99] op_sel_hi:[1,0,1]
v_pk_fma_f32 v[114:115], v[226:227], v[210:211], v[114:115] op_sel_hi:[1,0,1]
v_pk_fma_f32 v[100:101], v[228:229], v[196:197], v[100:101] op_sel_hi:[1,0,1]
v_pk_fma_f32 v[116:117], v[228:229], v[210:211], v[116:117] op_sel_hi:[1,0,1]
v_pk_fma_f32 v[102:103], v[230:231], v[196:197], v[102:103] op_sel_hi:[1,0,1]
v_pk_fma_f32 v[118:119], v[230:231], v[210:211], v[118:119] op_sel_hi:[1,0,1]
v_pk_fma_f32 v[104:105], v[232:233], v[196:197], v[104:105] op_sel_hi:[1,0,1]
v_pk_fma_f32 v[120:121], v[232:233], v[210:211], v[120:121] op_sel_hi:[1,0,1]
v_pk_fma_f32 v[106:107], v[234:235], v[196:197], v[106:107] op_sel_hi:[1,0,1]
v_pk_fma_f32 v[122:123], v[234:235], v[210:211], v[122:123] op_sel_hi:[1,0,1]
v_pk_fma_f32 v[108:109], v[236:237], v[196:197], v[108:109] op_sel_hi:[1,0,1]
v_pk_fma_f32 v[124:125], v[236:237], v[210:211], v[124:125] op_sel_hi:[1,0,1]
v_pk_fma_f32 v[110:111], v[238:239], v[196:197], v[110:111] op_sel_hi:[1,0,1]
v_pk_fma_f32 v[126:127], v[238:239], v[210:211], v[126:127] op_sel_hi:[1,0,1]
v_pk_mul_f32 v[202:203], v[96:97], v[198:199] op_sel_hi:[1,0]
v_pk_mul_f32 v[216:217], v[112:113], v[212:213] op_sel_hi:[1,0]
v_pk_mul_f32 v[204:205], v[98:99], v[198:199] op_sel_hi:[1,0]
v_pk_mul_f32 v[218:219], v[114:115], v[212:213] op_sel_hi:[1,0]
v_pk_mul_f32 v[206:207], v[100:101], v[198:199] op_sel_hi:[1,0]
v_pk_mul_f32 v[220:221], v[116:117], v[212:213] op_sel_hi:[1,0]
v_pk_mul_f32 v[208:209], v[102:103], v[198:199] op_sel_hi:[1,0]
v_pk_mul_f32 v[222:223], v[118:119], v[212:213] op_sel_hi:[1,0]
v_exp_f32 v202, v202
v_exp_f32 v216, v216
v_exp_f32 v203, v203
v_exp_f32 v217, v217
v_exp_f32 v204, v204
v_exp_f32 v218, v218
v_exp_f32 v205, v205
v_exp_f32 v219, v219
v_exp_f32 v206, v206
v_exp_f32 v220, v220
v_exp_f32 v207, v207
v_exp_f32 v221, v221
v_exp_f32 v208, v208
v_exp_f32 v222, v222
v_exp_f32 v209, v209
v_exp_f32 v223, v223
v_pk_mul_f32 v[96:97], v[96:97], v[104:105]
v_pk_mul_f32 v[112:113], v[112:113], v[120:121]
v_pk_mul_f32 v[98:99], v[98:99], v[106:107]
v_pk_mul_f32 v[114:115], v[114:115], v[122:123]
v_pk_mul_f32 v[100:101], v[100:101], v[108:109]
v_pk_mul_f32 v[116:117], v[116:117], v[124:125]
v_pk_mul_f32 v[102:103], v[102:103], v[110:111]
v_pk_mul_f32 v[118:119], v[118:119], v[126:127]
v_pk_fma_f32 v[202:203], v[202:203], v[200:201], v[200:201] op_sel_hi:[1,0,0]
v_pk_fma_f32 v[216:217], v[216:217], v[214:215], v[214:215] op_sel_hi:[1,0,0]
v_pk_fma_f32 v[204:205], v[204:205], v[200:201], v[200:201] op_sel_hi:[1,0,0]
v_pk_fma_f32 v[218:219], v[218:219], v[214:215], v[214:215] op_sel_hi:[1,0,0]
v_pk_fma_f32 v[206:207], v[206:207], v[200:201], v[200:201] op_sel_hi:[1,0,0]
v_pk_fma_f32 v[220:221], v[220:221], v[214:215], v[214:215] op_sel_hi:[1,0,0]
v_pk_fma_f32 v[208:209], v[208:209], v[200:201], v[200:201] op_sel_hi:[1,0,0]
v_pk_fma_f32 v[222:223], v[222:223], v[214:215], v[214:215] op_sel_hi:[1,0,0]
v_rcp_f32 v202, v202
v_rcp_f32 v216, v216
v_rcp_f32 v203, v203
v_rcp_f32 v217, v217
v_rcp_f32 v204, v204
v_rcp_f32 v218, v218
v_rcp_f32 v205, v205
v_rcp_f32 v219, v219
v_rcp_f32 v206, v206
v_rcp_f32 v220, v220
v_rcp_f32 v207, v207
v_rcp_f32 v221, v221
v_rcp_f32 v208, v208
v_rcp_f32 v222, v222
v_rcp_f32 v209, v209
v_rcp_f32 v223, v223
v_pk_mul_f32 v[96:97], v[96:97], v[202:203]
v_pk_mul_f32 v[112:113], v[112:113], v[216:217]
v_pk_mul_f32 v[98:99], v[98:99], v[204:205]
v_pk_mul_f32 v[114:115], v[114:115], v[218:219]
v_pk_mul_f32 v[100:101], v[100:101], v[206:207]
v_pk_mul_f32 v[116:117], v[116:117], v[220:221]
v_pk_mul_f32 v[102:103], v[102:103], v[208:209]
v_pk_mul_f32 v[118:119], v[118:119], v[222:223]
v_cvt_pk_bf16_f32 v104, v96, v97
v_cvt_pk_bf16_f32 v120, v112, v113
v_cvt_pk_bf16_f32 v105, v98, v99
v_cvt_pk_bf16_f32 v121, v114, v115
v_cvt_pk_bf16_f32 v106, v100, v101
v_cvt_pk_bf16_f32 v122, v116, v117
v_cvt_pk_bf16_f32 v107, v102, v103
v_cvt_pk_bf16_f32 v123, v118, v119
buffer_store_dwordx4 v[104:107], v240, s[20:23], s86 offen sc1
buffer_store_dwordx4 v[120:123], v240, s[20:23], s87 offen sc1
v_sub_f32 v196, 0, v190
v_sub_f32 v210, 0, v192
v_mul_f32 v198, -1.4426950408889634, v191
v_mul_f32 v212, -1.4426950408889634, v193
v_mul_f32 v200, v191, v191
v_mul_f32 v214, v193, v193
v_rcp_f32 v200, v200
v_rcp_f32 v214, v214
v_pk_fma_f32 v[128:129], v[224:225], v[196:197], v[128:129] op_sel_hi:[1,0,1]
v_pk_fma_f32 v[144:145], v[224:225], v[210:211], v[144:145] op_sel_hi:[1,0,1]
v_pk_fma_f32 v[130:131], v[226:227], v[196:197], v[130:131] op_sel_hi:[1,0,1]
v_pk_fma_f32 v[146:147], v[226:227], v[210:211], v[146:147] op_sel_hi:[1,0,1]
v_pk_fma_f32 v[132:133], v[228:229], v[196:197], v[132:133] op_sel_hi:[1,0,1]
v_pk_fma_f32 v[148:149], v[228:229], v[210:211], v[148:149] op_sel_hi:[1,0,1]
v_pk_fma_f32 v[134:135], v[230:231], v[196:197], v[134:135] op_sel_hi:[1,0,1]
v_pk_fma_f32 v[150:151], v[230:231], v[210:211], v[150:151] op_sel_hi:[1,0,1]
v_pk_fma_f32 v[136:137], v[232:233], v[196:197], v[136:137] op_sel_hi:[1,0,1]
v_pk_fma_f32 v[152:153], v[232:233], v[210:211], v[152:153] op_sel_hi:[1,0,1]
v_pk_fma_f32 v[138:139], v[234:235], v[196:197], v[138:139] op_sel_hi:[1,0,1]
v_pk_fma_f32 v[154:155], v[234:235], v[210:211], v[154:155] op_sel_hi:[1,0,1]
v_pk_fma_f32 v[140:141], v[236:237], v[196:197], v[140:141] op_sel_hi:[1,0,1]
v_pk_fma_f32 v[156:157], v[236:237], v[210:211], v[156:157] op_sel_hi:[1,0,1]
v_pk_fma_f32 v[142:143], v[238:239], v[196:197], v[142:143] op_sel_hi:[1,0,1]
v_pk_fma_f32 v[158:159], v[238:239], v[210:211], v[158:159] op_sel_hi:[1,0,1]
v_pk_mul_f32 v[202:203], v[128:129], v[198:199] op_sel_hi:[1,0]
v_pk_mul_f32 v[216:217], v[144:145], v[212:213] op_sel_hi:[1,0]
v_pk_mul_f32 v[204:205], v[130:131], v[198:199] op_sel_hi:[1,0]
v_pk_mul_f32 v[218:219], v[146:147], v[212:213] op_sel_hi:[1,0]
v_pk_mul_f32 v[206:207], v[132:133], v[198:199] op_sel_hi:[1,0]
v_pk_mul_f32 v[220:221], v[148:149], v[212:213] op_sel_hi:[1,0]
v_pk_mul_f32 v[208:209], v[134:135], v[198:199] op_sel_hi:[1,0]
v_pk_mul_f32 v[222:223], v[150:151], v[212:213] op_sel_hi:[1,0]
v_exp_f32 v202, v202
v_exp_f32 v216, v216
v_exp_f32 v203, v203
v_exp_f32 v217, v217
v_exp_f32 v204, v204
v_exp_f32 v218, v218
v_exp_f32 v205, v205
v_exp_f32 v219, v219
v_exp_f32 v206, v206
v_exp_f32 v220, v220
v_exp_f32 v207, v207
v_exp_f32 v221, v221
v_exp_f32 v208, v208
v_exp_f32 v222, v222
v_exp_f32 v209, v209
v_exp_f32 v223, v223
v_pk_mul_f32 v[128:129], v[128:129], v[136:137]
v_pk_mul_f32 v[144:145], v[144:145], v[152:153]
v_pk_mul_f32 v[130:131], v[130:131], v[138:139]
v_pk_mul_f32 v[146:147], v[146:147], v[154:155]
v_pk_mul_f32 v[132:133], v[132:133], v[140:141]
v_pk_mul_f32 v[148:149], v[148:149], v[156:157]
v_pk_mul_f32 v[134:135], v[134:135], v[142:143]
v_pk_mul_f32 v[150:151], v[150:151], v[158:159]
v_pk_fma_f32 v[202:203], v[202:203], v[200:201], v[200:201] op_sel_hi:[1,0,0]
v_pk_fma_f32 v[216:217], v[216:217], v[214:215], v[214:215] op_sel_hi:[1,0,0]
v_pk_fma_f32 v[204:205], v[204:205], v[200:201], v[200:201] op_sel_hi:[1,0,0]
v_pk_fma_f32 v[218:219], v[218:219], v[214:215], v[214:215] op_sel_hi:[1,0,0]
v_pk_fma_f32 v[206:207], v[206:207], v[200:201], v[200:201] op_sel_hi:[1,0,0]
v_pk_fma_f32 v[220:221], v[220:221], v[214:215], v[214:215] op_sel_hi:[1,0,0]
v_pk_fma_f32 v[208:209], v[208:209], v[200:201], v[200:201] op_sel_hi:[1,0,0]
v_pk_fma_f32 v[222:223], v[222:223], v[214:215], v[214:215] op_sel_hi:[1,0,0]
v_rcp_f32 v202, v202
v_rcp_f32 v216, v216
v_rcp_f32 v203, v203
v_rcp_f32 v217, v217
v_rcp_f32 v204, v204
v_rcp_f32 v218, v218
v_rcp_f32 v205, v205
v_rcp_f32 v219, v219
v_rcp_f32 v206, v206
v_rcp_f32 v220, v220
v_rcp_f32 v207, v207
v_rcp_f32 v221, v221
v_rcp_f32 v208, v208
v_rcp_f32 v222, v222
v_rcp_f32 v209, v209
v_rcp_f32 v223, v223
v_pk_mul_f32 v[128:129], v[128:129], v[202:203]
v_pk_mul_f32 v[144:145], v[144:145], v[216:217]
v_pk_mul_f32 v[130:131], v[130:131], v[204:205]
v_pk_mul_f32 v[146:147], v[146:147], v[218:219]
v_pk_mul_f32 v[132:133], v[132:133], v[206:207]
v_pk_mul_f32 v[148:149], v[148:149], v[220:221]
v_pk_mul_f32 v[134:135], v[134:135], v[208:209]
v_pk_mul_f32 v[150:151], v[150:151], v[222:223]
v_cvt_pk_bf16_f32 v136, v128, v129
v_cvt_pk_bf16_f32 v152, v144, v145
v_cvt_pk_bf16_f32 v137, v130, v131
v_cvt_pk_bf16_f32 v153, v146, v147
v_cvt_pk_bf16_f32 v138, v132, v133
v_cvt_pk_bf16_f32 v154, v148, v149
v_cvt_pk_bf16_f32 v139, v134, v135
v_cvt_pk_bf16_f32 v155, v150, v151
buffer_store_dwordx4 v[136:139], v240, s[20:23], s88 offen sc1
buffer_store_dwordx4 v[152:155], v240, s[20:23], s89 offen sc1
s_waitcnt vmcnt(10)
v_lshrrev_b32 v3, 4, v255
v_and_b32 v4, 15, v255
v_lshrrev_b32 v5, 2, v4
v_and_b32 v6, 3, v4
v_lshlrev_b32 v3, 2, v3
v_add_u32 v3, v3, v5
v_lshlrev_b32 v3, 7, v3
v_lshlrev_b32 v6, 3, v6
v_add_u32 v3, v3, v6
s_lshl_b32 s31, s24, 13
v_add_u32 v3, s31, v3
s_cmp_ge_u32 s68, 680
s_cbranch_scc1 FFN_wf_901_7
ds_read_b64_tr_b16 v[16:17], v3 offset:0
ds_read_b64_tr_b16 v[18:19], v3 offset:2048
ds_read_b64_tr_b16 v[20:21], v3 offset:32
ds_read_b64_tr_b16 v[22:23], v3 offset:2080
ds_read_b64_tr_b16 v[24:25], v3 offset:64
ds_read_b64_tr_b16 v[26:27], v3 offset:2112
ds_read_b64_tr_b16 v[28:29], v3 offset:96
ds_read_b64_tr_b16 v[30:31], v3 offset:2144
s_waitcnt lgkmcnt(0)
s_lshl_b32 s30, s70, 2
s_add_u32 s30, s30, 0
s_mul_hi_u32 s31, s30, 858993460
s_mul_i32 s32, s31, 5
s_sub_u32 s32, s30, s32
s_mul_i32 s31, s31, 68
s_add_u32 s31, s31, s69
s_mul_i32 s31, s31, 5
s_add_u32 s31, s31, s32
s_lshl_b32 s31, s31, 10
s_add_u32 s31, s31, 131072
buffer_store_dwordx4 v[16:19], v240, s[20:23], s31 offen sc1
s_lshl_b32 s30, s70, 2
s_add_u32 s30, s30, 1
s_mul_hi_u32 s31, s30, 858993460
s_mul_i32 s32, s31, 5
s_sub_u32 s32, s30, s32
s_mul_i32 s31, s31, 68
s_add_u32 s31, s31, s69
s_mul_i32 s31, s31, 5
s_add_u32 s31, s31, s32
s_lshl_b32 s31, s31, 10
s_add_u32 s31, s31, 131072
buffer_store_dwordx4 v[20:23], v240, s[20:23], s31 offen sc1
s_lshl_b32 s30, s70, 2
s_add_u32 s30, s30, 2
s_mul_hi_u32 s31, s30, 858993460
s_mul_i32 s32, s31, 5
s_sub_u32 s32, s30, s32
s_mul_i32 s31, s31, 68
s_add_u32 s31, s31, s69
s_mul_i32 s31, s31, 5
s_add_u32 s31, s31, s32
s_lshl_b32 s31, s31, 10
s_add_u32 s31, s31, 131072
buffer_store_dwordx4 v[24:27], v240, s[20:23], s31 offen sc1
s_lshl_b32 s30, s70, 2
s_add_u32 s30, s30, 3
s_mul_hi_u32 s31, s30, 858993460
s_mul_i32 s32, s31, 5
s_sub_u32 s32, s30, s32
s_mul_i32 s31, s31, 68
s_add_u32 s31, s31, s69
s_mul_i32 s31, s31, 5
s_add_u32 s31, s31, s32
s_lshl_b32 s31, s31, 10
s_add_u32 s31, s31, 131072
buffer_store_dwordx4 v[28:31], v240, s[20:23], s31 offen sc1
FFN_wf_901_7:
s_endpgm
ATT:
s_mov_b32 s38, 0
s_lshl_b32 s27, s25, 8
s_mov_b32 s4, s66
s_mov_b32 s5, s67
s_mov_b32 s6, s68
s_mov_b32 s7, s69
v_lshrrev_b32 v200, 3, v255
v_lshrrev_b32 v201, 4, v255
v_and_b32 v202, 7, v255
s_mul_i32 s30, s24, 64
s_add_u32 s30, s30, s27
s_mul_i32 s31, s24, 32
v_add_u32 v204, s30, v200
v_mul_u32_u24 v204, 1280, v204
v_add_u32 v203, 0, v201
v_add_u32 v203, s31, v203
v_and_b32 v203, 7, v203
v_xor_b32 v203, v203, v202
v_lshlrev_b32 v203, 4, v203
v_add_u32 v205, v203, v204
v_add_u32 v203, 4, v201
v_add_u32 v203, s31, v203
v_and_b32 v203, 7, v203
v_xor_b32 v203, v203, v202
v_lshlrev_b32 v203, 4, v203
v_add_u32 v206, v203, v204
v_add_u32 v172, 0, v205
v_add_u32 v173, 10240, v206
v_add_u32 v174, 20480, v205
v_add_u32 v175, 30720, v206
v_add_u32 v176, 40960, v205
v_add_u32 v177, 51200, v206
v_add_u32 v178, 61440, v205
v_add_u32 v179, 71680, v206
s_mul_i32 s34, s24, 8192
s_mov_b32 s40, 0
s_mov_b32 s39, s38
s_lshl_b32 s41, s39, 7
s_mul_i32 s42, s39, 245760
s_mov_b32 s48, s34
s_add_u32 m0, s48, 0
s_nop 0
buffer_load_dwordx4 v172, s[8:11], s41 offen lds
s_add_u32 m0, s48, 1024
s_nop 0
buffer_load_dwordx4 v173, s[8:11], s41 offen lds
s_add_u32 m0, s48, 2048
s_nop 0
buffer_load_dwordx4 v174, s[8:11], s41 offen lds
s_add_u32 m0, s48, 3072
s_nop 0
buffer_load_dwordx4 v175, s[8:11], s41 offen lds
s_add_u32 m0, s48, 4096
s_nop 0
buffer_load_dwordx4 v176, s[8:11], s41 offen lds
s_add_u32 m0, s48, 5120
s_nop 0
buffer_load_dwordx4 v177, s[8:11], s41 offen lds
s_add_u32 m0, s48, 6144
s_nop 0
buffer_load_dwordx4 v178, s[8:11], s41 offen lds
s_add_u32 m0, s48, 7168
s_nop 0
buffer_load_dwordx4 v179, s[8:11], s41 offen lds
s_mul_i32 s30, s24, 5
s_lshl_b32 s31, s28, 1
s_lshl_b32 s32, s29, 1
s_sub_u32 s32, s32, s31
s_sub_u32 s32, s32, 160
s_mov_b32 s33, 0xCCCD
s_add_u32 s53, s30, 0
s_lshl_b32 s53, s53, 6
v_add_u32 v200, s53, v255
v_mul_lo_u32 v201, v200, s33
v_lshrrev_b32 v201, 20, v201
v_mul_u32_u24 v202, 20, v201
v_sub_u32 v202, v200, v202
v_lshrrev_b32 v203, 2, v201
v_and_b32 v203, 2, v203
v_xor_b32 v202, v202, v203
v_cmp_le_u32 vcc, 10, v202
v_mov_b32 v204, s32
s_nop 0
v_cndmask_b32 v204, 0, v204, vcc
v_lshlrev_b32 v202, 4, v202
v_add_u32 v202, v202, v204
v_mul_u32_u24 v201, 3840, v201
v_add_u32 v201, v201, v202
v_add_u32 v180, s31, v201
s_add_u32 s53, s30, 1
s_lshl_b32 s53, s53, 6
v_add_u32 v200, s53, v255
v_mul_lo_u32 v201, v200, s33
v_lshrrev_b32 v201, 20, v201
v_mul_u32_u24 v202, 20, v201
v_sub_u32 v202, v200, v202
v_lshrrev_b32 v203, 2, v201
v_and_b32 v203, 2, v203
v_xor_b32 v202, v202, v203
v_cmp_le_u32 vcc, 10, v202
v_mov_b32 v204, s32
s_nop 0
v_cndmask_b32 v204, 0, v204, vcc
v_lshlrev_b32 v202, 4, v202
v_add_u32 v202, v202, v204
v_mul_u32_u24 v201, 3840, v201
v_add_u32 v201, v201, v202
v_add_u32 v181, s31, v201
s_add_u32 s53, s30, 2
s_lshl_b32 s53, s53, 6
v_add_u32 v200, s53, v255
v_mul_lo_u32 v201, v200, s33
v_lshrrev_b32 v201, 20, v201
v_mul_u32_u24 v202, 20, v201
v_sub_u32 v202, v200, v202
v_lshrrev_b32 v203, 2, v201
v_and_b32 v203, 2, v203
v_xor_b32 v202, v202, v203
v_cmp_le_u32 vcc, 10, v202
v_mov_b32 v204, s32
s_nop 0
v_cndmask_b32 v204, 0, v204, vcc
v_lshlrev_b32 v202, 4, v202
v_add_u32 v202, v202, v204
v_mul_u32_u24 v201, 3840, v201
v_add_u32 v201, v201, v202
v_add_u32 v182, s31, v201
s_add_u32 s53, s30, 3
s_lshl_b32 s53, s53, 6
v_add_u32 v200, s53, v255
v_mul_lo_u32 v201, v200, s33
v_lshrrev_b32 v201, 20, v201
v_mul_u32_u24 v202, 20, v201
v_sub_u32 v202, v200, v202
v_lshrrev_b32 v203, 2, v201
v_and_b32 v203, 2, v203
v_xor_b32 v202, v202, v203
v_cmp_le_u32 vcc, 10, v202
v_mov_b32 v204, s32
s_nop 0
v_cndmask_b32 v204, 0, v204, vcc
v_lshlrev_b32 v202, 4, v202
v_add_u32 v202, v202, v204
v_mul_u32_u24 v201, 3840, v201
v_add_u32 v201, v201, v202
v_add_u32 v183, s31, v201
s_add_u32 s53, s30, 4
s_lshl_b32 s53, s53, 6
v_add_u32 v200, s53, v255
v_mul_lo_u32 v201, v200, s33
v_lshrrev_b32 v201, 20, v201
v_mul_u32_u24 v202, 20, v201
v_sub_u32 v202, v200, v202
v_lshrrev_b32 v203, 2, v201
v_and_b32 v203, 2, v203
v_xor_b32 v202, v202, v203
v_cmp_le_u32 vcc, 10, v202
v_mov_b32 v204, s32
s_nop 0
v_cndmask_b32 v204, 0, v204, vcc
v_lshlrev_b32 v202, 4, v202
v_add_u32 v202, v202, v204
v_mul_u32_u24 v201, 3840, v201
v_add_u32 v201, v201, v202
v_add_u32 v184, s31, v201
s_lshl_b32 s35, s30, 10
s_add_u32 s35, s35, 32768
s_mov_b32 s12, s4
s_and_b32 s13, s5, 0xffff
s_mov_b32 s14, 2457600
s_mov_b32 s15, 0x20000
s_mov_b32 s16, s6
s_and_b32 s17, s7, 0xffff
s_mov_b32 s18, 25600
s_mov_b32 s19, 0x20000
s_mov_b32 s49, s35
s_add_u32 m0, s49, 0
s_nop 0
buffer_load_dwordx4 v180, s[12:15], s42 offen lds
s_add_u32 m0, s49, 1024
s_nop 0
buffer_load_dwordx4 v181, s[12:15], s42 offen lds
s_add_u32 m0, s49, 2048
s_nop 0
buffer_load_dwordx4 v182, s[12:15], s42 offen lds
s_add_u32 m0, s49, 3072
s_nop 0
buffer_load_dwordx4 v183, s[12:15], s42 offen lds
s_add_u32 m0, s49, 4096
s_nop 0
buffer_load_dwordx4 v184, s[12:15], s42 offen lds
s_add_u32 s39, s39, 1
s_cmp_ge_u32 s39, 10
s_cselect_b32 s39, 0, s39
s_lshl_b32 s41, s39, 7
s_mul_i32 s42, s39, 245760
s_add_u32 s40, s40, 53248
s_cmp_ge_u32 s40, 159744
s_cselect_b32 s43, 159744, 0
s_sub_u32 s40, s40, s43
s_add_u32 s48, s40, s34
s_add_u32 s49, s40, s35
v_lshlrev_b32 v201, 4, v255
s_mul_i32 s31, s26, 3200
s_lshl_b32 s32, s24, 10
s_add_u32 s31, s31, s32
s_add_u32 m0, s32, 159744
s_cmp_eq_u32 s24, 3
s_cselect_b64 s[54:55], 0xff, -1
s_mov_b64 exec, s[54:55]
buffer_load_dwordx4 v201, s[16:19], s31 offen lds
s_mov_b64 exec, -1
v_mov_b32 v204, 0
v_mov_b32 v205, 0
v_mov_b32 v206, 0
v_mov_b32 v207, 0
v_lshlrev_b32 v203, 4, v255
v_add_u32 v203, 162944, v203
s_mov_b32 exec_hi, 0x00ffffff
ds_write_b128 v203, v[204:207]
s_mov_b64 exec, -1
s_lshl_b32 s30, s24, 13
v_and_b32 v200, 15, v255
v_lshrrev_b32 v201, 4, v255
v_lshrrev_b32 v202, 1, v200
v_xor_b32 v202, v202, v201
v_and_b32 v202, 7, v202
v_lshlrev_b32 v202, 4, v202
v_lshlrev_b32 v203, 7, v200
v_add_u32 v203, v203, v202
v_add_u32 v160, s30, v203
v_xor_b32 v161, 64, v160
v_and_b32 v200, 15, v255
v_lshrrev_b32 v201, 4, v255
v_lshrrev_b32 v202, 2, v200
v_and_b32 v203, 3, v200
v_lshlrev_b32 v204, 3, v201
v_add_u32 v204, v204, v202
v_mul_u32_u24 v204, 320, v204
v_mul_u32_u24 v205, 5, v203
v_and_b32 v206, 1, v201
v_lshlrev_b32 v206, 2, v206
v_add_u32 v207, 0, v205
v_xor_b32 v207, v207, v206
v_lshlrev_b32 v207, 3, v207
v_add_u32 v207, v207, v204
v_add_u32 v162, 32768, v207
v_add_u32 v207, 1, v205
v_xor_b32 v207, v207, v206
v_lshlrev_b32 v207, 3, v207
v_add_u32 v207, v207, v204
v_add_u32 v163, 32768, v207
v_add_u32 v207, 2, v205
v_xor_b32 v207, v207, v206
v_lshlrev_b32 v207, 3, v207
v_add_u32 v207, v207, v204
v_add_u32 v164, 32768, v207
v_add_u32 v207, 3, v205
v_xor_b32 v207, v207, v206
v_lshlrev_b32 v207, 3, v207
v_add_u32 v207, v207, v204
v_add_u32 v165, 32768, v207
v_add_u32 v207, 4, v205
v_xor_b32 v207, v207, v206
v_lshlrev_b32 v207, 3, v207
v_add_u32 v207, v207, v204
v_add_u32 v166, 32768, v207
v_add_u32 v207, 20, v205
v_xor_b32 v207, v207, v206
v_lshlrev_b32 v207, 3, v207
v_add_u32 v207, v207, v204
v_add_u32 v167, 32768, v207
v_add_u32 v207, 21, v205
v_xor_b32 v207, v207, v206
v_lshlrev_b32 v207, 3, v207
v_add_u32 v207, v207, v204
v_add_u32 v168, 32768, v207
v_add_u32 v207, 22, v205
v_xor_b32 v207, v207, v206
v_lshlrev_b32 v207, 3, v207
v_add_u32 v207, v207, v204
v_add_u32 v169, 32768, v207
v_add_u32 v207, 23, v205
v_xor_b32 v207, v207, v206
v_lshlrev_b32 v207, 3, v207
v_add_u32 v207, v207, v204
v_add_u32 v170, 32768, v207
v_add_u32 v207, 24, v205
v_xor_b32 v207, v207, v206
v_lshlrev_b32 v207, 3, v207
v_add_u32 v207, v207, v204
v_add_u32 v171, 32768, v207
v_mul_u32_u24 v208, 800, v201
v_mul_u32_u24 v209, 40, v202
v_add_u32 v208, v208, v209
v_add_u32 v245, 159744, v208
v_mov_b32 v209, 162944
v_cmp_eq_u32 vcc, v203, v201
s_nop 1
v_cndmask_b32 v245, v209, v245, vcc
v_mov_b32 v0, 0
v_mov_b32 v1, 0
v_mov_b32 v2, 0
v_mov_b32 v3, 0
v_mov_b32 v4, 0
v_mov_b32 v5, 0
v_mov_b32 v6, 0
v_mov_b32 v7, 0
v_mov_b32 v8, 0
v_mov_b32 v9, 0
v_mov_b32 v10, 0
v_mov_b32 v11, 0
v_mov_b32 v12, 0
v_mov_b32 v13, 0
v_mov_b32 v14, 0
v_mov_b32 v15, 0
v_mov_b32 v16, 0
v_mov_b32 v17, 0
v_mov_b32 v18, 0
v_mov_b32 v19, 0
v_mov_b32 v20, 0
v_mov_b32 v21, 0
v_mov_b32 v22, 0
v_mov_b32 v23, 0
v_mov_b32 v24, 0
v_mov_b32 v25, 0
v_mov_b32 v26, 0
v_mov_b32 v27, 0
v_mov_b32 v28, 0
v_mov_b32 v29, 0
v_mov_b32 v30, 0
v_mov_b32 v31, 0
v_mov_b32 v32, 0
v_mov_b32 v33, 0
v_mov_b32 v34, 0
v_mov_b32 v35, 0
v_mov_b32 v36, 0
v_mov_b32 v37, 0
v_mov_b32 v38, 0
v_mov_b32 v39, 0
v_mov_b32 v40, 0
v_mov_b32 v41, 0
v_mov_b32 v42, 0
v_mov_b32 v43, 0
v_mov_b32 v44, 0
v_mov_b32 v45, 0
v_mov_b32 v46, 0
v_mov_b32 v47, 0
v_mov_b32 v48, 0
v_mov_b32 v49, 0
v_mov_b32 v50, 0
v_mov_b32 v51, 0
v_mov_b32 v52, 0
v_mov_b32 v53, 0
v_mov_b32 v54, 0
v_mov_b32 v55, 0
v_mov_b32 v56, 0
v_mov_b32 v57, 0
v_mov_b32 v58, 0
v_mov_b32 v59, 0
v_mov_b32 v60, 0
v_mov_b32 v61, 0
v_mov_b32 v62, 0
v_mov_b32 v63, 0
v_mov_b32 v64, 0
v_mov_b32 v65, 0
v_mov_b32 v66, 0
v_mov_b32 v67, 0
v_mov_b32 v68, 0
v_mov_b32 v69, 0
v_mov_b32 v70, 0
v_mov_b32 v71, 0
v_mov_b32 v72, 0
v_mov_b32 v73, 0
v_mov_b32 v74, 0
v_mov_b32 v75, 0
v_mov_b32 v76, 0
v_mov_b32 v77, 0
v_mov_b32 v78, 0
v_mov_b32 v79, 0
v_mov_b32 v80, 0
v_mov_b32 v81, 0
v_mov_b32 v82, 0
v_mov_b32 v83, 0
v_mov_b32 v84, 0
v_mov_b32 v85, 0
v_mov_b32 v86, 0
v_mov_b32 v87, 0
v_mov_b32 v88, 0
v_mov_b32 v89, 0
v_mov_b32 v90, 0
v_mov_b32 v91, 0
v_mov_b32 v92, 0
v_mov_b32 v93, 0
v_mov_b32 v94, 0
v_mov_b32 v95, 0
v_mov_b32 v96, 0
v_mov_b32 v97, 0
v_mov_b32 v98, 0
v_mov_b32 v99, 0
v_mov_b32 v100, 0
v_mov_b32 v101, 0
v_mov_b32 v102, 0
v_mov_b32 v103, 0
v_mov_b32 v104, 0
v_mov_b32 v105, 0
v_mov_b32 v106, 0
v_mov_b32 v107, 0
v_mov_b32 v108, 0
v_mov_b32 v109, 0
v_mov_b32 v110, 0
v_mov_b32 v111, 0
v_mov_b32 v112, 0
v_mov_b32 v113, 0
v_mov_b32 v114, 0
v_mov_b32 v115, 0
v_mov_b32 v116, 0
v_mov_b32 v117, 0
v_mov_b32 v118, 0
v_mov_b32 v119, 0
v_mov_b32 v120, 0
v_mov_b32 v121, 0
v_mov_b32 v122, 0
v_mov_b32 v123, 0
v_mov_b32 v124, 0
v_mov_b32 v125, 0
v_mov_b32 v126, 0
v_mov_b32 v127, 0
v_mov_b32 v128, 0
v_mov_b32 v129, 0
v_mov_b32 v130, 0
v_mov_b32 v131, 0
v_mov_b32 v132, 0
v_mov_b32 v133, 0
v_mov_b32 v134, 0
v_mov_b32 v135, 0
v_mov_b32 v136, 0
v_mov_b32 v137, 0
v_mov_b32 v138, 0
v_mov_b32 v139, 0
v_mov_b32 v140, 0
v_mov_b32 v141, 0
v_mov_b32 v142, 0
v_mov_b32 v143, 0
v_mov_b32 v144, 0
v_mov_b32 v145, 0
v_mov_b32 v146, 0
v_mov_b32 v147, 0
v_mov_b32 v148, 0
v_mov_b32 v149, 0
v_mov_b32 v150, 0
v_mov_b32 v151, 0
v_mov_b32 v152, 0
v_mov_b32 v153, 0
v_mov_b32 v154, 0
v_mov_b32 v155, 0
v_mov_b32 v156, 0
v_mov_b32 v157, 0
v_mov_b32 v158, 0
v_mov_b32 v159, 0
s_add_u32 m0, s48, 0
s_nop 0
buffer_load_dwordx4 v172, s[8:11], s41 offen lds
s_add_u32 m0, s49, 0
s_nop 0
buffer_load_dwordx4 v180, s[12:15], s42 offen lds
s_add_u32 m0, s48, 1024
s_nop 0
buffer_load_dwordx4 v173, s[8:11], s41 offen lds
s_add_u32 m0, s49, 1024
s_nop 0
buffer_load_dwordx4 v181, s[12:15], s42 offen lds
s_add_u32 m0, s48, 2048
s_nop 0
buffer_load_dwordx4 v174, s[8:11], s41 offen lds
s_add_u32 m0, s48, 3072
s_nop 0
buffer_load_dwordx4 v175, s[8:11], s41 offen lds
s_add_u32 m0, s49, 2048
s_nop 0
buffer_load_dwordx4 v182, s[12:15], s42 offen lds
s_add_u32 m0, s48, 4096
s_nop 0
buffer_load_dwordx4 v176, s[8:11], s41 offen lds
s_add_u32 m0, s48, 5120
s_nop 0
buffer_load_dwordx4 v177, s[8:11], s41 offen lds
s_add_u32 m0, s49, 3072
s_nop 0
buffer_load_dwordx4 v183, s[12:15], s42 offen lds
s_add_u32 m0, s48, 6144
s_nop 0
buffer_load_dwordx4 v178, s[8:11], s41 offen lds
s_add_u32 m0, s49, 4096
s_nop 0
buffer_load_dwordx4 v184, s[12:15], s42 offen lds
s_add_u32 m0, s48, 7168
s_nop 0
buffer_load_dwordx4 v179, s[8:11], s41 offen lds
s_add_u32 s39, s39, 1
s_cmp_ge_u32 s39, 10
s_cselect_b32 s39, 0, s39
s_lshl_b32 s41, s39, 7
s_mul_i32 s42, s39, 245760
s_add_u32 s40, s40, 53248
s_cmp_ge_u32 s40, 159744
s_cselect_b32 s43, 159744, 0
s_sub_u32 s40, s40, s43
s_add_u32 s48, s40, s34
s_add_u32 s49, s40, s35
s_getpc_b64 s[54:55]
PC_901_8:
s_sub_u32 s54, s54, PC_901_8-k1_kernel
s_subb_u32 s55, s55, 0
s_lshr_b32 s53, s2, 3
s_lshl_b32 s53, s53, 11
s_min_u32 s53, s53, CODE_END-k1_kernel-2048
s_lshl_b32 s60, s24, 9
s_add_u32 s53, s53, s60
v_lshlrev_b32 v200, 4, v255
v_add_u32 v200, s53, v200
s_mov_b32 exec_hi, 0
global_load_dwordx4 a[252:255], v200, s[54:55]
s_mov_b64 exec, -1
s_waitcnt vmcnt(14) lgkmcnt(0)
s_barrier
s_add_u32 m0, s48, 0
s_nop 0
buffer_load_dwordx4 v172, s[8:11], s41 offen lds
s_add_u32 m0, s49, 0
s_nop 0
buffer_load_dwordx4 v180, s[12:15], s42 offen lds
s_add_u32 m0, s48, 1024
s_nop 0
buffer_load_dwordx4 v173, s[8:11], s41 offen lds
s_add_u32 m0, s49, 1024
s_nop 0
buffer_load_dwordx4 v181, s[12:15], s42 offen lds
s_add_u32 m0, s48, 2048
s_nop 0
buffer_load_dwordx4 v174, s[8:11], s41 offen lds
s_add_u32 m0, s48, 3072
s_nop 0
buffer_load_dwordx4 v175, s[8:11], s41 offen lds
v_lshlrev_b32 v187, 7, v255
v_mov_b32 v186, 0
ds_read_b128 a[0:3], v160 offset:0
ds_read_b64_tr_b16 a[32:33], v162 offset:0
ds_read_b64_tr_b16 a[34:35], v162 offset:1280
ds_read_b64_tr_b16 a[36:37], v163 offset:0
ds_read_b64_tr_b16 a[38:39], v163 offset:1280
ds_read_b64_tr_b16 a[40:41], v164 offset:0
ds_read_b64_tr_b16 a[42:43], v164 offset:1280
ds_read_b64_tr_b16 a[44:45], v165 offset:0
ds_read_b64_tr_b16 a[46:47], v165 offset:1280
ds_read_b64_tr_b16 a[48:49], v166 offset:0
ds_read_b64_tr_b16 a[50:51], v166 offset:1280
ds_read_b64_tr_b16 a[52:53], v167 offset:0
ds_read_b64_tr_b16 a[54:55], v167 offset:1280
ds_read_b64_tr_b16 a[56:57], v168 offset:0
ds_read_b64_tr_b16 a[58:59], v168 offset:1280
ds_read_b64_tr_b16 a[60:61], v169 offset:0
ds_read_b64_tr_b16 a[62:63], v169 offset:1280
ds_read_b64_tr_b16 a[64:65], v170 offset:0
ds_read_b64_tr_b16 a[66:67], v170 offset:1280
ds_read_b64_tr_b16 a[68:69], v171 offset:0
ds_read_b64_tr_b16 a[70:71], v171 offset:1280
ds_read_b128 a[4:7], v160 offset:2048
ds_read_b128 a[8:11], v160 offset:4096
ds_read_b128 a[12:15], v160 offset:6144
s_cmp_eq_u32 s24, 0
s_cselect_b32 s33, 5, 99
s_waitcnt lgkmcnt(0)
s_mov_b32 s44, 0
s_mov_b32 s45, 0
s_mov_b32 s52, 1
ATT_loop:
v_mfma_f32_16x16x32_bf16 v[0:3], a[32:35], a[0:3], v[0:3]
ds_read_b128 a[16:19], v161 offset:0
v_mfma_f32_16x16x32_bf16 v[4:7], a[36:39], a[0:3], v[4:7]
ds_read_b64_tr_b16 a[72:73], v162 offset:10240
s_add_u32 s46, s45, 53248
v_mfma_f32_16x16x32_bf16 v[8:11], a[40:43], a[0:3], v[8:11]
ds_read_b64_tr_b16 a[74:75], v162 offset:11520
v_mfma_f32_16x16x32_bf16 v[12:15], a[44:47], a[0:3], v[12:15]
ds_read_b64_tr_b16 a[76:77], v163 offset:10240
s_cmp_ge_u32 s46, 159744
s_cselect_b32 s47, 159744, 0
v_mfma_f32_16x16x32_bf16 v[16:19], a[48:51], a[0:3], v[16:19]
ds_read_b64_tr_b16 a[78:79], v163 offset:11520
s_add_u32 m0, s49, 2048
v_mfma_f32_16x16x32_bf16 v[20:23], a[52:55], a[0:3], v[20:23]
buffer_load_dwordx4 v182, s[12:15], s42 offen lds
ds_read_b64_tr_b16 a[80:81], v164 offset:10240
v_mfma_f32_16x16x32_bf16 v[24:27], a[56:59], a[0:3], v[24:27]
ds_read_b64_tr_b16 a[82:83], v164 offset:11520
s_sub_u32 s46, s46, s47
v_mfma_f32_16x16x32_bf16 v[28:31], a[60:63], a[0:3], v[28:31]
ds_read_b64_tr_b16 a[84:85], v165 offset:10240
v_mfma_f32_16x16x32_bf16 v[32:35], a[64:67], a[0:3], v[32:35]
ds_read_b64_tr_b16 a[86:87], v165 offset:11520
s_add_u32 m0, s48, 4096
s_sub_u32 s47, s46, s45
v_mfma_f32_16x16x32_bf16 v[36:39], a[68:71], a[0:3], v[36:39]
buffer_load_dwordx4 v176, s[8:11], s41 offen lds
ds_read_b64_tr_b16 a[88:89], v166 offset:10240
v_mfma_f32_16x16x32_bf16 v[40:43], a[32:35], a[4:7], v[40:43]
ds_read_b64_tr_b16 a[90:91], v166 offset:11520
s_mov_b32 s45, s46
v_mfma_f32_16x16x32_bf16 v[44:47], a[36:39], a[4:7], v[44:47]
ds_read_b64_tr_b16 a[92:93], v167 offset:10240
v_mfma_f32_16x16x32_bf16 v[48:51], a[40:43], a[4:7], v[48:51]
ds_read_b64_tr_b16 a[94:95], v167 offset:11520
v_mfma_f32_16x16x32_bf16 v[52:55], a[44:47], a[4:7], v[52:55]
ds_read_b64_tr_b16 a[96:97], v168 offset:10240
s_add_u32 m0, s48, 5120
v_mfma_f32_16x16x32_bf16 v[56:59], a[48:51], a[4:7], v[56:59]
buffer_load_dwordx4 v177, s[8:11], s41 offen lds
ds_read_b64_tr_b16 a[98:99], v168 offset:11520
v_mfma_f32_16x16x32_bf16 v[60:63], a[52:55], a[4:7], v[60:63]
ds_read_b64_tr_b16 a[100:101], v169 offset:10240
v_mfma_f32_16x16x32_bf16 v[64:67], a[56:59], a[4:7], v[64:67]
ds_read_b64_tr_b16 a[102:103], v169 offset:11520
v_mfma_f32_16x16x32_bf16 v[68:71], a[60:63], a[4:7], v[68:71]
ds_read_b64_tr_b16 a[104:105], v170 offset:10240
v_mfma_f32_16x16x32_bf16 v[72:75], a[64:67], a[4:7], v[72:75]
ds_read_b64_tr_b16 a[106:107], v170 offset:11520
s_add_u32 m0, s49, 3072
v_mfma_f32_16x16x32_bf16 v[76:79], a[68:71], a[4:7], v[76:79]
buffer_load_dwordx4 v183, s[12:15], s42 offen lds
ds_read_b64_tr_b16 a[108:109], v171 offset:10240
v_mfma_f32_16x16x32_bf16 v[80:83], a[32:35], a[8:11], v[80:83]
ds_read_b64_tr_b16 a[110:111], v171 offset:11520
v_mfma_f32_16x16x32_bf16 v[84:87], a[36:39], a[8:11], v[84:87]
ds_read_b128 a[20:23], v161 offset:2048
v_mfma_f32_16x16x32_bf16 v[88:91], a[40:43], a[8:11], v[88:91]
ds_read_b128 a[24:27], v161 offset:4096
s_add_u32 m0, s48, 6144
v_mfma_f32_16x16x32_bf16 v[92:95], a[44:47], a[8:11], v[92:95]
buffer_load_dwordx4 v178, s[8:11], s41 offen lds
ds_read_b128 a[28:31], v161 offset:6144
v_mfma_f32_16x16x32_bf16 v[96:99], a[48:51], a[8:11], v[96:99]
v_mfma_f32_16x16x32_bf16 v[100:103], a[52:55], a[8:11], v[100:103]
v_add_u32 v160, s47, v160
v_mfma_f32_16x16x32_bf16 v[104:107], a[56:59], a[8:11], v[104:107]
v_add_u32 v161, s47, v161
v_mfma_f32_16x16x32_bf16 v[108:111], a[60:63], a[8:11], v[108:111]
s_add_u32 m0, s49, 4096
v_mfma_f32_16x16x32_bf16 v[112:115], a[64:67], a[8:11], v[112:115]
buffer_load_dwordx4 v184, s[12:15], s42 offen lds
v_add_u32 v162, s47, v162
v_mfma_f32_16x16x32_bf16 v[116:119], a[68:71], a[8:11], v[116:119]
v_add_u32 v163, s47, v163
v_mfma_f32_16x16x32_bf16 v[120:123], a[32:35], a[12:15], v[120:123]
v_add_u32 v164, s47, v164
v_mfma_f32_16x16x32_bf16 v[124:127], a[36:39], a[12:15], v[124:127]
s_add_u32 m0, s48, 7168
v_add_u32 v165, s47, v165
v_mfma_f32_16x16x32_bf16 v[128:131], a[40:43], a[12:15], v[128:131]
buffer_load_dwordx4 v179, s[8:11], s41 offen lds
v_add_u32 v166, s47, v166
v_mfma_f32_16x16x32_bf16 v[132:135], a[44:47], a[12:15], v[132:135]
v_add_u32 v167, s47, v167
v_mfma_f32_16x16x32_bf16 v[136:139], a[48:51], a[12:15], v[136:139]
v_mfma_f32_16x16x32_bf16 v[140:143], a[52:55], a[12:15], v[140:143]
v_add_u32 v168, s47, v168
s_add_u32 s39, s39, 1
s_cmp_ge_u32 s39, 10
s_cselect_b32 s39, 0, s39
v_mfma_f32_16x16x32_bf16 v[144:147], a[56:59], a[12:15], v[144:147]
v_add_u32 v169, s47, v169
s_lshl_b32 s41, s39, 7
s_mul_i32 s42, s39, 245760
v_mfma_f32_16x16x32_bf16 v[148:151], a[60:63], a[12:15], v[148:151]
v_add_u32 v170, s47, v170
s_add_u32 s40, s40, 53248
s_cmp_ge_u32 s40, 159744
s_cselect_b32 s43, 159744, 0
v_mfma_f32_16x16x32_bf16 v[152:155], a[64:67], a[12:15], v[152:155]
v_add_u32 v171, s47, v171
s_sub_u32 s40, s40, s43
v_mfma_f32_16x16x32_bf16 v[156:159], a[68:71], a[12:15], v[156:159]
s_add_u32 s48, s40, s34
s_add_u32 s49, s40, s35
s_cmp_eq_u32 s52, 0
s_cbranch_scc0 ATT_wxa
s_waitcnt vmcnt(13) lgkmcnt(0)
ATT_w0a:
s_barrier
s_cmp_eq_u32 s44, s33
s_cbranch_scc1 ATT_hook
ATT_go:
v_mfma_f32_16x16x32_bf16 v[0:3], a[72:75], a[16:19], v[0:3]
ds_read_b128 a[0:3], v160 offset:0
v_mfma_f32_16x16x32_bf16 v[4:7], a[76:79], a[16:19], v[4:7]
ds_read_b64_tr_b16 a[32:33], v162 offset:0
v_mfma_f32_16x16x32_bf16 v[8:11], a[80:83], a[16:19], v[8:11]
ds_read_b64_tr_b16 a[34:35], v162 offset:1280
v_mfma_f32_16x16x32_bf16 v[12:15], a[84:87], a[16:19], v[12:15]
ds_read_b64_tr_b16 a[36:37], v163 offset:0
v_mfma_f32_16x16x32_bf16 v[16:19], a[88:91], a[16:19], v[16:19]
ds_read_b64_tr_b16 a[38:39], v163 offset:1280
s_add_u32 m0, s48, 0
v_mfma_f32_16x16x32_bf16 v[20:23], a[92:95], a[16:19], v[20:23]
buffer_load_dwordx4 v172, s[8:11], s41 offen lds
ds_read_b64_tr_b16 a[40:41], v164 offset:0
v_mfma_f32_16x16x32_bf16 v[24:27], a[96:99], a[16:19], v[24:27]
ds_read_b64_tr_b16 a[42:43], v164 offset:1280
v_mfma_f32_16x16x32_bf16 v[28:31], a[100:103], a[16:19], v[28:31]
ds_read_b64_tr_b16 a[44:45], v165 offset:0
v_mfma_f32_16x16x32_bf16 v[32:35], a[104:107], a[16:19], v[32:35]
ds_read_b64_tr_b16 a[46:47], v165 offset:1280
v_mfma_f32_16x16x32_bf16 v[36:39], a[108:111], a[16:19], v[36:39]
ds_read_b64_tr_b16 a[48:49], v166 offset:0
v_mfma_f32_16x16x32_bf16 v[40:43], a[72:75], a[20:23], v[40:43]
ds_read_b64_tr_b16 a[50:51], v166 offset:1280
s_add_u32 m0, s49, 0
v_mfma_f32_16x16x32_bf16 v[44:47], a[76:79], a[20:23], v[44:47]
buffer_load_dwordx4 v180, s[12:15], s42 offen lds
ds_read_b64_tr_b16 a[52:53], v167 offset:0
v_mfma_f32_16x16x32_bf16 v[48:51], a[80:83], a[20:23], v[48:51]
ds_read_b64_tr_b16 a[54:55], v167 offset:1280
v_mfma_f32_16x16x32_bf16 v[52:55], a[84:87], a[20:23], v[52:55]
ds_read_b64_tr_b16 a[56:57], v168 offset:0
v_mfma_f32_16x16x32_bf16 v[56:59], a[88:91], a[20:23], v[56:59]
ds_read_b64_tr_b16 a[58:59], v168 offset:1280
v_mfma_f32_16x16x32_bf16 v[60:63], a[92:95], a[20:23], v[60:63]
ds_read_b64_tr_b16 a[60:61], v169 offset:0
s_add_u32 m0, s48, 1024
v_mfma_f32_16x16x32_bf16 v[64:67], a[96:99], a[20:23], v[64:67]
buffer_load_dwordx4 v173, s[8:11], s41 offen lds
ds_read_b64_tr_b16 a[62:63], v169 offset:1280
v_mfma_f32_16x16x32_bf16 v[68:71], a[100:103], a[20:23], v[68:71]
ds_read_b64_tr_b16 a[64:65], v170 offset:0
v_mfma_f32_16x16x32_bf16 v[72:75], a[104:107], a[20:23], v[72:75]
ds_read_b64_tr_b16 a[66:67], v170 offset:1280
v_mfma_f32_16x16x32_bf16 v[76:79], a[108:111], a[20:23], v[76:79]
ds_read_b64_tr_b16 a[68:69], v171 offset:0
v_mfma_f32_16x16x32_bf16 v[80:83], a[72:75], a[24:27], v[80:83]
ds_read_b64_tr_b16 a[70:71], v171 offset:1280
s_add_u32 m0, s49, 1024
v_mfma_f32_16x16x32_bf16 v[84:87], a[76:79], a[24:27], v[84:87]
buffer_load_dwordx4 v181, s[12:15], s42 offen lds
ds_read_b128 a[4:7], v160 offset:2048
v_mfma_f32_16x16x32_bf16 v[88:91], a[80:83], a[24:27], v[88:91]
ds_read_b128 a[8:11], v160 offset:4096
v_mfma_f32_16x16x32_bf16 v[92:95], a[84:87], a[24:27], v[92:95]
ds_read_b128 a[12:15], v160 offset:6144
v_mfma_f32_16x16x32_bf16 v[96:99], a[88:91], a[24:27], v[96:99]
v_mfma_f32_16x16x32_bf16 v[100:103], a[92:95], a[24:27], v[100:103]
v_mfma_f32_16x16x32_bf16 v[104:107], a[96:99], a[24:27], v[104:107]
s_add_u32 m0, s48, 2048
v_mfma_f32_16x16x32_bf16 v[108:111], a[100:103], a[24:27], v[108:111]
buffer_load_dwordx4 v174, s[8:11], s41 offen lds
v_mfma_f32_16x16x32_bf16 v[112:115], a[104:107], a[24:27], v[112:115]
v_mfma_f32_16x16x32_bf16 v[116:119], a[108:111], a[24:27], v[116:119]
v_mfma_f32_16x16x32_bf16 v[120:123], a[72:75], a[28:31], v[120:123]
v_mfma_f32_16x16x32_bf16 v[124:127], a[76:79], a[28:31], v[124:127]
s_add_u32 m0, s48, 3072
v_mfma_f32_16x16x32_bf16 v[128:131], a[80:83], a[28:31], v[128:131]
buffer_load_dwordx4 v175, s[8:11], s41 offen lds
v_mfma_f32_16x16x32_bf16 v[132:135], a[84:87], a[28:31], v[132:135]
v_mfma_f32_16x16x32_bf16 v[136:139], a[88:91], a[28:31], v[136:139]
v_mfma_f32_16x16x32_bf16 v[140:143], a[92:95], a[28:31], v[140:143]
v_mfma_f32_16x16x32_bf16 v[144:147], a[96:99], a[28:31], v[144:147]
v_mfma_f32_16x16x32_bf16 v[148:151], a[100:103], a[28:31], v[148:151]
s_add_u32 s44, s44, 1
v_mfma_f32_16x16x32_bf16 v[152:155], a[104:107], a[28:31], v[152:155]
v_mfma_f32_16x16x32_bf16 v[156:159], a[108:111], a[28:31], v[156:159]
s_cmp_lt_u32 s44, 7
s_waitcnt lgkmcnt(0)
s_cbranch_scc1 ATT_loop
v_mfma_f32_16x16x32_bf16 v[0:3], a[32:35], a[0:3], v[0:3]
ds_read_b128 a[16:19], v161 offset:0
v_mfma_f32_16x16x32_bf16 v[4:7], a[36:39], a[0:3], v[4:7]
ds_read_b64_tr_b16 a[72:73], v162 offset:10240
s_add_u32 s46, s45, 53248
v_mfma_f32_16x16x32_bf16 v[8:11], a[40:43], a[0:3], v[8:11]
ds_read_b64_tr_b16 a[74:75], v162 offset:11520
v_mfma_f32_16x16x32_bf16 v[12:15], a[44:47], a[0:3], v[12:15]
ds_read_b64_tr_b16 a[76:77], v163 offset:10240
s_cmp_ge_u32 s46, 159744
s_cselect_b32 s47, 159744, 0
v_mfma_f32_16x16x32_bf16 v[16:19], a[48:51], a[0:3], v[16:19]
ds_read_b64_tr_b16 a[78:79], v163 offset:11520
s_add_u32 m0, s49, 2048
v_mfma_f32_16x16x32_bf16 v[20:23], a[52:55], a[0:3], v[20:23]
buffer_load_dwordx4 v182, s[12:15], s42 offen lds
ds_read_b64_tr_b16 a[80:81], v164 offset:10240
v_mfma_f32_16x16x32_bf16 v[24:27], a[56:59], a[0:3], v[24:27]
ds_read_b64_tr_b16 a[82:83], v164 offset:11520
s_sub_u32 s46, s46, s47
v_mfma_f32_16x16x32_bf16 v[28:31], a[60:63], a[0:3], v[28:31]
ds_read_b64_tr_b16 a[84:85], v165 offset:10240
v_mfma_f32_16x16x32_bf16 v[32:35], a[64:67], a[0:3], v[32:35]
ds_read_b64_tr_b16 a[86:87], v165 offset:11520
s_add_u32 m0, s48, 4096
s_sub_u32 s47, s46, s45
v_mfma_f32_16x16x32_bf16 v[36:39], a[68:71], a[0:3], v[36:39]
buffer_load_dwordx4 v176, s[8:11], s41 offen lds
ds_read_b64_tr_b16 a[88:89], v166 offset:10240
v_mfma_f32_16x16x32_bf16 v[40:43], a[32:35], a[4:7], v[40:43]
ds_read_b64_tr_b16 a[90:91], v166 offset:11520
s_mov_b32 s45, s46
v_mfma_f32_16x16x32_bf16 v[44:47], a[36:39], a[4:7], v[44:47]
ds_read_b64_tr_b16 a[92:93], v167 offset:10240
v_mfma_f32_16x16x32_bf16 v[48:51], a[40:43], a[4:7], v[48:51]
ds_read_b64_tr_b16 a[94:95], v167 offset:11520
v_mfma_f32_16x16x32_bf16 v[52:55], a[44:47], a[4:7], v[52:55]
ds_read_b64_tr_b16 a[96:97], v168 offset:10240
s_add_u32 m0, s48, 5120
v_mfma_f32_16x16x32_bf16 v[56:59], a[48:51], a[4:7], v[56:59]
buffer_load_dwordx4 v177, s[8:11], s41 offen lds
ds_read_b64_tr_b16 a[98:99], v168 offset:11520
v_mfma_f32_16x16x32_bf16 v[60:63], a[52:55], a[4:7], v[60:63]
ds_read_b64_tr_b16 a[100:101], v169 offset:10240
v_mfma_f32_16x16x32_bf16 v[64:67], a[56:59], a[4:7], v[64:67]
ds_read_b64_tr_b16 a[102:103], v169 offset:11520
v_mfma_f32_16x16x32_bf16 v[68:71], a[60:63], a[4:7], v[68:71]
ds_read_b64_tr_b16 a[104:105], v170 offset:10240
v_mfma_f32_16x16x32_bf16 v[72:75], a[64:67], a[4:7], v[72:75]
ds_read_b64_tr_b16 a[106:107], v170 offset:11520
s_add_u32 m0, s49, 3072
v_mfma_f32_16x16x32_bf16 v[76:79], a[68:71], a[4:7], v[76:79]
buffer_load_dwordx4 v183, s[12:15], s42 offen lds
ds_read_b64_tr_b16 a[108:109], v171 offset:10240
v_mfma_f32_16x16x32_bf16 v[80:83], a[32:35], a[8:11], v[80:83]
ds_read_b64_tr_b16 a[110:111], v171 offset:11520
v_mfma_f32_16x16x32_bf16 v[84:87], a[36:39], a[8:11], v[84:87]
ds_read_b128 a[20:23], v161 offset:2048
v_mfma_f32_16x16x32_bf16 v[88:91], a[40:43], a[8:11], v[88:91]
ds_read_b128 a[24:27], v161 offset:4096
s_add_u32 m0, s48, 6144
v_mfma_f32_16x16x32_bf16 v[92:95], a[44:47], a[8:11], v[92:95]
buffer_load_dwordx4 v178, s[8:11], s41 offen lds
ds_read_b128 a[28:31], v161 offset:6144
v_mfma_f32_16x16x32_bf16 v[96:99], a[48:51], a[8:11], v[96:99]
v_mfma_f32_16x16x32_bf16 v[100:103], a[52:55], a[8:11], v[100:103]
v_add_u32 v160, s47, v160
v_mfma_f32_16x16x32_bf16 v[104:107], a[56:59], a[8:11], v[104:107]
v_add_u32 v161, s47, v161
v_mfma_f32_16x16x32_bf16 v[108:111], a[60:63], a[8:11], v[108:111]
s_add_u32 m0, s49, 4096
v_mfma_f32_16x16x32_bf16 v[112:115], a[64:67], a[8:11], v[112:115]
buffer_load_dwordx4 v184, s[12:15], s42 offen lds
v_add_u32 v162, s47, v162
v_mfma_f32_16x16x32_bf16 v[116:119], a[68:71], a[8:11], v[116:119]
v_add_u32 v163, s47, v163
v_mfma_f32_16x16x32_bf16 v[120:123], a[32:35], a[12:15], v[120:123]
v_add_u32 v164, s47, v164
v_mfma_f32_16x16x32_bf16 v[124:127], a[36:39], a[12:15], v[124:127]
s_add_u32 m0, s48, 7168
v_add_u32 v165, s47, v165
v_mfma_f32_16x16x32_bf16 v[128:131], a[40:43], a[12:15], v[128:131]
buffer_load_dwordx4 v179, s[8:11], s41 offen lds
v_add_u32 v166, s47, v166
v_mfma_f32_16x16x32_bf16 v[132:135], a[44:47], a[12:15], v[132:135]
v_add_u32 v167, s47, v167
v_mfma_f32_16x16x32_bf16 v[136:139], a[48:51], a[12:15], v[136:139]
v_mfma_f32_16x16x32_bf16 v[140:143], a[52:55], a[12:15], v[140:143]
v_add_u32 v168, s47, v168
v_mfma_f32_16x16x32_bf16 v[144:147], a[56:59], a[12:15], v[144:147]
v_add_u32 v169, s47, v169
v_mfma_f32_16x16x32_bf16 v[148:151], a[60:63], a[12:15], v[148:151]
v_add_u32 v170, s47, v170
v_mfma_f32_16x16x32_bf16 v[152:155], a[64:67], a[12:15], v[152:155]
v_add_u32 v171, s47, v171
v_mfma_f32_16x16x32_bf16 v[156:159], a[68:71], a[12:15], v[156:159]
s_cmp_eq_u32 s52, 0
s_cbranch_scc0 ATT_wxb
s_waitcnt vmcnt(13) lgkmcnt(0)
ATT_w0b:
s_cmp_eq_u32 s24, 0
s_cbranch_scc1 ATT_chk
ATT_bar7:
s_barrier
s_lshl_b32 s30, s24, 6
s_add_u32 s30, s30, s27
v_and_b32 v186, 15, v255
v_add_u32 v186, s30, v186
v_lshlrev_b32 v186, 3, v186
v_lshrrev_b32 v187, 4, v255
v_mul_u32_u24 v187, 80, v187
s_lshl_b32 s60, s28, 2
s_add_u32 s60, s60, 16384
s_lshl_b32 s61, s29, 2
s_add_u32 s61, s61, 16384
s_add_u32 s62, s60, 19968
s_add_u32 s63, s61, 19968
v_mfma_f32_16x16x32_bf16 v[0:3], a[72:75], a[16:19], v[0:3]
ds_read_b128 a[0:3], v160 offset:0
v_mfma_f32_16x16x32_bf16 v[4:7], a[76:79], a[16:19], v[4:7]
ds_read_b64_tr_b16 a[32:33], v162 offset:0
v_mfma_f32_16x16x32_bf16 v[8:11], a[80:83], a[16:19], v[8:11]
ds_read_b64_tr_b16 a[34:35], v162 offset:1280
v_mfma_f32_16x16x32_bf16 v[12:15], a[84:87], a[16:19], v[12:15]
ds_read_b64_tr_b16 a[36:37], v163 offset:0
v_mfma_f32_16x16x32_bf16 v[16:19], a[88:91], a[16:19], v[16:19]
ds_read_b64_tr_b16 a[38:39], v163 offset:1280
buffer_load_dwordx2 v[246:247], v186, s[20:23], 0 offen offset:0 sc1
v_mfma_f32_16x16x32_bf16 v[20:23], a[92:95], a[16:19], v[20:23]
ds_read_b64_tr_b16 a[40:41], v164 offset:0
v_mfma_f32_16x16x32_bf16 v[24:27], a[96:99], a[16:19], v[24:27]
ds_read_b64_tr_b16 a[42:43], v164 offset:1280
v_mfma_f32_16x16x32_bf16 v[28:31], a[100:103], a[16:19], v[28:31]
ds_read_b64_tr_b16 a[44:45], v165 offset:0
v_mfma_f32_16x16x32_bf16 v[32:35], a[104:107], a[16:19], v[32:35]
ds_read_b64_tr_b16 a[46:47], v165 offset:1280
v_mfma_f32_16x16x32_bf16 v[36:39], a[108:111], a[16:19], v[36:39]
ds_read_b64_tr_b16 a[48:49], v166 offset:0
v_mfma_f32_16x16x32_bf16 v[40:43], a[72:75], a[20:23], v[40:43]
ds_read_b64_tr_b16 a[50:51], v166 offset:1280
buffer_load_dwordx2 v[248:249], v186, s[20:23], 0 offen offset:128 sc1
v_mfma_f32_16x16x32_bf16 v[44:47], a[76:79], a[20:23], v[44:47]
ds_read_b64_tr_b16 a[52:53], v167 offset:0
v_mfma_f32_16x16x32_bf16 v[48:51], a[80:83], a[20:23], v[48:51]
ds_read_b64_tr_b16 a[54:55], v167 offset:1280
v_mfma_f32_16x16x32_bf16 v[52:55], a[84:87], a[20:23], v[52:55]
ds_read_b64_tr_b16 a[56:57], v168 offset:0
v_mfma_f32_16x16x32_bf16 v[56:59], a[88:91], a[20:23], v[56:59]
ds_read_b64_tr_b16 a[58:59], v168 offset:1280
v_mfma_f32_16x16x32_bf16 v[60:63], a[92:95], a[20:23], v[60:63]
ds_read_b64_tr_b16 a[60:61], v169 offset:0
v_mfma_f32_16x16x32_bf16 v[64:67], a[96:99], a[20:23], v[64:67]
ds_read_b64_tr_b16 a[62:63], v169 offset:1280
buffer_load_dwordx2 v[250:251], v186, s[20:23], 0 offen offset:256 sc1
v_mfma_f32_16x16x32_bf16 v[68:71], a[100:103], a[20:23], v[68:71]
ds_read_b64_tr_b16 a[64:65], v170 offset:0
v_mfma_f32_16x16x32_bf16 v[72:75], a[104:107], a[20:23], v[72:75]
ds_read_b64_tr_b16 a[66:67], v170 offset:1280
v_mfma_f32_16x16x32_bf16 v[76:79], a[108:111], a[20:23], v[76:79]
ds_read_b64_tr_b16 a[68:69], v171 offset:0
v_mfma_f32_16x16x32_bf16 v[80:83], a[72:75], a[24:27], v[80:83]
ds_read_b64_tr_b16 a[70:71], v171 offset:1280
v_mfma_f32_16x16x32_bf16 v[84:87], a[76:79], a[24:27], v[84:87]
ds_read_b128 a[4:7], v160 offset:2048
buffer_load_dwordx2 v[252:253], v186, s[20:23], 0 offen offset:384 sc1
v_mfma_f32_16x16x32_bf16 v[88:91], a[80:83], a[24:27], v[88:91]
ds_read_b128 a[8:11], v160 offset:4096
v_mfma_f32_16x16x32_bf16 v[92:95], a[84:87], a[24:27], v[92:95]
ds_read_b128 a[12:15], v160 offset:6144
v_mfma_f32_16x16x32_bf16 v[96:99], a[88:91], a[24:27], v[96:99]
v_mfma_f32_16x16x32_bf16 v[100:103], a[92:95], a[24:27], v[100:103]
v_mfma_f32_16x16x32_bf16 v[104:107], a[96:99], a[24:27], v[104:107]
v_mfma_f32_16x16x32_bf16 v[108:111], a[100:103], a[24:27], v[108:111]
buffer_load_dwordx4 a[172:175], v187, s[20:23], s60 offen offset:0 sc1
v_mfma_f32_16x16x32_bf16 v[112:115], a[104:107], a[24:27], v[112:115]
v_mfma_f32_16x16x32_bf16 v[116:119], a[108:111], a[24:27], v[116:119]
v_mfma_f32_16x16x32_bf16 v[120:123], a[72:75], a[28:31], v[120:123]
v_mfma_f32_16x16x32_bf16 v[124:127], a[76:79], a[28:31], v[124:127]
v_mfma_f32_16x16x32_bf16 v[128:131], a[80:83], a[28:31], v[128:131]
v_mfma_f32_16x16x32_bf16 v[132:135], a[84:87], a[28:31], v[132:135]
buffer_load_dwordx4 a[176:179], v187, s[20:23], s60 offen offset:16 sc1
v_mfma_f32_16x16x32_bf16 v[136:139], a[88:91], a[28:31], v[136:139]
v_mfma_f32_16x16x32_bf16 v[140:143], a[92:95], a[28:31], v[140:143]
v_mfma_f32_16x16x32_bf16 v[144:147], a[96:99], a[28:31], v[144:147]
v_mfma_f32_16x16x32_bf16 v[148:151], a[100:103], a[28:31], v[148:151]
v_mfma_f32_16x16x32_bf16 v[152:155], a[104:107], a[28:31], v[152:155]
v_mfma_f32_16x16x32_bf16 v[156:159], a[108:111], a[28:31], v[156:159]
s_waitcnt lgkmcnt(0)
v_mfma_f32_16x16x32_bf16 v[0:3], a[32:35], a[0:3], v[0:3]
ds_read_b128 a[16:19], v161 offset:0
v_mfma_f32_16x16x32_bf16 v[4:7], a[36:39], a[0:3], v[4:7]
ds_read_b64_tr_b16 a[72:73], v162 offset:10240
s_add_u32 s46, s45, 53248
v_mfma_f32_16x16x32_bf16 v[8:11], a[40:43], a[0:3], v[8:11]
ds_read_b64_tr_b16 a[74:75], v162 offset:11520
v_mfma_f32_16x16x32_bf16 v[12:15], a[44:47], a[0:3], v[12:15]
ds_read_b64_tr_b16 a[76:77], v163 offset:10240
s_cmp_ge_u32 s46, 159744
s_cselect_b32 s47, 159744, 0
v_mfma_f32_16x16x32_bf16 v[16:19], a[48:51], a[0:3], v[16:19]
ds_read_b64_tr_b16 a[78:79], v163 offset:11520
buffer_load_dwordx4 a[180:183], v187, s[20:23], s60 offen offset:32 sc1
v_mfma_f32_16x16x32_bf16 v[20:23], a[52:55], a[0:3], v[20:23]
ds_read_b64_tr_b16 a[80:81], v164 offset:10240
v_mfma_f32_16x16x32_bf16 v[24:27], a[56:59], a[0:3], v[24:27]
ds_read_b64_tr_b16 a[82:83], v164 offset:11520
s_sub_u32 s46, s46, s47
v_mfma_f32_16x16x32_bf16 v[28:31], a[60:63], a[0:3], v[28:31]
ds_read_b64_tr_b16 a[84:85], v165 offset:10240
v_mfma_f32_16x16x32_bf16 v[32:35], a[64:67], a[0:3], v[32:35]
ds_read_b64_tr_b16 a[86:87], v165 offset:11520
s_sub_u32 s47, s46, s45
v_mfma_f32_16x16x32_bf16 v[36:39], a[68:71], a[0:3], v[36:39]
ds_read_b64_tr_b16 a[88:89], v166 offset:10240
buffer_load_dwordx4 a[184:187], v187, s[20:23], s60 offen offset:48 sc1
v_mfma_f32_16x16x32_bf16 v[40:43], a[32:35], a[4:7], v[40:43]
ds_read_b64_tr_b16 a[90:91], v166 offset:11520
s_mov_b32 s45, s46
v_mfma_f32_16x16x32_bf16 v[44:47], a[36:39], a[4:7], v[44:47]
ds_read_b64_tr_b16 a[92:93], v167 offset:10240
v_mfma_f32_16x16x32_bf16 v[48:51], a[40:43], a[4:7], v[48:51]
ds_read_b64_tr_b16 a[94:95], v167 offset:11520
v_mfma_f32_16x16x32_bf16 v[52:55], a[44:47], a[4:7], v[52:55]
ds_read_b64_tr_b16 a[96:97], v168 offset:10240
v_mfma_f32_16x16x32_bf16 v[56:59], a[48:51], a[4:7], v[56:59]
ds_read_b64_tr_b16 a[98:99], v168 offset:11520
buffer_load_dwordx4 a[188:191], v187, s[20:23], s60 offen offset:64 sc1
v_mfma_f32_16x16x32_bf16 v[60:63], a[52:55], a[4:7], v[60:63]
ds_read_b64_tr_b16 a[100:101], v169 offset:10240
v_mfma_f32_16x16x32_bf16 v[64:67], a[56:59], a[4:7], v[64:67]
ds_read_b64_tr_b16 a[102:103], v169 offset:11520
v_mfma_f32_16x16x32_bf16 v[68:71], a[60:63], a[4:7], v[68:71]
ds_read_b64_tr_b16 a[104:105], v170 offset:10240
v_mfma_f32_16x16x32_bf16 v[72:75], a[64:67], a[4:7], v[72:75]
ds_read_b64_tr_b16 a[106:107], v170 offset:11520
v_mfma_f32_16x16x32_bf16 v[76:79], a[68:71], a[4:7], v[76:79]
ds_read_b64_tr_b16 a[108:109], v171 offset:10240
buffer_load_dwordx4 a[192:195], v187, s[20:23], s61 offen offset:0 sc1
v_mfma_f32_16x16x32_bf16 v[80:83], a[32:35], a[8:11], v[80:83]
ds_read_b64_tr_b16 a[110:111], v171 offset:11520
v_mfma_f32_16x16x32_bf16 v[84:87], a[36:39], a[8:11], v[84:87]
ds_read_b128 a[20:23], v161 offset:2048
v_mfma_f32_16x16x32_bf16 v[88:91], a[40:43], a[8:11], v[88:91]
ds_read_b128 a[24:27], v161 offset:4096
v_mfma_f32_16x16x32_bf16 v[92:95], a[44:47], a[8:11], v[92:95]
ds_read_b128 a[28:31], v161 offset:6144
buffer_load_dwordx4 a[196:199], v187, s[20:23], s61 offen offset:16 sc1
v_mfma_f32_16x16x32_bf16 v[96:99], a[48:51], a[8:11], v[96:99]
v_mfma_f32_16x16x32_bf16 v[100:103], a[52:55], a[8:11], v[100:103]
v_add_u32 v160, s47, v160
v_mfma_f32_16x16x32_bf16 v[104:107], a[56:59], a[8:11], v[104:107]
v_add_u32 v161, s47, v161
v_mfma_f32_16x16x32_bf16 v[108:111], a[60:63], a[8:11], v[108:111]
v_mfma_f32_16x16x32_bf16 v[112:115], a[64:67], a[8:11], v[112:115]
buffer_load_dwordx4 a[200:203], v187, s[20:23], s61 offen offset:32 sc1
v_add_u32 v162, s47, v162
v_mfma_f32_16x16x32_bf16 v[116:119], a[68:71], a[8:11], v[116:119]
v_add_u32 v163, s47, v163
v_mfma_f32_16x16x32_bf16 v[120:123], a[32:35], a[12:15], v[120:123]
v_add_u32 v164, s47, v164
v_mfma_f32_16x16x32_bf16 v[124:127], a[36:39], a[12:15], v[124:127]
v_add_u32 v165, s47, v165
v_mfma_f32_16x16x32_bf16 v[128:131], a[40:43], a[12:15], v[128:131]
v_add_u32 v166, s47, v166
v_mfma_f32_16x16x32_bf16 v[132:135], a[44:47], a[12:15], v[132:135]
buffer_load_dwordx4 a[204:207], v187, s[20:23], s61 offen offset:48 sc1
v_add_u32 v167, s47, v167
v_mfma_f32_16x16x32_bf16 v[136:139], a[48:51], a[12:15], v[136:139]
v_mfma_f32_16x16x32_bf16 v[140:143], a[52:55], a[12:15], v[140:143]
v_add_u32 v168, s47, v168
v_mfma_f32_16x16x32_bf16 v[144:147], a[56:59], a[12:15], v[144:147]
v_add_u32 v169, s47, v169
v_mfma_f32_16x16x32_bf16 v[148:151], a[60:63], a[12:15], v[148:151]
v_add_u32 v170, s47, v170
v_mfma_f32_16x16x32_bf16 v[152:155], a[64:67], a[12:15], v[152:155]
v_add_u32 v171, s47, v171
v_mfma_f32_16x16x32_bf16 v[156:159], a[68:71], a[12:15], v[156:159]
s_waitcnt vmcnt(13) lgkmcnt(0)
s_barrier
v_mfma_f32_16x16x32_bf16 v[0:3], a[72:75], a[16:19], v[0:3]
ds_read_b128 a[0:3], v160 offset:0
v_mfma_f32_16x16x32_bf16 v[4:7], a[76:79], a[16:19], v[4:7]
ds_read_b64_tr_b16 a[32:33], v162 offset:0
v_mfma_f32_16x16x32_bf16 v[8:11], a[80:83], a[16:19], v[8:11]
ds_read_b64_tr_b16 a[34:35], v162 offset:1280
v_mfma_f32_16x16x32_bf16 v[12:15], a[84:87], a[16:19], v[12:15]
ds_read_b64_tr_b16 a[36:37], v163 offset:0
buffer_load_dwordx4 a[208:211], v187, s[20:23], s61 offen offset:64 sc1
v_mfma_f32_16x16x32_bf16 v[16:19], a[88:91], a[16:19], v[16:19]
ds_read_b64_tr_b16 a[38:39], v163 offset:1280
v_mfma_f32_16x16x32_bf16 v[20:23], a[92:95], a[16:19], v[20:23]
ds_read_b64_tr_b16 a[40:41], v164 offset:0
v_mfma_f32_16x16x32_bf16 v[24:27], a[96:99], a[16:19], v[24:27]
ds_read_b64_tr_b16 a[42:43], v164 offset:1280
buffer_load_dwordx4 a[212:215], v187, s[20:23], s62 offen offset:0 sc1
v_mfma_f32_16x16x32_bf16 v[28:31], a[100:103], a[16:19], v[28:31]
ds_read_b64_tr_b16 a[44:45], v165 offset:0
v_mfma_f32_16x16x32_bf16 v[32:35], a[104:107], a[16:19], v[32:35]
ds_read_b64_tr_b16 a[46:47], v165 offset:1280
v_mfma_f32_16x16x32_bf16 v[36:39], a[108:111], a[16:19], v[36:39]
ds_read_b64_tr_b16 a[48:49], v166 offset:0
buffer_load_dwordx4 a[216:219], v187, s[20:23], s62 offen offset:16 sc1
v_mfma_f32_16x16x32_bf16 v[40:43], a[72:75], a[20:23], v[40:43]
ds_read_b64_tr_b16 a[50:51], v166 offset:1280
v_mfma_f32_16x16x32_bf16 v[44:47], a[76:79], a[20:23], v[44:47]
ds_read_b64_tr_b16 a[52:53], v167 offset:0
v_mfma_f32_16x16x32_bf16 v[48:51], a[80:83], a[20:23], v[48:51]
ds_read_b64_tr_b16 a[54:55], v167 offset:1280
buffer_load_dwordx4 a[220:223], v187, s[20:23], s62 offen offset:32 sc1
v_mfma_f32_16x16x32_bf16 v[52:55], a[84:87], a[20:23], v[52:55]
ds_read_b64_tr_b16 a[56:57], v168 offset:0
v_mfma_f32_16x16x32_bf16 v[56:59], a[88:91], a[20:23], v[56:59]
ds_read_b64_tr_b16 a[58:59], v168 offset:1280
v_mfma_f32_16x16x32_bf16 v[60:63], a[92:95], a[20:23], v[60:63]
ds_read_b64_tr_b16 a[60:61], v169 offset:0
buffer_load_dwordx4 a[224:227], v187, s[20:23], s62 offen offset:48 sc1
v_mfma_f32_16x16x32_bf16 v[64:67], a[96:99], a[20:23], v[64:67]
ds_read_b64_tr_b16 a[62:63], v169 offset:1280
v_mfma_f32_16x16x32_bf16 v[68:71], a[100:103], a[20:23], v[68:71]
ds_read_b64_tr_b16 a[64:65], v170 offset:0
v_mfma_f32_16x16x32_bf16 v[72:75], a[104:107], a[20:23], v[72:75]
ds_read_b64_tr_b16 a[66:67], v170 offset:1280
v_mfma_f32_16x16x32_bf16 v[76:79], a[108:111], a[20:23], v[76:79]
ds_read_b64_tr_b16 a[68:69], v171 offset:0
buffer_load_dwordx4 a[228:231], v187, s[20:23], s62 offen offset:64 sc1
v_mfma_f32_16x16x32_bf16 v[80:83], a[72:75], a[24:27], v[80:83]
ds_read_b64_tr_b16 a[70:71], v171 offset:1280
v_mfma_f32_16x16x32_bf16 v[84:87], a[76:79], a[24:27], v[84:87]
ds_read_b128 a[4:7], v160 offset:2048
v_mfma_f32_16x16x32_bf16 v[88:91], a[80:83], a[24:27], v[88:91]
ds_read_b128 a[8:11], v160 offset:4096
buffer_load_dwordx4 a[232:235], v187, s[20:23], s63 offen offset:0 sc1
v_mfma_f32_16x16x32_bf16 v[92:95], a[84:87], a[24:27], v[92:95]
ds_read_b128 a[12:15], v160 offset:6144
v_mfma_f32_16x16x32_bf16 v[96:99], a[88:91], a[24:27], v[96:99]
v_mfma_f32_16x16x32_bf16 v[100:103], a[92:95], a[24:27], v[100:103]
buffer_load_dwordx4 a[236:239], v187, s[20:23], s63 offen offset:16 sc1
v_mfma_f32_16x16x32_bf16 v[104:107], a[96:99], a[24:27], v[104:107]
v_mfma_f32_16x16x32_bf16 v[108:111], a[100:103], a[24:27], v[108:111]
v_mfma_f32_16x16x32_bf16 v[112:115], a[104:107], a[24:27], v[112:115]
buffer_load_dwordx4 a[240:243], v187, s[20:23], s63 offen offset:32 sc1
v_mfma_f32_16x16x32_bf16 v[116:119], a[108:111], a[24:27], v[116:119]
v_mfma_f32_16x16x32_bf16 v[120:123], a[72:75], a[28:31], v[120:123]
v_mfma_f32_16x16x32_bf16 v[124:127], a[76:79], a[28:31], v[124:127]
buffer_load_dwordx4 a[244:247], v187, s[20:23], s63 offen offset:48 sc1
v_mfma_f32_16x16x32_bf16 v[128:131], a[80:83], a[28:31], v[128:131]
v_mfma_f32_16x16x32_bf16 v[132:135], a[84:87], a[28:31], v[132:135]
v_mfma_f32_16x16x32_bf16 v[136:139], a[88:91], a[28:31], v[136:139]
buffer_load_dwordx4 a[248:251], v187, s[20:23], s63 offen offset:64 sc1
v_mfma_f32_16x16x32_bf16 v[140:143], a[92:95], a[28:31], v[140:143]
v_mfma_f32_16x16x32_bf16 v[144:147], a[96:99], a[28:31], v[144:147]
v_mfma_f32_16x16x32_bf16 v[148:151], a[100:103], a[28:31], v[148:151]
v_mfma_f32_16x16x32_bf16 v[152:155], a[104:107], a[28:31], v[152:155]
v_mfma_f32_16x16x32_bf16 v[156:159], a[108:111], a[28:31], v[156:159]
s_waitcnt lgkmcnt(0)
v_mfma_f32_16x16x32_bf16 v[0:3], a[32:35], a[0:3], v[0:3]
ds_read_b128 a[16:19], v161 offset:0
v_mfma_f32_16x16x32_bf16 v[4:7], a[36:39], a[0:3], v[4:7]
ds_read_b64_tr_b16 a[72:73], v162 offset:10240
s_add_u32 s46, s45, 53248
v_mfma_f32_16x16x32_bf16 v[8:11], a[40:43], a[0:3], v[8:11]
ds_read_b64_tr_b16 a[74:75], v162 offset:11520
v_mfma_f32_16x16x32_bf16 v[12:15], a[44:47], a[0:3], v[12:15]
ds_read_b64_tr_b16 a[76:77], v163 offset:10240
s_cmp_ge_u32 s46, 159744
s_cselect_b32 s47, 159744, 0
v_mfma_f32_16x16x32_bf16 v[16:19], a[48:51], a[0:3], v[16:19]
ds_read_b64_tr_b16 a[78:79], v163 offset:11520
v_mfma_f32_16x16x32_bf16 v[20:23], a[52:55], a[0:3], v[20:23]
ds_read_b64_tr_b16 a[80:81], v164 offset:10240
v_mfma_f32_16x16x32_bf16 v[24:27], a[56:59], a[0:3], v[24:27]
ds_read_b64_tr_b16 a[82:83], v164 offset:11520
s_sub_u32 s46, s46, s47
v_mfma_f32_16x16x32_bf16 v[28:31], a[60:63], a[0:3], v[28:31]
ds_read_b64_tr_b16 a[84:85], v165 offset:10240
v_mfma_f32_16x16x32_bf16 v[32:35], a[64:67], a[0:3], v[32:35]
ds_read_b64_tr_b16 a[86:87], v165 offset:11520
s_sub_u32 s47, s46, s45
v_mfma_f32_16x16x32_bf16 v[36:39], a[68:71], a[0:3], v[36:39]
ds_read_b64_tr_b16 a[88:89], v166 offset:10240
v_mfma_f32_16x16x32_bf16 v[40:43], a[32:35], a[4:7], v[40:43]
ds_read_b64_tr_b16 a[90:91], v166 offset:11520
s_mov_b32 s45, s46
v_mfma_f32_16x16x32_bf16 v[44:47], a[36:39], a[4:7], v[44:47]
ds_read_b64_tr_b16 a[92:93], v167 offset:10240
v_mfma_f32_16x16x32_bf16 v[48:51], a[40:43], a[4:7], v[48:51]
ds_read_b64_tr_b16 a[94:95], v167 offset:11520
v_mfma_f32_16x16x32_bf16 v[52:55], a[44:47], a[4:7], v[52:55]
ds_read_b64_tr_b16 a[96:97], v168 offset:10240
v_mfma_f32_16x16x32_bf16 v[56:59], a[48:51], a[4:7], v[56:59]
ds_read_b64_tr_b16 a[98:99], v168 offset:11520
v_mfma_f32_16x16x32_bf16 v[60:63], a[52:55], a[4:7], v[60:63]
ds_read_b64_tr_b16 a[100:101], v169 offset:10240
v_mfma_f32_16x16x32_bf16 v[64:67], a[56:59], a[4:7], v[64:67]
ds_read_b64_tr_b16 a[102:103], v169 offset:11520
v_mfma_f32_16x16x32_bf16 v[68:71], a[60:63], a[4:7], v[68:71]
ds_read_b64_tr_b16 a[104:105], v170 offset:10240
v_mfma_f32_16x16x32_bf16 v[72:75], a[64:67], a[4:7], v[72:75]
ds_read_b64_tr_b16 a[106:107], v170 offset:11520
v_mfma_f32_16x16x32_bf16 v[76:79], a[68:71], a[4:7], v[76:79]
ds_read_b64_tr_b16 a[108:109], v171 offset:10240
v_mfma_f32_16x16x32_bf16 v[80:83], a[32:35], a[8:11], v[80:83]
ds_read_b64_tr_b16 a[110:111], v171 offset:11520
v_mfma_f32_16x16x32_bf16 v[84:87], a[36:39], a[8:11], v[84:87]
ds_read_b128 a[20:23], v161 offset:2048
v_mfma_f32_16x16x32_bf16 v[88:91], a[40:43], a[8:11], v[88:91]
ds_read_b128 a[24:27], v161 offset:4096
v_mfma_f32_16x16x32_bf16 v[92:95], a[44:47], a[8:11], v[92:95]
ds_read_b128 a[28:31], v161 offset:6144
v_mfma_f32_16x16x32_bf16 v[96:99], a[48:51], a[8:11], v[96:99]
v_mfma_f32_16x16x32_bf16 v[100:103], a[52:55], a[8:11], v[100:103]
v_add_u32 v160, s47, v160
v_mfma_f32_16x16x32_bf16 v[104:107], a[56:59], a[8:11], v[104:107]
v_add_u32 v161, s47, v161
v_mfma_f32_16x16x32_bf16 v[108:111], a[60:63], a[8:11], v[108:111]
v_mfma_f32_16x16x32_bf16 v[112:115], a[64:67], a[8:11], v[112:115]
v_add_u32 v162, s47, v162
v_mfma_f32_16x16x32_bf16 v[116:119], a[68:71], a[8:11], v[116:119]
v_add_u32 v163, s47, v163
v_mfma_f32_16x16x32_bf16 v[120:123], a[32:35], a[12:15], v[120:123]
v_add_u32 v164, s47, v164
v_mfma_f32_16x16x32_bf16 v[124:127], a[36:39], a[12:15], v[124:127]
v_add_u32 v165, s47, v165
v_mfma_f32_16x16x32_bf16 v[128:131], a[40:43], a[12:15], v[128:131]
v_add_u32 v166, s47, v166
v_mfma_f32_16x16x32_bf16 v[132:135], a[44:47], a[12:15], v[132:135]
v_add_u32 v167, s47, v167
v_mfma_f32_16x16x32_bf16 v[136:139], a[48:51], a[12:15], v[136:139]
v_mfma_f32_16x16x32_bf16 v[140:143], a[52:55], a[12:15], v[140:143]
v_add_u32 v168, s47, v168
v_mfma_f32_16x16x32_bf16 v[144:147], a[56:59], a[12:15], v[144:147]
v_add_u32 v169, s47, v169
v_mfma_f32_16x16x32_bf16 v[148:151], a[60:63], a[12:15], v[148:151]
v_add_u32 v170, s47, v170
v_mfma_f32_16x16x32_bf16 v[152:155], a[64:67], a[12:15], v[152:155]
v_add_u32 v171, s47, v171
v_mfma_f32_16x16x32_bf16 v[156:159], a[68:71], a[12:15], v[156:159]
s_waitcnt lgkmcnt(0)
v_mfma_f32_16x16x32_bf16 v[0:3], a[72:75], a[16:19], v[0:3]
v_mfma_f32_16x16x32_bf16 v[4:7], a[76:79], a[16:19], v[4:7]
v_mfma_f32_16x16x32_bf16 v[8:11], a[80:83], a[16:19], v[8:11]
v_mfma_f32_16x16x32_bf16 v[12:15], a[84:87], a[16:19], v[12:15]
v_mfma_f32_16x16x32_bf16 v[16:19], a[88:91], a[16:19], v[16:19]
v_mfma_f32_16x16x32_bf16 v[20:23], a[92:95], a[16:19], v[20:23]
v_mfma_f32_16x16x32_bf16 v[24:27], a[96:99], a[16:19], v[24:27]
v_mfma_f32_16x16x32_bf16 v[28:31], a[100:103], a[16:19], v[28:31]
v_mfma_f32_16x16x32_bf16 v[32:35], a[104:107], a[16:19], v[32:35]
v_mfma_f32_16x16x32_bf16 v[36:39], a[108:111], a[16:19], v[36:39]
v_mfma_f32_16x16x32_bf16 v[40:43], a[72:75], a[20:23], v[40:43]
v_mfma_f32_16x16x32_bf16 v[44:47], a[76:79], a[20:23], v[44:47]
v_mfma_f32_16x16x32_bf16 v[48:51], a[80:83], a[20:23], v[48:51]
v_mfma_f32_16x16x32_bf16 v[52:55], a[84:87], a[20:23], v[52:55]
v_mfma_f32_16x16x32_bf16 v[56:59], a[88:91], a[20:23], v[56:59]
v_mfma_f32_16x16x32_bf16 v[60:63], a[92:95], a[20:23], v[60:63]
v_mfma_f32_16x16x32_bf16 v[64:67], a[96:99], a[20:23], v[64:67]
v_mfma_f32_16x16x32_bf16 v[68:71], a[100:103], a[20:23], v[68:71]
v_mfma_f32_16x16x32_bf16 v[72:75], a[104:107], a[20:23], v[72:75]
v_mfma_f32_16x16x32_bf16 v[76:79], a[108:111], a[20:23], v[76:79]
v_mfma_f32_16x16x32_bf16 v[80:83], a[72:75], a[24:27], v[80:83]
v_mfma_f32_16x16x32_bf16 v[84:87], a[76:79], a[24:27], v[84:87]
v_mfma_f32_16x16x32_bf16 v[88:91], a[80:83], a[24:27], v[88:91]
v_mfma_f32_16x16x32_bf16 v[92:95], a[84:87], a[24:27], v[92:95]
v_mfma_f32_16x16x32_bf16 v[96:99], a[88:91], a[24:27], v[96:99]
v_mfma_f32_16x16x32_bf16 v[100:103], a[92:95], a[24:27], v[100:103]
v_mfma_f32_16x16x32_bf16 v[104:107], a[96:99], a[24:27], v[104:107]
v_mfma_f32_16x16x32_bf16 v[108:111], a[100:103], a[24:27], v[108:111]
v_mfma_f32_16x16x32_bf16 v[112:115], a[104:107], a[24:27], v[112:115]
v_mfma_f32_16x16x32_bf16 v[116:119], a[108:111], a[24:27], v[116:119]
v_mfma_f32_16x16x32_bf16 v[120:123], a[72:75], a[28:31], v[120:123]
v_mfma_f32_16x16x32_bf16 v[124:127], a[76:79], a[28:31], v[124:127]
v_mfma_f32_16x16x32_bf16 v[128:131], a[80:83], a[28:31], v[128:131]
v_mfma_f32_16x16x32_bf16 v[132:135], a[84:87], a[28:31], v[132:135]
v_mfma_f32_16x16x32_bf16 v[136:139], a[88:91], a[28:31], v[136:139]
v_mfma_f32_16x16x32_bf16 v[140:143], a[92:95], a[28:31], v[140:143]
v_mfma_f32_16x16x32_bf16 v[144:147], a[96:99], a[28:31], v[144:147]
v_mfma_f32_16x16x32_bf16 v[148:151], a[100:103], a[28:31], v[148:151]
v_mfma_f32_16x16x32_bf16 v[152:155], a[104:107], a[28:31], v[152:155]
v_mfma_f32_16x16x32_bf16 v[156:159], a[108:111], a[28:31], v[156:159]
s_branch ATT_done
ATT_wxa:
s_cmp_eq_u32 s52, 1
s_cbranch_scc0 ATT_x_901_9
s_waitcnt vmcnt(14) lgkmcnt(0)
s_mov_b32 s52, 0
s_branch ATT_w0a
ATT_x_901_9:
s_waitcnt vmcnt(13) lgkmcnt(0)
s_mov_b32 s52, 0
s_branch ATT_w0a
ATT_wxb:
s_cmp_eq_u32 s52, 1
s_cbranch_scc0 ATT_x_901_10
s_waitcnt vmcnt(14) lgkmcnt(0)
s_mov_b32 s52, 0
s_branch ATT_w0b
ATT_x_901_10:
s_waitcnt vmcnt(13) lgkmcnt(0)
s_mov_b32 s52, 0
s_branch ATT_w0b
ATT_chk:
s_mov_b32 s53, 0
ATT_chk2:
s_mov_b64 exec, 3
v_cmp_ne_u32 vcc, 78, v186
s_mov_b64 exec, -1
s_nop 1
s_cbranch_vccz ATT_bar7
s_add_u32 s53, s53, 1
s_cmp_ge_u32 s53, 0x40000
s_cbranch_scc1 ATT_bar7
s_sleep 8
s_mov_b64 exec, 3
buffer_load_dword v186, v187, s[56:59], 0 offen sc1
s_mov_b64 exec, -1
s_waitcnt vmcnt(0)
s_branch ATT_chk2
ATT_hook:
v_lshlrev_b32 v187, 7, v255
s_mov_b64 exec, 3
buffer_load_dword v186, v187, s[56:59], 0 offen sc1
s_mov_b64 exec, -1
s_mov_b32 s33, 99
s_mov_b32 s52, 1
s_branch ATT_go
ATT_done:
s_nop 7
s_waitcnt vmcnt(0)
s_cmp_eq_u32 s51, 1
s_cbranch_scc1 KV_EPI
v_mov_b32 v236, -1
v_mov_b32 v237, -1
v_mov_b32 v238, -1
v_mov_b32 v239, -1
v_lshlrev_b32 v240, 4, v255
s_and_b32 s30, s2, 7
s_lshl_b32 s30, s30, 2
s_lshr_b32 s31, s2, 3
s_sub_u32 s31, s31, 28
s_add_u32 s30, s30, s31
s_mul_i32 s30, s30, 68
s_add_u32 s30, s30, 48
s_lshl_b32 s30, s30, 12
s_mul_i32 s31, s24, 20480
s_add_u32 s30, s30, s31
s_add_u32 s30, s30, 3145728
buffer_store_dwordx4 v[236:239], v240, s[20:23], s30 offen sc1
s_add_u32 s30, s30, 1024
buffer_store_dwordx4 v[236:239], v240, s[20:23], s30 offen sc1
s_add_u32 s30, s30, 1024
buffer_store_dwordx4 v[236:239], v240, s[20:23], s30 offen sc1
s_add_u32 s30, s30, 1024
buffer_store_dwordx4 v[236:239], v240, s[20:23], s30 offen sc1
s_add_u32 s30, s30, 1024
buffer_store_dwordx4 v[236:239], v240, s[20:23], s30 offen sc1
s_add_u32 s30, s30, 1024
buffer_store_dwordx4 v[236:239], v240, s[20:23], s30 offen sc1
s_add_u32 s30, s30, 1024
buffer_store_dwordx4 v[236:239], v240, s[20:23], s30 offen sc1
s_add_u32 s30, s30, 1024
buffer_store_dwordx4 v[236:239], v240, s[20:23], s30 offen sc1
s_add_u32 s30, s30, 1024
buffer_store_dwordx4 v[236:239], v240, s[20:23], s30 offen sc1
s_add_u32 s30, s30, 1024
buffer_store_dwordx4 v[236:239], v240, s[20:23], s30 offen sc1
s_add_u32 s30, s30, 1024
buffer_store_dwordx4 v[236:239], v240, s[20:23], s30 offen sc1
s_add_u32 s30, s30, 1024
buffer_store_dwordx4 v[236:239], v240, s[20:23], s30 offen sc1
s_add_u32 s30, s30, 1024
buffer_store_dwordx4 v[236:239], v240, s[20:23], s30 offen sc1
s_add_u32 s30, s30, 1024
buffer_store_dwordx4 v[236:239], v240, s[20:23], s30 offen sc1
s_add_u32 s30, s30, 1024
buffer_store_dwordx4 v[236:239], v240, s[20:23], s30 offen sc1
s_add_u32 s30, s30, 1024
buffer_store_dwordx4 v[236:239], v240, s[20:23], s30 offen sc1
s_add_u32 s30, s30, 1024
buffer_store_dwordx4 v[236:239], v240, s[20:23], s30 offen sc1
s_add_u32 s30, s30, 1024
buffer_store_dwordx4 v[236:239], v240, s[20:23], s30 offen sc1
s_add_u32 s30, s30, 1024
buffer_store_dwordx4 v[236:239], v240, s[20:23], s30 offen sc1
s_add_u32 s30, s30, 1024
buffer_store_dwordx4 v[236:239], v240, s[20:23], s30 offen sc1
v_accvgpr_read_b32 v160, a172
v_accvgpr_read_b32 v161, a173
v_accvgpr_read_b32 v162, a174
v_accvgpr_read_b32 v163, a175
v_accvgpr_read_b32 v164, a176
v_accvgpr_read_b32 v165, a177
v_accvgpr_read_b32 v166, a178
v_accvgpr_read_b32 v167, a179
v_accvgpr_read_b32 v168, a180
v_accvgpr_read_b32 v169, a181
v_accvgpr_read_b32 v170, a182
v_accvgpr_read_b32 v171, a183
v_accvgpr_read_b32 v172, a184
v_accvgpr_read_b32 v173, a185
v_accvgpr_read_b32 v174, a186
v_accvgpr_read_b32 v175, a187
v_accvgpr_read_b32 v176, a188
v_accvgpr_read_b32 v177, a189
v_accvgpr_read_b32 v178, a190
v_accvgpr_read_b32 v179, a191
v_accvgpr_read_b32 v180, a192
v_accvgpr_read_b32 v181, a193
v_accvgpr_read_b32 v182, a194
v_accvgpr_read_b32 v183, a195
v_accvgpr_read_b32 v184, a196
v_accvgpr_read_b32 v185, a197
v_accvgpr_read_b32 v186, a198
v_accvgpr_read_b32 v187, a199
v_accvgpr_read_b32 v188, a200
v_accvgpr_read_b32 v189, a201
v_accvgpr_read_b32 v190, a202
v_accvgpr_read_b32 v191, a203
v_accvgpr_read_b32 v192, a204
v_accvgpr_read_b32 v193, a205
v_accvgpr_read_b32 v194, a206
v_accvgpr_read_b32 v195, a207
v_accvgpr_read_b32 v196, a208
v_accvgpr_read_b32 v197, a209
v_accvgpr_read_b32 v198, a210
v_accvgpr_read_b32 v199, a211
v_accvgpr_read_b32 v200, a212
v_accvgpr_read_b32 v201, a213
v_accvgpr_read_b32 v202, a214
v_accvgpr_read_b32 v203, a215
v_accvgpr_read_b32 v204, a216
v_accvgpr_read_b32 v205, a217
v_accvgpr_read_b32 v206, a218
v_accvgpr_read_b32 v207, a219
v_accvgpr_read_b32 v208, a220
v_accvgpr_read_b32 v209, a221
v_accvgpr_read_b32 v210, a222
v_accvgpr_read_b32 v211, a223
v_accvgpr_read_b32 v212, a224
v_accvgpr_read_b32 v213, a225
v_accvgpr_read_b32 v214, a226
v_accvgpr_read_b32 v215, a227
v_accvgpr_read_b32 v216, a228
v_accvgpr_read_b32 v217, a229
v_accvgpr_read_b32 v218, a230
v_accvgpr_read_b32 v219, a231
v_accvgpr_read_b32 v220, a232
v_accvgpr_read_b32 v221, a233
v_accvgpr_read_b32 v222, a234
v_accvgpr_read_b32 v223, a235
v_accvgpr_read_b32 v224, a236
v_accvgpr_read_b32 v225, a237
v_accvgpr_read_b32 v226, a238
v_accvgpr_read_b32 v227, a239
v_accvgpr_read_b32 v228, a240
v_accvgpr_read_b32 v229, a241
v_accvgpr_read_b32 v230, a242
v_accvgpr_read_b32 v231, a243
v_accvgpr_read_b32 v232, a244
v_accvgpr_read_b32 v233, a245
v_accvgpr_read_b32 v234, a246
v_accvgpr_read_b32 v235, a247
v_accvgpr_read_b32 v236, a248
v_accvgpr_read_b32 v237, a249
v_accvgpr_read_b32 v238, a250
v_accvgpr_read_b32 v239, a251
v_pk_add_f32 v[160:161], v[160:161], v[200:201]
v_pk_add_f32 v[162:163], v[162:163], v[202:203]
v_pk_add_f32 v[164:165], v[164:165], v[204:205]
v_pk_add_f32 v[166:167], v[166:167], v[206:207]
v_pk_add_f32 v[168:169], v[168:169], v[208:209]
v_pk_add_f32 v[170:171], v[170:171], v[210:211]
v_pk_add_f32 v[172:173], v[172:173], v[212:213]
v_pk_add_f32 v[174:175], v[174:175], v[214:215]
v_pk_add_f32 v[176:177], v[176:177], v[216:217]
v_pk_add_f32 v[178:179], v[178:179], v[218:219]
v_pk_add_f32 v[180:181], v[180:181], v[220:221]
v_pk_add_f32 v[182:183], v[182:183], v[222:223]
v_pk_add_f32 v[184:185], v[184:185], v[224:225]
v_pk_add_f32 v[186:187], v[186:187], v[226:227]
v_pk_add_f32 v[188:189], v[188:189], v[228:229]
v_pk_add_f32 v[190:191], v[190:191], v[230:231]
v_pk_add_f32 v[192:193], v[192:193], v[232:233]
v_pk_add_f32 v[194:195], v[194:195], v[234:235]
v_pk_add_f32 v[196:197], v[196:197], v[236:237]
v_pk_add_f32 v[198:199], v[198:199], v[238:239]
v_lshrrev_b32 v200, 4, v255
v_and_b32 v201, 15, v255
v_mul_u32_u24 v202, 98304, v200
v_lshlrev_b32 v203, 4, v201
v_add_u32 v204, v202, v203
s_lshl_b32 s30, s25, 4
s_lshl_b32 s31, s24, 2
s_add_u32 s30, s30, s31
s_lshl_b32 s31, s26, 3
v_sub_f32 v208, 0, v246
v_mov_b32 v210, v247
v_pk_fma_f32 v[0:1], v[160:161], v[208:209], v[0:1] op_sel_hi:[1,0,1]
v_pk_fma_f32 v[20:21], v[180:181], v[208:209], v[20:21] op_sel_hi:[1,0,1]
v_pk_fma_f32 v[2:3], v[162:163], v[208:209], v[2:3] op_sel_hi:[1,0,1]
v_pk_fma_f32 v[22:23], v[182:183], v[208:209], v[22:23] op_sel_hi:[1,0,1]
v_pk_fma_f32 v[4:5], v[164:165], v[208:209], v[4:5] op_sel_hi:[1,0,1]
v_pk_fma_f32 v[24:25], v[184:185], v[208:209], v[24:25] op_sel_hi:[1,0,1]
v_pk_fma_f32 v[6:7], v[166:167], v[208:209], v[6:7] op_sel_hi:[1,0,1]
v_pk_fma_f32 v[26:27], v[186:187], v[208:209], v[26:27] op_sel_hi:[1,0,1]
v_pk_fma_f32 v[8:9], v[168:169], v[208:209], v[8:9] op_sel_hi:[1,0,1]
v_pk_fma_f32 v[28:29], v[188:189], v[208:209], v[28:29] op_sel_hi:[1,0,1]
v_pk_fma_f32 v[10:11], v[170:171], v[208:209], v[10:11] op_sel_hi:[1,0,1]
v_pk_fma_f32 v[30:31], v[190:191], v[208:209], v[30:31] op_sel_hi:[1,0,1]
v_pk_fma_f32 v[12:13], v[172:173], v[208:209], v[12:13] op_sel_hi:[1,0,1]
v_pk_fma_f32 v[32:33], v[192:193], v[208:209], v[32:33] op_sel_hi:[1,0,1]
v_pk_fma_f32 v[14:15], v[174:175], v[208:209], v[14:15] op_sel_hi:[1,0,1]
v_pk_fma_f32 v[34:35], v[194:195], v[208:209], v[34:35] op_sel_hi:[1,0,1]
v_pk_fma_f32 v[16:17], v[176:177], v[208:209], v[16:17] op_sel_hi:[1,0,1]
v_pk_fma_f32 v[36:37], v[196:197], v[208:209], v[36:37] op_sel_hi:[1,0,1]
v_pk_fma_f32 v[18:19], v[178:179], v[208:209], v[18:19] op_sel_hi:[1,0,1]
v_pk_fma_f32 v[38:39], v[198:199], v[208:209], v[38:39] op_sel_hi:[1,0,1]
v_pk_mul_f32 v[0:1], v[0:1], v[210:211] op_sel_hi:[1,0]
v_pk_mul_f32 v[20:21], v[20:21], v[210:211] op_sel_hi:[1,0]
v_pk_mul_f32 v[2:3], v[2:3], v[210:211] op_sel_hi:[1,0]
v_pk_mul_f32 v[22:23], v[22:23], v[210:211] op_sel_hi:[1,0]
v_pk_mul_f32 v[4:5], v[4:5], v[210:211] op_sel_hi:[1,0]
v_pk_mul_f32 v[24:25], v[24:25], v[210:211] op_sel_hi:[1,0]
v_pk_mul_f32 v[6:7], v[6:7], v[210:211] op_sel_hi:[1,0]
v_pk_mul_f32 v[26:27], v[26:27], v[210:211] op_sel_hi:[1,0]
v_pk_mul_f32 v[8:9], v[8:9], v[210:211] op_sel_hi:[1,0]
v_pk_mul_f32 v[28:29], v[28:29], v[210:211] op_sel_hi:[1,0]
v_pk_mul_f32 v[10:11], v[10:11], v[210:211] op_sel_hi:[1,0]
v_pk_mul_f32 v[30:31], v[30:31], v[210:211] op_sel_hi:[1,0]
v_pk_mul_f32 v[12:13], v[12:13], v[210:211] op_sel_hi:[1,0]
v_pk_mul_f32 v[32:33], v[32:33], v[210:211] op_sel_hi:[1,0]
v_pk_mul_f32 v[14:15], v[14:15], v[210:211] op_sel_hi:[1,0]
v_pk_mul_f32 v[34:35], v[34:35], v[210:211] op_sel_hi:[1,0]
v_pk_mul_f32 v[16:17], v[16:17], v[210:211] op_sel_hi:[1,0]
v_pk_mul_f32 v[36:37], v[36:37], v[210:211] op_sel_hi:[1,0]
v_pk_mul_f32 v[18:19], v[18:19], v[210:211] op_sel_hi:[1,0]
v_pk_mul_f32 v[38:39], v[38:39], v[210:211] op_sel_hi:[1,0]
v_cvt_pk_bf16_f32 v0, v0, v1
v_cvt_pk_bf16_f32 v20, v20, v21
v_cvt_pk_bf16_f32 v1, v2, v3
v_cvt_pk_bf16_f32 v21, v22, v23
v_cvt_pk_bf16_f32 v2, v4, v5
v_cvt_pk_bf16_f32 v22, v24, v25
v_cvt_pk_bf16_f32 v3, v6, v7
v_cvt_pk_bf16_f32 v23, v26, v27
v_cvt_pk_bf16_f32 v4, v8, v9
v_cvt_pk_bf16_f32 v24, v28, v29
v_cvt_pk_bf16_f32 v5, v10, v11
v_cvt_pk_bf16_f32 v25, v30, v31
v_cvt_pk_bf16_f32 v6, v12, v13
v_cvt_pk_bf16_f32 v26, v32, v33
v_cvt_pk_bf16_f32 v7, v14, v15
v_cvt_pk_bf16_f32 v27, v34, v35
v_cvt_pk_bf16_f32 v8, v16, v17
v_cvt_pk_bf16_f32 v28, v36, v37
v_cvt_pk_bf16_f32 v9, v18, v19
v_cvt_pk_bf16_f32 v29, v38, v39
v_mov_b32 v10, 0
v_mov_b32 v30, 0
v_mov_b32 v11, 0
v_mov_b32 v31, 0
s_add_u32 s60, s31, 0
s_add_u32 s61, s31, 4
s_lshl_b32 s60, s60, 7
s_lshl_b32 s61, s61, 7
s_add_u32 s60, s60, s30
s_add_u32 s61, s61, s30
s_add_u32 s60, s60, 0
s_add_u32 s61, s61, 0
s_mul_i32 s60, s60, 768
s_mul_i32 s61, s61, 768
s_add_u32 s60, s60, 12582912
s_add_u32 s61, s61, 12582912
buffer_store_dwordx4 v[0:3], v204, s[20:23], s60 offen sc1
buffer_store_dwordx4 v[20:23], v204, s[20:23], s61 offen sc1
buffer_store_dwordx4 v[4:7], v204, s[20:23], s60 offen offset:256 sc1
buffer_store_dwordx4 v[24:27], v204, s[20:23], s61 offen offset:256 sc1
buffer_store_dwordx4 v[8:11], v204, s[20:23], s60 offen offset:512 sc1
buffer_store_dwordx4 v[28:31], v204, s[20:23], s61 offen offset:512 sc1
v_sub_f32 v208, 0, v248
v_mov_b32 v210, v249
v_pk_fma_f32 v[40:41], v[160:161], v[208:209], v[40:41] op_sel_hi:[1,0,1]
v_pk_fma_f32 v[60:61], v[180:181], v[208:209], v[60:61] op_sel_hi:[1,0,1]
v_pk_fma_f32 v[42:43], v[162:163], v[208:209], v[42:43] op_sel_hi:[1,0,1]
v_pk_fma_f32 v[62:63], v[182:183], v[208:209], v[62:63] op_sel_hi:[1,0,1]
v_pk_fma_f32 v[44:45], v[164:165], v[208:209], v[44:45] op_sel_hi:[1,0,1]
v_pk_fma_f32 v[64:65], v[184:185], v[208:209], v[64:65] op_sel_hi:[1,0,1]
v_pk_fma_f32 v[46:47], v[166:167], v[208:209], v[46:47] op_sel_hi:[1,0,1]
v_pk_fma_f32 v[66:67], v[186:187], v[208:209], v[66:67] op_sel_hi:[1,0,1]
v_pk_fma_f32 v[48:49], v[168:169], v[208:209], v[48:49] op_sel_hi:[1,0,1]
v_pk_fma_f32 v[68:69], v[188:189], v[208:209], v[68:69] op_sel_hi:[1,0,1]
v_pk_fma_f32 v[50:51], v[170:171], v[208:209], v[50:51] op_sel_hi:[1,0,1]
v_pk_fma_f32 v[70:71], v[190:191], v[208:209], v[70:71] op_sel_hi:[1,0,1]
v_pk_fma_f32 v[52:53], v[172:173], v[208:209], v[52:53] op_sel_hi:[1,0,1]
v_pk_fma_f32 v[72:73], v[192:193], v[208:209], v[72:73] op_sel_hi:[1,0,1]
v_pk_fma_f32 v[54:55], v[174:175], v[208:209], v[54:55] op_sel_hi:[1,0,1]
v_pk_fma_f32 v[74:75], v[194:195], v[208:209], v[74:75] op_sel_hi:[1,0,1]
v_pk_fma_f32 v[56:57], v[176:177], v[208:209], v[56:57] op_sel_hi:[1,0,1]
v_pk_fma_f32 v[76:77], v[196:197], v[208:209], v[76:77] op_sel_hi:[1,0,1]
v_pk_fma_f32 v[58:59], v[178:179], v[208:209], v[58:59] op_sel_hi:[1,0,1]
v_pk_fma_f32 v[78:79], v[198:199], v[208:209], v[78:79] op_sel_hi:[1,0,1]
v_pk_mul_f32 v[40:41], v[40:41], v[210:211] op_sel_hi:[1,0]
v_pk_mul_f32 v[60:61], v[60:61], v[210:211] op_sel_hi:[1,0]
v_pk_mul_f32 v[42:43], v[42:43], v[210:211] op_sel_hi:[1,0]
v_pk_mul_f32 v[62:63], v[62:63], v[210:211] op_sel_hi:[1,0]
v_pk_mul_f32 v[44:45], v[44:45], v[210:211] op_sel_hi:[1,0]
v_pk_mul_f32 v[64:65], v[64:65], v[210:211] op_sel_hi:[1,0]
v_pk_mul_f32 v[46:47], v[46:47], v[210:211] op_sel_hi:[1,0]
v_pk_mul_f32 v[66:67], v[66:67], v[210:211] op_sel_hi:[1,0]
v_pk_mul_f32 v[48:49], v[48:49], v[210:211] op_sel_hi:[1,0]
v_pk_mul_f32 v[68:69], v[68:69], v[210:211] op_sel_hi:[1,0]
v_pk_mul_f32 v[50:51], v[50:51], v[210:211] op_sel_hi:[1,0]
v_pk_mul_f32 v[70:71], v[70:71], v[210:211] op_sel_hi:[1,0]
v_pk_mul_f32 v[52:53], v[52:53], v[210:211] op_sel_hi:[1,0]
v_pk_mul_f32 v[72:73], v[72:73], v[210:211] op_sel_hi:[1,0]
v_pk_mul_f32 v[54:55], v[54:55], v[210:211] op_sel_hi:[1,0]
v_pk_mul_f32 v[74:75], v[74:75], v[210:211] op_sel_hi:[1,0]
v_pk_mul_f32 v[56:57], v[56:57], v[210:211] op_sel_hi:[1,0]
v_pk_mul_f32 v[76:77], v[76:77], v[210:211] op_sel_hi:[1,0]
v_pk_mul_f32 v[58:59], v[58:59], v[210:211] op_sel_hi:[1,0]
v_pk_mul_f32 v[78:79], v[78:79], v[210:211] op_sel_hi:[1,0]
v_cvt_pk_bf16_f32 v40, v40, v41
v_cvt_pk_bf16_f32 v60, v60, v61
v_cvt_pk_bf16_f32 v41, v42, v43
v_cvt_pk_bf16_f32 v61, v62, v63
v_cvt_pk_bf16_f32 v42, v44, v45
v_cvt_pk_bf16_f32 v62, v64, v65
v_cvt_pk_bf16_f32 v43, v46, v47
v_cvt_pk_bf16_f32 v63, v66, v67
v_cvt_pk_bf16_f32 v44, v48, v49
v_cvt_pk_bf16_f32 v64, v68, v69
v_cvt_pk_bf16_f32 v45, v50, v51
v_cvt_pk_bf16_f32 v65, v70, v71
v_cvt_pk_bf16_f32 v46, v52, v53
v_cvt_pk_bf16_f32 v66, v72, v73
v_cvt_pk_bf16_f32 v47, v54, v55
v_cvt_pk_bf16_f32 v67, v74, v75
v_cvt_pk_bf16_f32 v48, v56, v57
v_cvt_pk_bf16_f32 v68, v76, v77
v_cvt_pk_bf16_f32 v49, v58, v59
v_cvt_pk_bf16_f32 v69, v78, v79
v_mov_b32 v50, 0
v_mov_b32 v70, 0
v_mov_b32 v51, 0
v_mov_b32 v71, 0
s_add_u32 s60, s31, 0
s_add_u32 s61, s31, 4
s_lshl_b32 s60, s60, 7
s_lshl_b32 s61, s61, 7
s_add_u32 s60, s60, s30
s_add_u32 s61, s61, s30
s_add_u32 s60, s60, 1
s_add_u32 s61, s61, 1
s_mul_i32 s60, s60, 768
s_mul_i32 s61, s61, 768
s_add_u32 s60, s60, 12582912
s_add_u32 s61, s61, 12582912
buffer_store_dwordx4 v[40:43], v204, s[20:23], s60 offen sc1
buffer_store_dwordx4 v[60:63], v204, s[20:23], s61 offen sc1
buffer_store_dwordx4 v[44:47], v204, s[20:23], s60 offen offset:256 sc1
buffer_store_dwordx4 v[64:67], v204, s[20:23], s61 offen offset:256 sc1
buffer_store_dwordx4 v[48:51], v204, s[20:23], s60 offen offset:512 sc1
buffer_store_dwordx4 v[68:71], v204, s[20:23], s61 offen offset:512 sc1
v_sub_f32 v208, 0, v250
v_mov_b32 v210, v251
v_pk_fma_f32 v[80:81], v[160:161], v[208:209], v[80:81] op_sel_hi:[1,0,1]
v_pk_fma_f32 v[100:101], v[180:181], v[208:209], v[100:101] op_sel_hi:[1,0,1]
v_pk_fma_f32 v[82:83], v[162:163], v[208:209], v[82:83] op_sel_hi:[1,0,1]
v_pk_fma_f32 v[102:103], v[182:183], v[208:209], v[102:103] op_sel_hi:[1,0,1]
v_pk_fma_f32 v[84:85], v[164:165], v[208:209], v[84:85] op_sel_hi:[1,0,1]
v_pk_fma_f32 v[104:105], v[184:185], v[208:209], v[104:105] op_sel_hi:[1,0,1]
v_pk_fma_f32 v[86:87], v[166:167], v[208:209], v[86:87] op_sel_hi:[1,0,1]
v_pk_fma_f32 v[106:107], v[186:187], v[208:209], v[106:107] op_sel_hi:[1,0,1]
v_pk_fma_f32 v[88:89], v[168:169], v[208:209], v[88:89] op_sel_hi:[1,0,1]
v_pk_fma_f32 v[108:109], v[188:189], v[208:209], v[108:109] op_sel_hi:[1,0,1]
v_pk_fma_f32 v[90:91], v[170:171], v[208:209], v[90:91] op_sel_hi:[1,0,1]
v_pk_fma_f32 v[110:111], v[190:191], v[208:209], v[110:111] op_sel_hi:[1,0,1]
v_pk_fma_f32 v[92:93], v[172:173], v[208:209], v[92:93] op_sel_hi:[1,0,1]
v_pk_fma_f32 v[112:113], v[192:193], v[208:209], v[112:113] op_sel_hi:[1,0,1]
v_pk_fma_f32 v[94:95], v[174:175], v[208:209], v[94:95] op_sel_hi:[1,0,1]
v_pk_fma_f32 v[114:115], v[194:195], v[208:209], v[114:115] op_sel_hi:[1,0,1]
v_pk_fma_f32 v[96:97], v[176:177], v[208:209], v[96:97] op_sel_hi:[1,0,1]
v_pk_fma_f32 v[116:117], v[196:197], v[208:209], v[116:117] op_sel_hi:[1,0,1]
v_pk_fma_f32 v[98:99], v[178:179], v[208:209], v[98:99] op_sel_hi:[1,0,1]
v_pk_fma_f32 v[118:119], v[198:199], v[208:209], v[118:119] op_sel_hi:[1,0,1]
v_pk_mul_f32 v[80:81], v[80:81], v[210:211] op_sel_hi:[1,0]
v_pk_mul_f32 v[100:101], v[100:101], v[210:211] op_sel_hi:[1,0]
v_pk_mul_f32 v[82:83], v[82:83], v[210:211] op_sel_hi:[1,0]
v_pk_mul_f32 v[102:103], v[102:103], v[210:211] op_sel_hi:[1,0]
v_pk_mul_f32 v[84:85], v[84:85], v[210:211] op_sel_hi:[1,0]
v_pk_mul_f32 v[104:105], v[104:105], v[210:211] op_sel_hi:[1,0]
v_pk_mul_f32 v[86:87], v[86:87], v[210:211] op_sel_hi:[1,0]
v_pk_mul_f32 v[106:107], v[106:107], v[210:211] op_sel_hi:[1,0]
v_pk_mul_f32 v[88:89], v[88:89], v[210:211] op_sel_hi:[1,0]
v_pk_mul_f32 v[108:109], v[108:109], v[210:211] op_sel_hi:[1,0]
v_pk_mul_f32 v[90:91], v[90:91], v[210:211] op_sel_hi:[1,0]
v_pk_mul_f32 v[110:111], v[110:111], v[210:211] op_sel_hi:[1,0]
v_pk_mul_f32 v[92:93], v[92:93], v[210:211] op_sel_hi:[1,0]
v_pk_mul_f32 v[112:113], v[112:113], v[210:211] op_sel_hi:[1,0]
v_pk_mul_f32 v[94:95], v[94:95], v[210:211] op_sel_hi:[1,0]
v_pk_mul_f32 v[114:115], v[114:115], v[210:211] op_sel_hi:[1,0]
v_pk_mul_f32 v[96:97], v[96:97], v[210:211] op_sel_hi:[1,0]
v_pk_mul_f32 v[116:117], v[116:117], v[210:211] op_sel_hi:[1,0]
v_pk_mul_f32 v[98:99], v[98:99], v[210:211] op_sel_hi:[1,0]
v_pk_mul_f32 v[118:119], v[118:119], v[210:211] op_sel_hi:[1,0]
v_cvt_pk_bf16_f32 v80, v80, v81
v_cvt_pk_bf16_f32 v100, v100, v101
v_cvt_pk_bf16_f32 v81, v82, v83
v_cvt_pk_bf16_f32 v101, v102, v103
v_cvt_pk_bf16_f32 v82, v84, v85
v_cvt_pk_bf16_f32 v102, v104, v105
v_cvt_pk_bf16_f32 v83, v86, v87
v_cvt_pk_bf16_f32 v103, v106, v107
v_cvt_pk_bf16_f32 v84, v88, v89
v_cvt_pk_bf16_f32 v104, v108, v109
v_cvt_pk_bf16_f32 v85, v90, v91
v_cvt_pk_bf16_f32 v105, v110, v111
v_cvt_pk_bf16_f32 v86, v92, v93
v_cvt_pk_bf16_f32 v106, v112, v113
v_cvt_pk_bf16_f32 v87, v94, v95
v_cvt_pk_bf16_f32 v107, v114, v115
v_cvt_pk_bf16_f32 v88, v96, v97
v_cvt_pk_bf16_f32 v108, v116, v117
v_cvt_pk_bf16_f32 v89, v98, v99
v_cvt_pk_bf16_f32 v109, v118, v119
v_mov_b32 v90, 0
v_mov_b32 v110, 0
v_mov_b32 v91, 0
v_mov_b32 v111, 0
s_add_u32 s60, s31, 0
s_add_u32 s61, s31, 4
s_lshl_b32 s60, s60, 7
s_lshl_b32 s61, s61, 7
s_add_u32 s60, s60, s30
s_add_u32 s61, s61, s30
s_add_u32 s60, s60, 2
s_add_u32 s61, s61, 2
s_mul_i32 s60, s60, 768
s_mul_i32 s61, s61, 768
s_add_u32 s60, s60, 12582912
s_add_u32 s61, s61, 12582912
buffer_store_dwordx4 v[80:83], v204, s[20:23], s60 offen sc1
buffer_store_dwordx4 v[100:103], v204, s[20:23], s61 offen sc1
buffer_store_dwordx4 v[84:87], v204, s[20:23], s60 offen offset:256 sc1
buffer_store_dwordx4 v[104:107], v204, s[20:23], s61 offen offset:256 sc1
buffer_store_dwordx4 v[88:91], v204, s[20:23], s60 offen offset:512 sc1
buffer_store_dwordx4 v[108:111], v204, s[20:23], s61 offen offset:512 sc1
v_sub_f32 v208, 0, v252
v_mov_b32 v210, v253
v_pk_fma_f32 v[120:121], v[160:161], v[208:209], v[120:121] op_sel_hi:[1,0,1]
v_pk_fma_f32 v[140:141], v[180:181], v[208:209], v[140:141] op_sel_hi:[1,0,1]
v_pk_fma_f32 v[122:123], v[162:163], v[208:209], v[122:123] op_sel_hi:[1,0,1]
v_pk_fma_f32 v[142:143], v[182:183], v[208:209], v[142:143] op_sel_hi:[1,0,1]
v_pk_fma_f32 v[124:125], v[164:165], v[208:209], v[124:125] op_sel_hi:[1,0,1]
v_pk_fma_f32 v[144:145], v[184:185], v[208:209], v[144:145] op_sel_hi:[1,0,1]
v_pk_fma_f32 v[126:127], v[166:167], v[208:209], v[126:127] op_sel_hi:[1,0,1]
v_pk_fma_f32 v[146:147], v[186:187], v[208:209], v[146:147] op_sel_hi:[1,0,1]
v_pk_fma_f32 v[128:129], v[168:169], v[208:209], v[128:129] op_sel_hi:[1,0,1]
v_pk_fma_f32 v[148:149], v[188:189], v[208:209], v[148:149] op_sel_hi:[1,0,1]
v_pk_fma_f32 v[130:131], v[170:171], v[208:209], v[130:131] op_sel_hi:[1,0,1]
v_pk_fma_f32 v[150:151], v[190:191], v[208:209], v[150:151] op_sel_hi:[1,0,1]
v_pk_fma_f32 v[132:133], v[172:173], v[208:209], v[132:133] op_sel_hi:[1,0,1]
v_pk_fma_f32 v[152:153], v[192:193], v[208:209], v[152:153] op_sel_hi:[1,0,1]
v_pk_fma_f32 v[134:135], v[174:175], v[208:209], v[134:135] op_sel_hi:[1,0,1]
v_pk_fma_f32 v[154:155], v[194:195], v[208:209], v[154:155] op_sel_hi:[1,0,1]
v_pk_fma_f32 v[136:137], v[176:177], v[208:209], v[136:137] op_sel_hi:[1,0,1]
v_pk_fma_f32 v[156:157], v[196:197], v[208:209], v[156:157] op_sel_hi:[1,0,1]
v_pk_fma_f32 v[138:139], v[178:179], v[208:209], v[138:139] op_sel_hi:[1,0,1]
v_pk_fma_f32 v[158:159], v[198:199], v[208:209], v[158:159] op_sel_hi:[1,0,1]
v_pk_mul_f32 v[120:121], v[120:121], v[210:211] op_sel_hi:[1,0]
v_pk_mul_f32 v[140:141], v[140:141], v[210:211] op_sel_hi:[1,0]
v_pk_mul_f32 v[122:123], v[122:123], v[210:211] op_sel_hi:[1,0]
v_pk_mul_f32 v[142:143], v[142:143], v[210:211] op_sel_hi:[1,0]
v_pk_mul_f32 v[124:125], v[124:125], v[210:211] op_sel_hi:[1,0]
v_pk_mul_f32 v[144:145], v[144:145], v[210:211] op_sel_hi:[1,0]
v_pk_mul_f32 v[126:127], v[126:127], v[210:211] op_sel_hi:[1,0]
v_pk_mul_f32 v[146:147], v[146:147], v[210:211] op_sel_hi:[1,0]
v_pk_mul_f32 v[128:129], v[128:129], v[210:211] op_sel_hi:[1,0]
v_pk_mul_f32 v[148:149], v[148:149], v[210:211] op_sel_hi:[1,0]
v_pk_mul_f32 v[130:131], v[130:131], v[210:211] op_sel_hi:[1,0]
v_pk_mul_f32 v[150:151], v[150:151], v[210:211] op_sel_hi:[1,0]
v_pk_mul_f32 v[132:133], v[132:133], v[210:211] op_sel_hi:[1,0]
v_pk_mul_f32 v[152:153], v[152:153], v[210:211] op_sel_hi:[1,0]
v_pk_mul_f32 v[134:135], v[134:135], v[210:211] op_sel_hi:[1,0]
v_pk_mul_f32 v[154:155], v[154:155], v[210:211] op_sel_hi:[1,0]
v_pk_mul_f32 v[136:137], v[136:137], v[210:211] op_sel_hi:[1,0]
v_pk_mul_f32 v[156:157], v[156:157], v[210:211] op_sel_hi:[1,0]
v_pk_mul_f32 v[138:139], v[138:139], v[210:211] op_sel_hi:[1,0]
v_pk_mul_f32 v[158:159], v[158:159], v[210:211] op_sel_hi:[1,0]
v_cvt_pk_bf16_f32 v120, v120, v121
v_cvt_pk_bf16_f32 v140, v140, v141
v_cvt_pk_bf16_f32 v121, v122, v123
v_cvt_pk_bf16_f32 v141, v142, v143
v_cvt_pk_bf16_f32 v122, v124, v125
v_cvt_pk_bf16_f32 v142, v144, v145
v_cvt_pk_bf16_f32 v123, v126, v127
v_cvt_pk_bf16_f32 v143, v146, v147
v_cvt_pk_bf16_f32 v124, v128, v129
v_cvt_pk_bf16_f32 v144, v148, v149
v_cvt_pk_bf16_f32 v125, v130, v131
v_cvt_pk_bf16_f32 v145, v150, v151
v_cvt_pk_bf16_f32 v126, v132, v133
v_cvt_pk_bf16_f32 v146, v152, v153
v_cvt_pk_bf16_f32 v127, v134, v135
v_cvt_pk_bf16_f32 v147, v154, v155
v_cvt_pk_bf16_f32 v128, v136, v137
v_cvt_pk_bf16_f32 v148, v156, v157
v_cvt_pk_bf16_f32 v129, v138, v139
v_cvt_pk_bf16_f32 v149, v158, v159
v_mov_b32 v130, 0
v_mov_b32 v150, 0
v_mov_b32 v131, 0
v_mov_b32 v151, 0
s_add_u32 s60, s31, 0
s_add_u32 s61, s31, 4
s_lshl_b32 s60, s60, 7
s_lshl_b32 s61, s61, 7
s_add_u32 s60, s60, s30
s_add_u32 s61, s61, s30
s_add_u32 s60, s60, 3
s_add_u32 s61, s61, 3
s_mul_i32 s60, s60, 768
s_mul_i32 s61, s61, 768
s_add_u32 s60, s60, 12582912
s_add_u32 s61, s61, 12582912
buffer_store_dwordx4 v[120:123], v204, s[20:23], s60 offen sc1
buffer_store_dwordx4 v[140:143], v204, s[20:23], s61 offen sc1
buffer_store_dwordx4 v[124:127], v204, s[20:23], s60 offen offset:256 sc1
buffer_store_dwordx4 v[144:147], v204, s[20:23], s61 offen offset:256 sc1
buffer_store_dwordx4 v[128:131], v204, s[20:23], s60 offen offset:512 sc1
buffer_store_dwordx4 v[148:151], v204, s[20:23], s61 offen offset:512 sc1
s_endpgm
KV_EPI:
s_barrier
KVD0:
ds_read_b64_tr_b16 a[112:113], v245 offset:0
ds_read_b64_tr_b16 a[114:115], v245 offset:160
ds_read_b64_tr_b16 a[116:117], v245 offset:320
ds_read_b64_tr_b16 a[118:119], v245 offset:480
ds_read_b64_tr_b16 a[120:121], v245 offset:640
ds_read_b64_tr_b16 a[122:123], v245 offset:800
ds_read_b64_tr_b16 a[124:125], v245 offset:8
ds_read_b64_tr_b16 a[126:127], v245 offset:168
ds_read_b64_tr_b16 a[128:129], v245 offset:328
ds_read_b64_tr_b16 a[130:131], v245 offset:488
ds_read_b64_tr_b16 a[132:133], v245 offset:648
ds_read_b64_tr_b16 a[134:135], v245 offset:808
ds_read_b64_tr_b16 a[136:137], v245 offset:16
ds_read_b64_tr_b16 a[138:139], v245 offset:176
ds_read_b64_tr_b16 a[140:141], v245 offset:336
ds_read_b64_tr_b16 a[142:143], v245 offset:496
ds_read_b64_tr_b16 a[144:145], v245 offset:656
ds_read_b64_tr_b16 a[146:147], v245 offset:816
ds_read_b64_tr_b16 a[148:149], v245 offset:24
ds_read_b64_tr_b16 a[150:151], v245 offset:184
ds_read_b64_tr_b16 a[152:153], v245 offset:344
ds_read_b64_tr_b16 a[154:155], v245 offset:504
ds_read_b64_tr_b16 a[156:157], v245 offset:664
ds_read_b64_tr_b16 a[158:159], v245 offset:824
ds_read_b64_tr_b16 a[160:161], v245 offset:32
ds_read_b64_tr_b16 a[162:163], v245 offset:192
ds_read_b64_tr_b16 a[164:165], v245 offset:352
ds_read_b64_tr_b16 a[166:167], v245 offset:512
ds_read_b64_tr_b16 a[168:169], v245 offset:672
ds_read_b64_tr_b16 a[170:171], v245 offset:832
v_lshrrev_b32 v200, 4, v255
v_and_b32 v201, 15, v255
v_lshlrev_b32 v202, 15, v200
v_lshlrev_b32 v203, 5, v201
v_add_u32 v202, v202, v203
s_lshl_b32 s30, s24, 11
v_add_u32 v244, s30, v202
v_accvgpr_read_b32 v160, a172
v_accvgpr_read_b32 v161, a173
v_accvgpr_read_b32 v162, a174
v_accvgpr_read_b32 v163, a175
v_accvgpr_read_b32 v164, a176
v_accvgpr_read_b32 v165, a177
v_accvgpr_read_b32 v166, a178
v_accvgpr_read_b32 v167, a179
v_accvgpr_read_b32 v168, a180
v_accvgpr_read_b32 v169, a181
v_accvgpr_read_b32 v170, a182
v_accvgpr_read_b32 v171, a183
v_accvgpr_read_b32 v172, a184
v_accvgpr_read_b32 v173, a185
v_accvgpr_read_b32 v174, a186
v_accvgpr_read_b32 v175, a187
v_accvgpr_read_b32 v176, a188
v_accvgpr_read_b32 v177, a189
v_accvgpr_read_b32 v178, a190
v_accvgpr_read_b32 v179, a191
v_accvgpr_read_b32 v180, a192
v_accvgpr_read_b32 v181, a193
v_accvgpr_read_b32 v182, a194
v_accvgpr_read_b32 v183, a195
v_accvgpr_read_b32 v184, a196
v_accvgpr_read_b32 v185, a197
v_accvgpr_read_b32 v186, a198
v_accvgpr_read_b32 v187, a199
v_accvgpr_read_b32 v188, a200
v_accvgpr_read_b32 v189, a201
v_accvgpr_read_b32 v190, a202
v_accvgpr_read_b32 v191, a203
v_accvgpr_read_b32 v192, a204
v_accvgpr_read_b32 v193, a205
v_accvgpr_read_b32 v194, a206
v_accvgpr_read_b32 v195, a207
v_accvgpr_read_b32 v196, a208
v_accvgpr_read_b32 v197, a209
v_accvgpr_read_b32 v198, a210
v_accvgpr_read_b32 v199, a211
v_accvgpr_read_b32 v200, a212
v_accvgpr_read_b32 v201, a213
v_accvgpr_read_b32 v202, a214
v_accvgpr_read_b32 v203, a215
v_accvgpr_read_b32 v204, a216
v_accvgpr_read_b32 v205, a217
v_accvgpr_read_b32 v206, a218
v_accvgpr_read_b32 v207, a219
v_accvgpr_read_b32 v208, a220
v_accvgpr_read_b32 v209, a221
v_accvgpr_read_b32 v210, a222
v_accvgpr_read_b32 v211, a223
v_accvgpr_read_b32 v212, a224
v_accvgpr_read_b32 v213, a225
v_accvgpr_read_b32 v214, a226
v_accvgpr_read_b32 v215, a227
v_accvgpr_read_b32 v216, a228
v_accvgpr_read_b32 v217, a229
v_accvgpr_read_b32 v218, a230
v_accvgpr_read_b32 v219, a231
v_accvgpr_read_b32 v220, a232
v_accvgpr_read_b32 v221, a233
v_accvgpr_read_b32 v222, a234
v_accvgpr_read_b32 v223, a235
v_accvgpr_read_b32 v224, a236
v_accvgpr_read_b32 v225, a237
v_accvgpr_read_b32 v226, a238
v_accvgpr_read_b32 v227, a239
v_accvgpr_read_b32 v228, a240
v_accvgpr_read_b32 v229, a241
v_accvgpr_read_b32 v230, a242
v_accvgpr_read_b32 v231, a243
v_accvgpr_read_b32 v232, a244
v_accvgpr_read_b32 v233, a245
v_accvgpr_read_b32 v234, a246
v_accvgpr_read_b32 v235, a247
v_accvgpr_read_b32 v236, a248
v_accvgpr_read_b32 v237, a249
v_accvgpr_read_b32 v238, a250
v_accvgpr_read_b32 v239, a251
v_pk_add_f32 v[160:161], v[160:161], v[200:201]
v_pk_add_f32 v[162:163], v[162:163], v[202:203]
v_pk_add_f32 v[164:165], v[164:165], v[204:205]
v_pk_add_f32 v[166:167], v[166:167], v[206:207]
v_pk_add_f32 v[168:169], v[168:169], v[208:209]
v_pk_add_f32 v[170:171], v[170:171], v[210:211]
v_pk_add_f32 v[172:173], v[172:173], v[212:213]
v_pk_add_f32 v[174:175], v[174:175], v[214:215]
v_pk_add_f32 v[176:177], v[176:177], v[216:217]
v_pk_add_f32 v[178:179], v[178:179], v[218:219]
v_pk_add_f32 v[180:181], v[180:181], v[220:221]
v_pk_add_f32 v[182:183], v[182:183], v[222:223]
v_pk_add_f32 v[184:185], v[184:185], v[224:225]
v_pk_add_f32 v[186:187], v[186:187], v[226:227]
v_pk_add_f32 v[188:189], v[188:189], v[228:229]
v_pk_add_f32 v[190:191], v[190:191], v[230:231]
v_pk_add_f32 v[192:193], v[192:193], v[232:233]
v_pk_add_f32 v[194:195], v[194:195], v[234:235]
v_pk_add_f32 v[196:197], v[196:197], v[236:237]
v_pk_add_f32 v[198:199], v[198:199], v[238:239]
v_sub_f32 v200, 0, v246
v_sub_f32 v204, 0, v248
v_mov_b32 v202, v247
v_mov_b32 v206, v249
v_pk_fma_f32 v[20:21], v[180:181], v[200:201], v[20:21] op_sel_hi:[1,0,1]
v_pk_fma_f32 v[60:61], v[180:181], v[204:205], v[60:61] op_sel_hi:[1,0,1]
v_pk_fma_f32 v[22:23], v[182:183], v[200:201], v[22:23] op_sel_hi:[1,0,1]
v_pk_fma_f32 v[62:63], v[182:183], v[204:205], v[62:63] op_sel_hi:[1,0,1]
v_pk_fma_f32 v[24:25], v[184:185], v[200:201], v[24:25] op_sel_hi:[1,0,1]
v_pk_fma_f32 v[64:65], v[184:185], v[204:205], v[64:65] op_sel_hi:[1,0,1]
v_pk_fma_f32 v[26:27], v[186:187], v[200:201], v[26:27] op_sel_hi:[1,0,1]
v_pk_fma_f32 v[66:67], v[186:187], v[204:205], v[66:67] op_sel_hi:[1,0,1]
v_pk_fma_f32 v[28:29], v[188:189], v[200:201], v[28:29] op_sel_hi:[1,0,1]
v_pk_fma_f32 v[68:69], v[188:189], v[204:205], v[68:69] op_sel_hi:[1,0,1]
v_pk_fma_f32 v[30:31], v[190:191], v[200:201], v[30:31] op_sel_hi:[1,0,1]
v_pk_fma_f32 v[70:71], v[190:191], v[204:205], v[70:71] op_sel_hi:[1,0,1]
v_pk_fma_f32 v[32:33], v[192:193], v[200:201], v[32:33] op_sel_hi:[1,0,1]
v_pk_fma_f32 v[72:73], v[192:193], v[204:205], v[72:73] op_sel_hi:[1,0,1]
v_pk_fma_f32 v[34:35], v[194:195], v[200:201], v[34:35] op_sel_hi:[1,0,1]
v_pk_fma_f32 v[74:75], v[194:195], v[204:205], v[74:75] op_sel_hi:[1,0,1]
v_pk_fma_f32 v[36:37], v[196:197], v[200:201], v[36:37] op_sel_hi:[1,0,1]
v_pk_fma_f32 v[76:77], v[196:197], v[204:205], v[76:77] op_sel_hi:[1,0,1]
v_pk_fma_f32 v[38:39], v[198:199], v[200:201], v[38:39] op_sel_hi:[1,0,1]
v_pk_fma_f32 v[78:79], v[198:199], v[204:205], v[78:79] op_sel_hi:[1,0,1]
v_pk_mul_f32 v[20:21], v[20:21], v[202:203] op_sel_hi:[1,0]
v_pk_mul_f32 v[60:61], v[60:61], v[206:207] op_sel_hi:[1,0]
v_pk_mul_f32 v[22:23], v[22:23], v[202:203] op_sel_hi:[1,0]
v_pk_mul_f32 v[62:63], v[62:63], v[206:207] op_sel_hi:[1,0]
v_pk_mul_f32 v[24:25], v[24:25], v[202:203] op_sel_hi:[1,0]
v_pk_mul_f32 v[64:65], v[64:65], v[206:207] op_sel_hi:[1,0]
v_pk_mul_f32 v[26:27], v[26:27], v[202:203] op_sel_hi:[1,0]
v_pk_mul_f32 v[66:67], v[66:67], v[206:207] op_sel_hi:[1,0]
v_pk_mul_f32 v[28:29], v[28:29], v[202:203] op_sel_hi:[1,0]
v_pk_mul_f32 v[68:69], v[68:69], v[206:207] op_sel_hi:[1,0]
v_pk_mul_f32 v[30:31], v[30:31], v[202:203] op_sel_hi:[1,0]
v_pk_mul_f32 v[70:71], v[70:71], v[206:207] op_sel_hi:[1,0]
v_pk_mul_f32 v[32:33], v[32:33], v[202:203] op_sel_hi:[1,0]
v_pk_mul_f32 v[72:73], v[72:73], v[206:207] op_sel_hi:[1,0]
v_pk_mul_f32 v[34:35], v[34:35], v[202:203] op_sel_hi:[1,0]
v_pk_mul_f32 v[74:75], v[74:75], v[206:207] op_sel_hi:[1,0]
v_pk_mul_f32 v[36:37], v[36:37], v[202:203] op_sel_hi:[1,0]
v_pk_mul_f32 v[76:77], v[76:77], v[206:207] op_sel_hi:[1,0]
v_pk_mul_f32 v[38:39], v[38:39], v[202:203] op_sel_hi:[1,0]
v_pk_mul_f32 v[78:79], v[78:79], v[206:207] op_sel_hi:[1,0]
v_cvt_pk_bf16_f32 v20, v20, v21
v_cvt_pk_bf16_f32 v60, v60, v61
v_cvt_pk_bf16_f32 v21, v22, v23
v_cvt_pk_bf16_f32 v61, v62, v63
v_cvt_pk_bf16_f32 v22, v24, v25
v_cvt_pk_bf16_f32 v62, v64, v65
v_cvt_pk_bf16_f32 v23, v26, v27
v_cvt_pk_bf16_f32 v63, v66, v67
v_cvt_pk_bf16_f32 v24, v28, v29
v_cvt_pk_bf16_f32 v64, v68, v69
v_cvt_pk_bf16_f32 v25, v30, v31
v_cvt_pk_bf16_f32 v65, v70, v71
v_cvt_pk_bf16_f32 v26, v32, v33
v_cvt_pk_bf16_f32 v66, v72, v73
v_cvt_pk_bf16_f32 v27, v34, v35
v_cvt_pk_bf16_f32 v67, v74, v75
v_cvt_pk_bf16_f32 v28, v36, v37
v_cvt_pk_bf16_f32 v68, v76, v77
v_cvt_pk_bf16_f32 v29, v38, v39
v_cvt_pk_bf16_f32 v69, v78, v79
ds_write_b128 v244, v[20:23] offset:24576
ds_write_b128 v244, v[60:63] offset:25088
ds_write_b128 v244, v[24:27] offset:24592
ds_write_b128 v244, v[64:67] offset:25104
v_sub_f32 v200, 0, v250
v_sub_f32 v204, 0, v252
v_mov_b32 v202, v251
v_mov_b32 v206, v253
v_pk_fma_f32 v[100:101], v[180:181], v[200:201], v[100:101] op_sel_hi:[1,0,1]
v_pk_fma_f32 v[140:141], v[180:181], v[204:205], v[140:141] op_sel_hi:[1,0,1]
v_pk_fma_f32 v[102:103], v[182:183], v[200:201], v[102:103] op_sel_hi:[1,0,1]
v_pk_fma_f32 v[142:143], v[182:183], v[204:205], v[142:143] op_sel_hi:[1,0,1]
v_pk_fma_f32 v[104:105], v[184:185], v[200:201], v[104:105] op_sel_hi:[1,0,1]
v_pk_fma_f32 v[144:145], v[184:185], v[204:205], v[144:145] op_sel_hi:[1,0,1]
v_pk_fma_f32 v[106:107], v[186:187], v[200:201], v[106:107] op_sel_hi:[1,0,1]
v_pk_fma_f32 v[146:147], v[186:187], v[204:205], v[146:147] op_sel_hi:[1,0,1]
v_pk_fma_f32 v[108:109], v[188:189], v[200:201], v[108:109] op_sel_hi:[1,0,1]
v_pk_fma_f32 v[148:149], v[188:189], v[204:205], v[148:149] op_sel_hi:[1,0,1]
v_pk_fma_f32 v[110:111], v[190:191], v[200:201], v[110:111] op_sel_hi:[1,0,1]
v_pk_fma_f32 v[150:151], v[190:191], v[204:205], v[150:151] op_sel_hi:[1,0,1]
v_pk_fma_f32 v[112:113], v[192:193], v[200:201], v[112:113] op_sel_hi:[1,0,1]
v_pk_fma_f32 v[152:153], v[192:193], v[204:205], v[152:153] op_sel_hi:[1,0,1]
v_pk_fma_f32 v[114:115], v[194:195], v[200:201], v[114:115] op_sel_hi:[1,0,1]
v_pk_fma_f32 v[154:155], v[194:195], v[204:205], v[154:155] op_sel_hi:[1,0,1]
v_pk_fma_f32 v[116:117], v[196:197], v[200:201], v[116:117] op_sel_hi:[1,0,1]
v_pk_fma_f32 v[156:157], v[196:197], v[204:205], v[156:157] op_sel_hi:[1,0,1]
v_pk_fma_f32 v[118:119], v[198:199], v[200:201], v[118:119] op_sel_hi:[1,0,1]
v_pk_fma_f32 v[158:159], v[198:199], v[204:205], v[158:159] op_sel_hi:[1,0,1]
v_pk_mul_f32 v[100:101], v[100:101], v[202:203] op_sel_hi:[1,0]
v_pk_mul_f32 v[140:141], v[140:141], v[206:207] op_sel_hi:[1,0]
v_pk_mul_f32 v[102:103], v[102:103], v[202:203] op_sel_hi:[1,0]
v_pk_mul_f32 v[142:143], v[142:143], v[206:207] op_sel_hi:[1,0]
v_pk_mul_f32 v[104:105], v[104:105], v[202:203] op_sel_hi:[1,0]
v_pk_mul_f32 v[144:145], v[144:145], v[206:207] op_sel_hi:[1,0]
v_pk_mul_f32 v[106:107], v[106:107], v[202:203] op_sel_hi:[1,0]
v_pk_mul_f32 v[146:147], v[146:147], v[206:207] op_sel_hi:[1,0]
v_pk_mul_f32 v[108:109], v[108:109], v[202:203] op_sel_hi:[1,0]
v_pk_mul_f32 v[148:149], v[148:149], v[206:207] op_sel_hi:[1,0]
v_pk_mul_f32 v[110:111], v[110:111], v[202:203] op_sel_hi:[1,0]
v_pk_mul_f32 v[150:151], v[150:151], v[206:207] op_sel_hi:[1,0]
v_pk_mul_f32 v[112:113], v[112:113], v[202:203] op_sel_hi:[1,0]
v_pk_mul_f32 v[152:153], v[152:153], v[206:207] op_sel_hi:[1,0]
v_pk_mul_f32 v[114:115], v[114:115], v[202:203] op_sel_hi:[1,0]
v_pk_mul_f32 v[154:155], v[154:155], v[206:207] op_sel_hi:[1,0]
v_pk_mul_f32 v[116:117], v[116:117], v[202:203] op_sel_hi:[1,0]
v_pk_mul_f32 v[156:157], v[156:157], v[206:207] op_sel_hi:[1,0]
v_pk_mul_f32 v[118:119], v[118:119], v[202:203] op_sel_hi:[1,0]
v_pk_mul_f32 v[158:159], v[158:159], v[206:207] op_sel_hi:[1,0]
v_cvt_pk_bf16_f32 v100, v100, v101
v_cvt_pk_bf16_f32 v140, v140, v141
v_cvt_pk_bf16_f32 v101, v102, v103
v_cvt_pk_bf16_f32 v141, v142, v143
v_cvt_pk_bf16_f32 v102, v104, v105
v_cvt_pk_bf16_f32 v142, v144, v145
v_cvt_pk_bf16_f32 v103, v106, v107
v_cvt_pk_bf16_f32 v143, v146, v147
v_cvt_pk_bf16_f32 v104, v108, v109
v_cvt_pk_bf16_f32 v144, v148, v149
v_cvt_pk_bf16_f32 v105, v110, v111
v_cvt_pk_bf16_f32 v145, v150, v151
v_cvt_pk_bf16_f32 v106, v112, v113
v_cvt_pk_bf16_f32 v146, v152, v153
v_cvt_pk_bf16_f32 v107, v114, v115
v_cvt_pk_bf16_f32 v147, v154, v155
v_cvt_pk_bf16_f32 v108, v116, v117
v_cvt_pk_bf16_f32 v148, v156, v157
v_cvt_pk_bf16_f32 v109, v118, v119
v_cvt_pk_bf16_f32 v149, v158, v159
ds_write_b128 v244, v[100:103] offset:25600
ds_write_b128 v244, v[140:143] offset:26112
ds_write_b128 v244, v[104:107] offset:25616
ds_write_b128 v244, v[144:147] offset:26128
s_waitcnt lgkmcnt(0)
KVD1:
v_sub_f32 v240, 0, v246
v_pk_fma_f32 v[0:1], v[160:161], v[240:241], v[0:1] op_sel_hi:[1,0,1]
v_pk_fma_f32 v[2:3], v[162:163], v[240:241], v[2:3] op_sel_hi:[1,0,1]
v_pk_fma_f32 v[4:5], v[164:165], v[240:241], v[4:5] op_sel_hi:[1,0,1]
v_pk_fma_f32 v[6:7], v[166:167], v[240:241], v[6:7] op_sel_hi:[1,0,1]
v_pk_fma_f32 v[8:9], v[168:169], v[240:241], v[8:9] op_sel_hi:[1,0,1]
v_pk_fma_f32 v[10:11], v[170:171], v[240:241], v[10:11] op_sel_hi:[1,0,1]
v_pk_fma_f32 v[12:13], v[172:173], v[240:241], v[12:13] op_sel_hi:[1,0,1]
v_pk_fma_f32 v[14:15], v[174:175], v[240:241], v[14:15] op_sel_hi:[1,0,1]
v_pk_fma_f32 v[16:17], v[176:177], v[240:241], v[16:17] op_sel_hi:[1,0,1]
v_pk_fma_f32 v[18:19], v[178:179], v[240:241], v[18:19] op_sel_hi:[1,0,1]
v_cvt_pk_bf16_f32 v0, v0, v1
v_cvt_pk_bf16_f32 v1, v2, v3
v_cvt_pk_bf16_f32 v2, v4, v5
v_cvt_pk_bf16_f32 v3, v6, v7
v_cvt_pk_bf16_f32 v4, v8, v9
v_cvt_pk_bf16_f32 v5, v10, v11
v_cvt_pk_bf16_f32 v6, v12, v13
v_cvt_pk_bf16_f32 v7, v14, v15
v_cvt_pk_bf16_f32 v8, v16, v17
v_cvt_pk_bf16_f32 v9, v18, v19
v_mov_b32 v10, 0
v_mov_b32 v11, 0
v_mfma_f32_16x16x32_bf16 v[200:203], a[112:115], v[0:3], 0
v_mfma_f32_16x16x32_bf16 v[204:207], a[124:127], v[0:3], 0
v_mfma_f32_16x16x32_bf16 v[208:211], a[136:139], v[0:3], 0
v_mfma_f32_16x16x32_bf16 v[212:215], a[148:151], v[0:3], 0
v_mfma_f32_16x16x32_bf16 v[216:219], a[160:163], v[0:3], 0
v_mfma_f32_16x16x32_bf16 v[200:203], a[116:119], v[4:7], v[200:203]
v_mfma_f32_16x16x32_bf16 v[204:207], a[128:131], v[4:7], v[204:207]
v_mfma_f32_16x16x32_bf16 v[208:211], a[140:143], v[4:7], v[208:211]
v_mfma_f32_16x16x32_bf16 v[212:215], a[152:155], v[4:7], v[212:215]
v_mfma_f32_16x16x32_bf16 v[216:219], a[164:167], v[4:7], v[216:219]
v_mfma_f32_16x16x32_bf16 v[200:203], a[120:123], v[8:11], v[200:203]
v_mfma_f32_16x16x32_bf16 v[204:207], a[132:135], v[8:11], v[204:207]
v_mfma_f32_16x16x32_bf16 v[208:211], a[144:147], v[8:11], v[208:211]
v_mfma_f32_16x16x32_bf16 v[212:215], a[156:159], v[8:11], v[212:215]
v_mfma_f32_16x16x32_bf16 v[216:219], a[168:171], v[8:11], v[216:219]
v_mul_f32 v20, 1.4426950408889634, v247
v_sub_f32 v22, 0, v20
s_nop 1
v_max3_f32 v30, v200, v201, v202
v_min3_f32 v31, v200, v201, v202
v_max3_f32 v30, v30, v203, v204
v_sub_f32 v240, 0, v248
v_min3_f32 v31, v31, v203, v204
v_max3_f32 v30, v30, v205, v206
v_min3_f32 v31, v31, v205, v206
v_max3_f32 v30, v30, v207, v208
v_pk_fma_f32 v[40:41], v[160:161], v[240:241], v[40:41] op_sel_hi:[1,0,1]
v_min3_f32 v31, v31, v207, v208
v_max3_f32 v30, v30, v209, v210
v_min3_f32 v31, v31, v209, v210
v_max3_f32 v30, v30, v211, v212
v_pk_fma_f32 v[42:43], v[162:163], v[240:241], v[42:43] op_sel_hi:[1,0,1]
v_min3_f32 v31, v31, v211, v212
v_max3_f32 v30, v30, v213, v214
v_min3_f32 v31, v31, v213, v214
v_max3_f32 v30, v30, v215, v216
v_pk_fma_f32 v[44:45], v[164:165], v[240:241], v[44:45] op_sel_hi:[1,0,1]
v_min3_f32 v31, v31, v215, v216
v_max3_f32 v30, v30, v217, v218
v_min3_f32 v31, v31, v217, v218
v_max_f32 v30, v30, v219
v_pk_fma_f32 v[46:47], v[166:167], v[240:241], v[46:47] op_sel_hi:[1,0,1]
v_min_f32 v31, v31, v219
v_mul_f32 v24, v30, v22
v_mul_f32 v26, v31, v20
v_pk_fma_f32 v[180:181], v[200:201], v[22:23], v[26:27] op_sel_hi:[1,0,0]
v_pk_fma_f32 v[48:49], v[168:169], v[240:241], v[48:49] op_sel_hi:[1,0,1]
v_pk_fma_f32 v[182:183], v[202:203], v[22:23], v[26:27] op_sel_hi:[1,0,0]
v_pk_fma_f32 v[184:185], v[204:205], v[22:23], v[26:27] op_sel_hi:[1,0,0]
v_pk_fma_f32 v[186:187], v[206:207], v[22:23], v[26:27] op_sel_hi:[1,0,0]
v_pk_fma_f32 v[188:189], v[208:209], v[22:23], v[26:27] op_sel_hi:[1,0,0]
v_pk_fma_f32 v[50:51], v[170:171], v[240:241], v[50:51] op_sel_hi:[1,0,1]
v_pk_fma_f32 v[190:191], v[210:211], v[22:23], v[26:27] op_sel_hi:[1,0,0]
v_pk_fma_f32 v[192:193], v[212:213], v[22:23], v[26:27] op_sel_hi:[1,0,0]
v_pk_fma_f32 v[194:195], v[214:215], v[22:23], v[26:27] op_sel_hi:[1,0,0]
v_pk_fma_f32 v[196:197], v[216:217], v[22:23], v[26:27] op_sel_hi:[1,0,0]
v_pk_fma_f32 v[52:53], v[172:173], v[240:241], v[52:53] op_sel_hi:[1,0,1]
v_pk_fma_f32 v[198:199], v[218:219], v[22:23], v[26:27] op_sel_hi:[1,0,0]
v_pk_fma_f32 v[200:201], v[200:201], v[20:21], v[24:25] op_sel_hi:[1,0,0]
v_pk_fma_f32 v[202:203], v[202:203], v[20:21], v[24:25] op_sel_hi:[1,0,0]
v_pk_fma_f32 v[204:205], v[204:205], v[20:21], v[24:25] op_sel_hi:[1,0,0]
v_pk_fma_f32 v[54:55], v[174:175], v[240:241], v[54:55] op_sel_hi:[1,0,1]
v_pk_fma_f32 v[206:207], v[206:207], v[20:21], v[24:25] op_sel_hi:[1,0,0]
v_pk_fma_f32 v[208:209], v[208:209], v[20:21], v[24:25] op_sel_hi:[1,0,0]
v_pk_fma_f32 v[210:211], v[210:211], v[20:21], v[24:25] op_sel_hi:[1,0,0]
v_pk_fma_f32 v[212:213], v[212:213], v[20:21], v[24:25] op_sel_hi:[1,0,0]
v_pk_fma_f32 v[214:215], v[214:215], v[20:21], v[24:25] op_sel_hi:[1,0,0]
v_pk_fma_f32 v[56:57], v[176:177], v[240:241], v[56:57] op_sel_hi:[1,0,1]
v_pk_fma_f32 v[216:217], v[216:217], v[20:21], v[24:25] op_sel_hi:[1,0,0]
v_pk_fma_f32 v[218:219], v[218:219], v[20:21], v[24:25] op_sel_hi:[1,0,0]
v_exp_f32 v180, v180
v_exp_f32 v181, v181
v_pk_fma_f32 v[58:59], v[178:179], v[240:241], v[58:59] op_sel_hi:[1,0,1]
v_exp_f32 v182, v182
v_exp_f32 v183, v183
v_exp_f32 v184, v184
v_exp_f32 v185, v185
v_cvt_pk_bf16_f32 v40, v40, v41
v_exp_f32 v186, v186
v_exp_f32 v187, v187
v_exp_f32 v188, v188
v_exp_f32 v189, v189
v_cvt_pk_bf16_f32 v41, v42, v43
v_exp_f32 v190, v190
v_exp_f32 v191, v191
v_exp_f32 v192, v192
v_exp_f32 v193, v193
v_cvt_pk_bf16_f32 v42, v44, v45
v_exp_f32 v194, v194
v_exp_f32 v195, v195
v_exp_f32 v196, v196
v_exp_f32 v197, v197
v_cvt_pk_bf16_f32 v43, v46, v47
v_exp_f32 v198, v198
v_exp_f32 v199, v199
v_exp_f32 v200, v200
v_exp_f32 v201, v201
v_cvt_pk_bf16_f32 v44, v48, v49
v_exp_f32 v202, v202
v_exp_f32 v203, v203
v_exp_f32 v204, v204
v_exp_f32 v205, v205
v_cvt_pk_bf16_f32 v45, v50, v51
v_exp_f32 v206, v206
v_exp_f32 v207, v207
v_exp_f32 v208, v208
v_exp_f32 v209, v209
v_cvt_pk_bf16_f32 v46, v52, v53
v_exp_f32 v210, v210
v_exp_f32 v211, v211
v_exp_f32 v212, v212
v_exp_f32 v213, v213
v_cvt_pk_bf16_f32 v47, v54, v55
v_exp_f32 v214, v214
v_exp_f32 v215, v215
v_exp_f32 v216, v216
v_exp_f32 v217, v217
v_exp_f32 v218, v218
v_cvt_pk_bf16_f32 v48, v56, v57
v_exp_f32 v219, v219
v_pk_add_f32 v[34:35], v[180:181], v[182:183]
v_pk_add_f32 v[32:33], v[200:201], v[202:203]
v_pk_add_f32 v[34:35], v[34:35], v[184:185]
v_cvt_pk_bf16_f32 v49, v58, v59
v_pk_add_f32 v[32:33], v[32:33], v[204:205]
v_pk_add_f32 v[34:35], v[34:35], v[186:187]
v_pk_add_f32 v[32:33], v[32:33], v[206:207]
v_pk_add_f32 v[34:35], v[34:35], v[188:189]
v_mov_b32 v50, 0
v_pk_add_f32 v[32:33], v[32:33], v[208:209]
v_pk_add_f32 v[34:35], v[34:35], v[190:191]
v_pk_add_f32 v[32:33], v[32:33], v[210:211]
v_pk_add_f32 v[34:35], v[34:35], v[192:193]
v_mov_b32 v51, 0
v_pk_add_f32 v[32:33], v[32:33], v[212:213]
v_pk_add_f32 v[34:35], v[34:35], v[194:195]
v_pk_add_f32 v[32:33], v[32:33], v[214:215]
v_pk_add_f32 v[34:35], v[34:35], v[196:197]
v_mfma_f32_16x16x32_bf16 v[220:223], a[112:115], v[40:43], 0
v_pk_add_f32 v[32:33], v[32:33], v[216:217]
v_pk_add_f32 v[34:35], v[34:35], v[198:199]
v_pk_add_f32 v[32:33], v[32:33], v[218:219]
v_add_f32 v34, v34, v35
v_mfma_f32_16x16x32_bf16 v[224:227], a[124:127], v[40:43], 0
v_add_f32 v32, v32, v33
v_rcp_f32 v34, v34
v_rcp_f32 v32, v32
v_pk_mul_f32 v[180:181], v[180:181], v[34:35] op_sel_hi:[1,0]
v_mfma_f32_16x16x32_bf16 v[228:231], a[136:139], v[40:43], 0
v_pk_mul_f32 v[200:201], v[200:201], v[32:33] op_sel_hi:[1,0]
v_pk_mul_f32 v[182:183], v[182:183], v[34:35] op_sel_hi:[1,0]
v_pk_mul_f32 v[202:203], v[202:203], v[32:33] op_sel_hi:[1,0]
v_pk_mul_f32 v[184:185], v[184:185], v[34:35] op_sel_hi:[1,0]
v_mfma_f32_16x16x32_bf16 v[232:235], a[148:151], v[40:43], 0
v_pk_mul_f32 v[204:205], v[204:205], v[32:33] op_sel_hi:[1,0]
v_pk_mul_f32 v[186:187], v[186:187], v[34:35] op_sel_hi:[1,0]
v_pk_mul_f32 v[206:207], v[206:207], v[32:33] op_sel_hi:[1,0]
v_pk_mul_f32 v[188:189], v[188:189], v[34:35] op_sel_hi:[1,0]
v_mfma_f32_16x16x32_bf16 v[236:239], a[160:163], v[40:43], 0
v_pk_mul_f32 v[208:209], v[208:209], v[32:33] op_sel_hi:[1,0]
v_pk_mul_f32 v[190:191], v[190:191], v[34:35] op_sel_hi:[1,0]
v_pk_mul_f32 v[210:211], v[210:211], v[32:33] op_sel_hi:[1,0]
v_pk_mul_f32 v[192:193], v[192:193], v[34:35] op_sel_hi:[1,0]
v_pk_mul_f32 v[212:213], v[212:213], v[32:33] op_sel_hi:[1,0]
v_mfma_f32_16x16x32_bf16 v[220:223], a[116:119], v[44:47], v[220:223]
v_pk_mul_f32 v[194:195], v[194:195], v[34:35] op_sel_hi:[1,0]
v_pk_mul_f32 v[214:215], v[214:215], v[32:33] op_sel_hi:[1,0]
v_pk_mul_f32 v[196:197], v[196:197], v[34:35] op_sel_hi:[1,0]
v_pk_mul_f32 v[216:217], v[216:217], v[32:33] op_sel_hi:[1,0]
v_mfma_f32_16x16x32_bf16 v[224:227], a[128:131], v[44:47], v[224:227]
v_pk_mul_f32 v[198:199], v[198:199], v[34:35] op_sel_hi:[1,0]
v_pk_mul_f32 v[218:219], v[218:219], v[32:33] op_sel_hi:[1,0]
v_cvt_pk_bf16_f32 v0, v200, v201
v_cvt_pk_bf16_f32 v1, v202, v203
v_mfma_f32_16x16x32_bf16 v[228:231], a[140:143], v[44:47], v[228:231]
v_cvt_pk_bf16_f32 v2, v205, v206
v_cvt_pk_bf16_f32 v3, v207, v208
v_cvt_pk_bf16_f32 v4, v210, v211
v_cvt_pk_bf16_f32 v5, v212, v213
v_mfma_f32_16x16x32_bf16 v[232:235], a[152:155], v[44:47], v[232:235]
v_cvt_pk_bf16_f32 v6, v215, v216
v_cvt_pk_bf16_f32 v7, v217, v218
ds_write_b128 v244, v[0:3] offset:0
ds_write_b128 v244, v[4:7] offset:16
v_mfma_f32_16x16x32_bf16 v[236:239], a[164:167], v[44:47], v[236:239]
v_cvt_pk_bf16_f32 v8, v204, v180
v_cvt_pk_bf16_f32 v9, v181, v182
v_cvt_pk_bf16_f32 v10, v209, v185
v_cvt_pk_bf16_f32 v11, v186, v187
v_mfma_f32_16x16x32_bf16 v[220:223], a[120:123], v[48:51], v[220:223]
v_cvt_pk_bf16_f32 v12, v214, v190
v_cvt_pk_bf16_f32 v13, v191, v192
v_cvt_pk_bf16_f32 v14, v219, v195
v_cvt_pk_bf16_f32 v15, v196, v197
v_mfma_f32_16x16x32_bf16 v[224:227], a[132:135], v[48:51], v[224:227]
ds_write_b128 v244, v[8:11] offset:8192
ds_write_b128 v244, v[12:15] offset:8208
v_cvt_pk_bf16_f32 v32, v183, v184
v_cvt_pk_bf16_f32 v34, v188, v189
v_mfma_f32_16x16x32_bf16 v[228:231], a[144:147], v[48:51], v[228:231]
v_cvt_pk_bf16_f32 v36, v193, v194
v_cvt_pk_bf16_f32 v38, v198, v199
v_mov_b32 v33, v28
v_mov_b32 v35, v29
v_mfma_f32_16x16x32_bf16 v[232:235], a[156:159], v[48:51], v[232:235]
v_mov_b32 v37, 0x3f80
v_mov_b32 v39, 0
ds_write_b128 v244, v[32:35] offset:16384
ds_write_b128 v244, v[36:39] offset:16400
v_mfma_f32_16x16x32_bf16 v[236:239], a[168:171], v[48:51], v[236:239]
v_mul_f32 v60, 1.4426950408889634, v249
v_sub_f32 v62, 0, v60
v_max3_f32 v70, v220, v221, v222
v_min3_f32 v71, v220, v221, v222
v_max3_f32 v70, v70, v223, v224
v_sub_f32 v240, 0, v250
v_min3_f32 v71, v71, v223, v224
v_max3_f32 v70, v70, v225, v226
v_min3_f32 v71, v71, v225, v226
v_max3_f32 v70, v70, v227, v228
v_pk_fma_f32 v[80:81], v[160:161], v[240:241], v[80:81] op_sel_hi:[1,0,1]
v_min3_f32 v71, v71, v227, v228
v_max3_f32 v70, v70, v229, v230
v_min3_f32 v71, v71, v229, v230
v_max3_f32 v70, v70, v231, v232
v_pk_fma_f32 v[82:83], v[162:163], v[240:241], v[82:83] op_sel_hi:[1,0,1]
v_min3_f32 v71, v71, v231, v232
v_max3_f32 v70, v70, v233, v234
v_min3_f32 v71, v71, v233, v234
v_max3_f32 v70, v70, v235, v236
v_pk_fma_f32 v[84:85], v[164:165], v[240:241], v[84:85] op_sel_hi:[1,0,1]
v_min3_f32 v71, v71, v235, v236
v_max3_f32 v70, v70, v237, v238
v_min3_f32 v71, v71, v237, v238
v_max_f32 v70, v70, v239
v_pk_fma_f32 v[86:87], v[166:167], v[240:241], v[86:87] op_sel_hi:[1,0,1]
v_min_f32 v71, v71, v239
v_mul_f32 v64, v70, v62
v_mul_f32 v66, v71, v60
v_pk_fma_f32 v[180:181], v[220:221], v[62:63], v[66:67] op_sel_hi:[1,0,0]
v_pk_fma_f32 v[88:89], v[168:169], v[240:241], v[88:89] op_sel_hi:[1,0,1]
v_pk_fma_f32 v[182:183], v[222:223], v[62:63], v[66:67] op_sel_hi:[1,0,0]
v_pk_fma_f32 v[184:185], v[224:225], v[62:63], v[66:67] op_sel_hi:[1,0,0]
v_pk_fma_f32 v[186:187], v[226:227], v[62:63], v[66:67] op_sel_hi:[1,0,0]
v_pk_fma_f32 v[188:189], v[228:229], v[62:63], v[66:67] op_sel_hi:[1,0,0]
v_pk_fma_f32 v[90:91], v[170:171], v[240:241], v[90:91] op_sel_hi:[1,0,1]
v_pk_fma_f32 v[190:191], v[230:231], v[62:63], v[66:67] op_sel_hi:[1,0,0]
v_pk_fma_f32 v[192:193], v[232:233], v[62:63], v[66:67] op_sel_hi:[1,0,0]
v_pk_fma_f32 v[194:195], v[234:235], v[62:63], v[66:67] op_sel_hi:[1,0,0]
v_pk_fma_f32 v[196:197], v[236:237], v[62:63], v[66:67] op_sel_hi:[1,0,0]
v_pk_fma_f32 v[92:93], v[172:173], v[240:241], v[92:93] op_sel_hi:[1,0,1]
v_pk_fma_f32 v[198:199], v[238:239], v[62:63], v[66:67] op_sel_hi:[1,0,0]
v_pk_fma_f32 v[220:221], v[220:221], v[60:61], v[64:65] op_sel_hi:[1,0,0]
v_pk_fma_f32 v[222:223], v[222:223], v[60:61], v[64:65] op_sel_hi:[1,0,0]
v_pk_fma_f32 v[224:225], v[224:225], v[60:61], v[64:65] op_sel_hi:[1,0,0]
v_pk_fma_f32 v[94:95], v[174:175], v[240:241], v[94:95] op_sel_hi:[1,0,1]
v_pk_fma_f32 v[226:227], v[226:227], v[60:61], v[64:65] op_sel_hi:[1,0,0]
v_pk_fma_f32 v[228:229], v[228:229], v[60:61], v[64:65] op_sel_hi:[1,0,0]
v_pk_fma_f32 v[230:231], v[230:231], v[60:61], v[64:65] op_sel_hi:[1,0,0]
v_pk_fma_f32 v[232:233], v[232:233], v[60:61], v[64:65] op_sel_hi:[1,0,0]
v_pk_fma_f32 v[234:235], v[234:235], v[60:61], v[64:65] op_sel_hi:[1,0,0]
v_pk_fma_f32 v[96:97], v[176:177], v[240:241], v[96:97] op_sel_hi:[1,0,1]
v_pk_fma_f32 v[236:237], v[236:237], v[60:61], v[64:65] op_sel_hi:[1,0,0]
v_pk_fma_f32 v[238:239], v[238:239], v[60:61], v[64:65] op_sel_hi:[1,0,0]
v_exp_f32 v180, v180
v_exp_f32 v181, v181
v_pk_fma_f32 v[98:99], v[178:179], v[240:241], v[98:99] op_sel_hi:[1,0,1]
v_exp_f32 v182, v182
v_exp_f32 v183, v183
v_exp_f32 v184, v184
v_exp_f32 v185, v185
v_cvt_pk_bf16_f32 v80, v80, v81
v_exp_f32 v186, v186
v_exp_f32 v187, v187
v_exp_f32 v188, v188
v_exp_f32 v189, v189
v_cvt_pk_bf16_f32 v81, v82, v83
v_exp_f32 v190, v190
v_exp_f32 v191, v191
v_exp_f32 v192, v192
v_exp_f32 v193, v193
v_cvt_pk_bf16_f32 v82, v84, v85
v_exp_f32 v194, v194
v_exp_f32 v195, v195
v_exp_f32 v196, v196
v_exp_f32 v197, v197
v_cvt_pk_bf16_f32 v83, v86, v87
v_exp_f32 v198, v198
v_exp_f32 v199, v199
v_exp_f32 v220, v220
v_exp_f32 v221, v221
v_cvt_pk_bf16_f32 v84, v88, v89
v_exp_f32 v222, v222
v_exp_f32 v223, v223
v_exp_f32 v224, v224
v_exp_f32 v225, v225
v_cvt_pk_bf16_f32 v85, v90, v91
v_exp_f32 v226, v226
v_exp_f32 v227, v227
v_exp_f32 v228, v228
v_exp_f32 v229, v229
v_cvt_pk_bf16_f32 v86, v92, v93
v_exp_f32 v230, v230
v_exp_f32 v231, v231
v_exp_f32 v232, v232
v_exp_f32 v233, v233
v_cvt_pk_bf16_f32 v87, v94, v95
v_exp_f32 v234, v234
v_exp_f32 v235, v235
v_exp_f32 v236, v236
v_exp_f32 v237, v237
v_exp_f32 v238, v238
v_cvt_pk_bf16_f32 v88, v96, v97
v_exp_f32 v239, v239
v_pk_add_f32 v[74:75], v[180:181], v[182:183]
v_pk_add_f32 v[72:73], v[220:221], v[222:223]
v_pk_add_f32 v[74:75], v[74:75], v[184:185]
v_cvt_pk_bf16_f32 v89, v98, v99
v_pk_add_f32 v[72:73], v[72:73], v[224:225]
v_pk_add_f32 v[74:75], v[74:75], v[186:187]
v_pk_add_f32 v[72:73], v[72:73], v[226:227]
v_pk_add_f32 v[74:75], v[74:75], v[188:189]
v_mov_b32 v90, 0
v_pk_add_f32 v[72:73], v[72:73], v[228:229]
v_pk_add_f32 v[74:75], v[74:75], v[190:191]
v_pk_add_f32 v[72:73], v[72:73], v[230:231]
v_pk_add_f32 v[74:75], v[74:75], v[192:193]
v_mov_b32 v91, 0
v_pk_add_f32 v[72:73], v[72:73], v[232:233]
v_pk_add_f32 v[74:75], v[74:75], v[194:195]
v_pk_add_f32 v[72:73], v[72:73], v[234:235]
v_pk_add_f32 v[74:75], v[74:75], v[196:197]
v_mfma_f32_16x16x32_bf16 v[200:203], a[112:115], v[80:83], 0
v_pk_add_f32 v[72:73], v[72:73], v[236:237]
v_pk_add_f32 v[74:75], v[74:75], v[198:199]
v_pk_add_f32 v[72:73], v[72:73], v[238:239]
v_add_f32 v74, v74, v75
v_mfma_f32_16x16x32_bf16 v[204:207], a[124:127], v[80:83], 0
v_add_f32 v72, v72, v73
v_rcp_f32 v74, v74
v_rcp_f32 v72, v72
v_pk_mul_f32 v[180:181], v[180:181], v[74:75] op_sel_hi:[1,0]
v_mfma_f32_16x16x32_bf16 v[208:211], a[136:139], v[80:83], 0
v_pk_mul_f32 v[220:221], v[220:221], v[72:73] op_sel_hi:[1,0]
v_pk_mul_f32 v[182:183], v[182:183], v[74:75] op_sel_hi:[1,0]
v_pk_mul_f32 v[222:223], v[222:223], v[72:73] op_sel_hi:[1,0]
v_pk_mul_f32 v[184:185], v[184:185], v[74:75] op_sel_hi:[1,0]
v_mfma_f32_16x16x32_bf16 v[212:215], a[148:151], v[80:83], 0
v_pk_mul_f32 v[224:225], v[224:225], v[72:73] op_sel_hi:[1,0]
v_pk_mul_f32 v[186:187], v[186:187], v[74:75] op_sel_hi:[1,0]
v_pk_mul_f32 v[226:227], v[226:227], v[72:73] op_sel_hi:[1,0]
v_pk_mul_f32 v[188:189], v[188:189], v[74:75] op_sel_hi:[1,0]
v_mfma_f32_16x16x32_bf16 v[216:219], a[160:163], v[80:83], 0
v_pk_mul_f32 v[228:229], v[228:229], v[72:73] op_sel_hi:[1,0]
v_pk_mul_f32 v[190:191], v[190:191], v[74:75] op_sel_hi:[1,0]
v_pk_mul_f32 v[230:231], v[230:231], v[72:73] op_sel_hi:[1,0]
v_pk_mul_f32 v[192:193], v[192:193], v[74:75] op_sel_hi:[1,0]
v_pk_mul_f32 v[232:233], v[232:233], v[72:73] op_sel_hi:[1,0]
v_mfma_f32_16x16x32_bf16 v[200:203], a[116:119], v[84:87], v[200:203]
v_pk_mul_f32 v[194:195], v[194:195], v[74:75] op_sel_hi:[1,0]
v_pk_mul_f32 v[234:235], v[234:235], v[72:73] op_sel_hi:[1,0]
v_pk_mul_f32 v[196:197], v[196:197], v[74:75] op_sel_hi:[1,0]
v_pk_mul_f32 v[236:237], v[236:237], v[72:73] op_sel_hi:[1,0]
v_mfma_f32_16x16x32_bf16 v[204:207], a[128:131], v[84:87], v[204:207]
v_pk_mul_f32 v[198:199], v[198:199], v[74:75] op_sel_hi:[1,0]
v_pk_mul_f32 v[238:239], v[238:239], v[72:73] op_sel_hi:[1,0]
v_cvt_pk_bf16_f32 v40, v220, v221
v_cvt_pk_bf16_f32 v41, v222, v223
v_mfma_f32_16x16x32_bf16 v[208:211], a[140:143], v[84:87], v[208:211]
v_cvt_pk_bf16_f32 v42, v225, v226
v_cvt_pk_bf16_f32 v43, v227, v228
v_cvt_pk_bf16_f32 v44, v230, v231
v_cvt_pk_bf16_f32 v45, v232, v233
v_mfma_f32_16x16x32_bf16 v[212:215], a[152:155], v[84:87], v[212:215]
v_cvt_pk_bf16_f32 v46, v235, v236
v_cvt_pk_bf16_f32 v47, v237, v238
ds_write_b128 v244, v[40:43] offset:512
ds_write_b128 v244, v[44:47] offset:528
v_mfma_f32_16x16x32_bf16 v[216:219], a[164:167], v[84:87], v[216:219]
v_cvt_pk_bf16_f32 v48, v224, v180
v_cvt_pk_bf16_f32 v49, v181, v182
v_cvt_pk_bf16_f32 v50, v229, v185
v_cvt_pk_bf16_f32 v51, v186, v187
v_mfma_f32_16x16x32_bf16 v[200:203], a[120:123], v[88:91], v[200:203]
v_cvt_pk_bf16_f32 v52, v234, v190
v_cvt_pk_bf16_f32 v53, v191, v192
v_cvt_pk_bf16_f32 v54, v239, v195
v_cvt_pk_bf16_f32 v55, v196, v197
v_mfma_f32_16x16x32_bf16 v[204:207], a[132:135], v[88:91], v[204:207]
ds_write_b128 v244, v[48:51] offset:8704
ds_write_b128 v244, v[52:55] offset:8720
v_cvt_pk_bf16_f32 v72, v183, v184
v_cvt_pk_bf16_f32 v74, v188, v189
v_mfma_f32_16x16x32_bf16 v[208:211], a[144:147], v[88:91], v[208:211]
v_cvt_pk_bf16_f32 v76, v193, v194
v_cvt_pk_bf16_f32 v78, v198, v199
v_mov_b32 v73, v68
v_mov_b32 v75, v69
v_mfma_f32_16x16x32_bf16 v[212:215], a[156:159], v[88:91], v[212:215]
v_mov_b32 v77, 0x3f80
v_mov_b32 v79, 0
ds_write_b128 v244, v[72:75] offset:16896
ds_write_b128 v244, v[76:79] offset:16912
v_mfma_f32_16x16x32_bf16 v[216:219], a[168:171], v[88:91], v[216:219]
s_waitcnt lgkmcnt(0)
s_barrier
v_mul_f32 v100, 1.4426950408889634, v251
v_sub_f32 v102, 0, v100
v_max3_f32 v110, v200, v201, v202
v_min3_f32 v111, v200, v201, v202
v_max3_f32 v110, v110, v203, v204
v_lshrrev_b32 v64, 4, v255
v_sub_f32 v240, 0, v252
v_min3_f32 v111, v111, v203, v204
v_max3_f32 v110, v110, v205, v206
v_min3_f32 v111, v111, v205, v206
v_max3_f32 v110, v110, v207, v208
v_and_b32 v65, 15, v255
v_pk_fma_f32 v[120:121], v[160:161], v[240:241], v[120:121] op_sel_hi:[1,0,1]
v_min3_f32 v111, v111, v207, v208
v_max3_f32 v110, v110, v209, v210
v_min3_f32 v111, v111, v209, v210
v_max3_f32 v110, v110, v211, v212
v_lshrrev_b32 v66, 2, v65
v_pk_fma_f32 v[122:123], v[162:163], v[240:241], v[122:123] op_sel_hi:[1,0,1]
v_min3_f32 v111, v111, v211, v212
v_max3_f32 v110, v110, v213, v214
v_min3_f32 v111, v111, v213, v214
v_max3_f32 v110, v110, v215, v216
v_and_b32 v67, 3, v65
v_pk_fma_f32 v[124:125], v[164:165], v[240:241], v[124:125] op_sel_hi:[1,0,1]
v_min3_f32 v111, v111, v215, v216
v_max3_f32 v110, v110, v217, v218
v_min3_f32 v111, v111, v217, v218
v_max_f32 v110, v110, v219
v_lshlrev_b32 v64, 2, v64
v_pk_fma_f32 v[126:127], v[166:167], v[240:241], v[126:127] op_sel_hi:[1,0,1]
v_min_f32 v111, v111, v219
v_mul_f32 v104, v110, v102
v_mul_f32 v106, v111, v100
v_pk_fma_f32 v[180:181], v[200:201], v[102:103], v[106:107] op_sel_hi:[1,0,0]
v_add_u32 v64, v64, v66
v_pk_fma_f32 v[128:129], v[168:169], v[240:241], v[128:129] op_sel_hi:[1,0,1]
v_pk_fma_f32 v[182:183], v[202:203], v[102:103], v[106:107] op_sel_hi:[1,0,0]
v_pk_fma_f32 v[184:185], v[204:205], v[102:103], v[106:107] op_sel_hi:[1,0,0]
v_pk_fma_f32 v[186:187], v[206:207], v[102:103], v[106:107] op_sel_hi:[1,0,0]
v_pk_fma_f32 v[188:189], v[208:209], v[102:103], v[106:107] op_sel_hi:[1,0,0]
v_lshlrev_b32 v64, 5, v64
v_pk_fma_f32 v[130:131], v[170:171], v[240:241], v[130:131] op_sel_hi:[1,0,1]
v_pk_fma_f32 v[190:191], v[210:211], v[102:103], v[106:107] op_sel_hi:[1,0,0]
v_pk_fma_f32 v[192:193], v[212:213], v[102:103], v[106:107] op_sel_hi:[1,0,0]
v_pk_fma_f32 v[194:195], v[214:215], v[102:103], v[106:107] op_sel_hi:[1,0,0]
v_pk_fma_f32 v[196:197], v[216:217], v[102:103], v[106:107] op_sel_hi:[1,0,0]
v_lshlrev_b32 v67, 3, v67
v_pk_fma_f32 v[132:133], v[172:173], v[240:241], v[132:133] op_sel_hi:[1,0,1]
v_pk_fma_f32 v[198:199], v[218:219], v[102:103], v[106:107] op_sel_hi:[1,0,0]
v_pk_fma_f32 v[200:201], v[200:201], v[100:101], v[104:105] op_sel_hi:[1,0,0]
v_pk_fma_f32 v[202:203], v[202:203], v[100:101], v[104:105] op_sel_hi:[1,0,0]
v_pk_fma_f32 v[204:205], v[204:205], v[100:101], v[104:105] op_sel_hi:[1,0,0]
v_add_u32 v64, v64, v67
v_pk_fma_f32 v[134:135], v[174:175], v[240:241], v[134:135] op_sel_hi:[1,0,1]
v_pk_fma_f32 v[206:207], v[206:207], v[100:101], v[104:105] op_sel_hi:[1,0,0]
v_pk_fma_f32 v[208:209], v[208:209], v[100:101], v[104:105] op_sel_hi:[1,0,0]
v_pk_fma_f32 v[210:211], v[210:211], v[100:101], v[104:105] op_sel_hi:[1,0,0]
v_pk_fma_f32 v[212:213], v[212:213], v[100:101], v[104:105] op_sel_hi:[1,0,0]
s_lshl_b32 s30, s24, 15
v_pk_fma_f32 v[214:215], v[214:215], v[100:101], v[104:105] op_sel_hi:[1,0,0]
v_pk_fma_f32 v[136:137], v[176:177], v[240:241], v[136:137] op_sel_hi:[1,0,1]
v_pk_fma_f32 v[216:217], v[216:217], v[100:101], v[104:105] op_sel_hi:[1,0,0]
v_pk_fma_f32 v[218:219], v[218:219], v[100:101], v[104:105] op_sel_hi:[1,0,0]
v_exp_f32 v180, v180
v_add_u32 v64, s30, v64
v_exp_f32 v181, v181
v_pk_fma_f32 v[138:139], v[178:179], v[240:241], v[138:139] op_sel_hi:[1,0,1]
v_exp_f32 v182, v182
v_exp_f32 v183, v183
v_exp_f32 v184, v184
ds_read_b64_tr_b16 v[32:33], v64 offset:0
v_exp_f32 v185, v185
v_cvt_pk_bf16_f32 v120, v120, v121
v_exp_f32 v186, v186
v_exp_f32 v187, v187
v_exp_f32 v188, v188
ds_read_b64_tr_b16 v[34:35], v64 offset:512
v_exp_f32 v189, v189
v_cvt_pk_bf16_f32 v121, v122, v123
v_exp_f32 v190, v190
v_exp_f32 v191, v191
v_exp_f32 v192, v192
ds_read_b64_tr_b16 v[36:37], v64 offset:8192
v_exp_f32 v193, v193
v_cvt_pk_bf16_f32 v122, v124, v125
v_exp_f32 v194, v194
v_exp_f32 v195, v195
ds_read_b64_tr_b16 v[38:39], v64 offset:8704
v_exp_f32 v196, v196
v_exp_f32 v197, v197
v_cvt_pk_bf16_f32 v123, v126, v127
v_exp_f32 v198, v198
v_exp_f32 v199, v199
ds_read_b64_tr_b16 v[40:41], v64 offset:16384
v_exp_f32 v200, v200
v_exp_f32 v201, v201
v_cvt_pk_bf16_f32 v124, v128, v129
v_exp_f32 v202, v202
v_exp_f32 v203, v203
ds_read_b64_tr_b16 v[42:43], v64 offset:16896
v_exp_f32 v204, v204
v_exp_f32 v205, v205
v_cvt_pk_bf16_f32 v125, v130, v131
v_exp_f32 v206, v206
v_exp_f32 v207, v207
ds_read_b64_tr_b16 v[44:45], v64 offset:24576
v_exp_f32 v208, v208
v_exp_f32 v209, v209
v_cvt_pk_bf16_f32 v126, v132, v133
v_exp_f32 v210, v210
v_exp_f32 v211, v211
ds_read_b64_tr_b16 v[46:47], v64 offset:25088
v_exp_f32 v212, v212
v_exp_f32 v213, v213
v_cvt_pk_bf16_f32 v127, v134, v135
v_exp_f32 v214, v214
v_exp_f32 v215, v215
ds_read_b64_tr_b16 v[48:49], v64 offset:2048
v_exp_f32 v216, v216
v_exp_f32 v217, v217
v_exp_f32 v218, v218
v_cvt_pk_bf16_f32 v128, v136, v137
v_exp_f32 v219, v219
ds_read_b64_tr_b16 v[50:51], v64 offset:2560
v_pk_add_f32 v[114:115], v[180:181], v[182:183]
v_pk_add_f32 v[112:113], v[200:201], v[202:203]
v_pk_add_f32 v[114:115], v[114:115], v[184:185]
v_cvt_pk_bf16_f32 v129, v138, v139
v_pk_add_f32 v[112:113], v[112:113], v[204:205]
ds_read_b64_tr_b16 v[52:53], v64 offset:10240
v_pk_add_f32 v[114:115], v[114:115], v[186:187]
v_pk_add_f32 v[112:113], v[112:113], v[206:207]
v_pk_add_f32 v[114:115], v[114:115], v[188:189]
v_mov_b32 v130, 0
v_pk_add_f32 v[112:113], v[112:113], v[208:209]
ds_read_b64_tr_b16 v[54:55], v64 offset:10752
v_pk_add_f32 v[114:115], v[114:115], v[190:191]
v_pk_add_f32 v[112:113], v[112:113], v[210:211]
v_pk_add_f32 v[114:115], v[114:115], v[192:193]
v_mov_b32 v131, 0
v_pk_add_f32 v[112:113], v[112:113], v[212:213]
ds_read_b64_tr_b16 v[56:57], v64 offset:18432
v_pk_add_f32 v[114:115], v[114:115], v[194:195]
v_pk_add_f32 v[112:113], v[112:113], v[214:215]
v_pk_add_f32 v[114:115], v[114:115], v[196:197]
v_mfma_f32_16x16x32_bf16 v[220:223], a[112:115], v[120:123], 0
v_pk_add_f32 v[112:113], v[112:113], v[216:217]
ds_read_b64_tr_b16 v[58:59], v64 offset:18944
v_pk_add_f32 v[114:115], v[114:115], v[198:199]
v_pk_add_f32 v[112:113], v[112:113], v[218:219]
v_add_f32 v114, v114, v115
v_mfma_f32_16x16x32_bf16 v[224:227], a[124:127], v[120:123], 0
v_add_f32 v112, v112, v113
ds_read_b64_tr_b16 v[60:61], v64 offset:26624
v_rcp_f32 v114, v114
v_rcp_f32 v112, v112
v_pk_mul_f32 v[180:181], v[180:181], v[114:115] op_sel_hi:[1,0]
v_mfma_f32_16x16x32_bf16 v[228:231], a[136:139], v[120:123], 0
v_pk_mul_f32 v[200:201], v[200:201], v[112:113] op_sel_hi:[1,0]
ds_read_b64_tr_b16 v[62:63], v64 offset:27136
v_pk_mul_f32 v[182:183], v[182:183], v[114:115] op_sel_hi:[1,0]
v_pk_mul_f32 v[202:203], v[202:203], v[112:113] op_sel_hi:[1,0]
v_pk_mul_f32 v[184:185], v[184:185], v[114:115] op_sel_hi:[1,0]
v_mfma_f32_16x16x32_bf16 v[232:235], a[148:151], v[120:123], 0
v_pk_mul_f32 v[204:205], v[204:205], v[112:113] op_sel_hi:[1,0]
s_waitcnt lgkmcnt(0)
v_pk_mul_f32 v[186:187], v[186:187], v[114:115] op_sel_hi:[1,0]
v_pk_mul_f32 v[206:207], v[206:207], v[112:113] op_sel_hi:[1,0]
v_pk_mul_f32 v[188:189], v[188:189], v[114:115] op_sel_hi:[1,0]
v_mfma_f32_16x16x32_bf16 v[236:239], a[160:163], v[120:123], 0
v_mfma_f32_16x16x32_bf16 v[0:3], v[32:35], v[44:47], 0
v_pk_mul_f32 v[208:209], v[208:209], v[112:113] op_sel_hi:[1,0]
v_pk_mul_f32 v[190:191], v[190:191], v[114:115] op_sel_hi:[1,0]
v_pk_mul_f32 v[210:211], v[210:211], v[112:113] op_sel_hi:[1,0]
v_pk_mul_f32 v[192:193], v[192:193], v[114:115] op_sel_hi:[1,0]
v_pk_mul_f32 v[212:213], v[212:213], v[112:113] op_sel_hi:[1,0]
v_mfma_f32_16x16x32_bf16 v[4:7], v[32:35], v[40:43], 0
v_mfma_f32_16x16x32_bf16 v[220:223], a[116:119], v[124:127], v[220:223]
v_pk_mul_f32 v[194:195], v[194:195], v[114:115] op_sel_hi:[1,0]
v_pk_mul_f32 v[214:215], v[214:215], v[112:113] op_sel_hi:[1,0]
v_pk_mul_f32 v[196:197], v[196:197], v[114:115] op_sel_hi:[1,0]
v_pk_mul_f32 v[216:217], v[216:217], v[112:113] op_sel_hi:[1,0]
v_mfma_f32_16x16x32_bf16 v[8:11], v[36:39], v[44:47], 0
v_mfma_f32_16x16x32_bf16 v[224:227], a[128:131], v[124:127], v[224:227]
v_pk_mul_f32 v[198:199], v[198:199], v[114:115] op_sel_hi:[1,0]
v_pk_mul_f32 v[218:219], v[218:219], v[112:113] op_sel_hi:[1,0]
v_cvt_pk_bf16_f32 v80, v200, v201
v_cvt_pk_bf16_f32 v81, v202, v203
v_mfma_f32_16x16x32_bf16 v[12:15], v[36:39], v[40:43], 0
v_mfma_f32_16x16x32_bf16 v[228:231], a[140:143], v[124:127], v[228:231]
v_cvt_pk_bf16_f32 v82, v205, v206
v_cvt_pk_bf16_f32 v83, v207, v208
v_cvt_pk_bf16_f32 v84, v210, v211
v_cvt_pk_bf16_f32 v85, v212, v213
v_mfma_f32_16x16x32_bf16 v[16:19], v[40:43], v[44:47], 0
v_mfma_f32_16x16x32_bf16 v[232:235], a[152:155], v[124:127], v[232:235]
v_cvt_pk_bf16_f32 v86, v215, v216
v_cvt_pk_bf16_f32 v87, v217, v218
ds_write_b128 v244, v[80:83] offset:1024
ds_write_b128 v244, v[84:87] offset:1040
v_mfma_f32_16x16x32_bf16 v[20:23], v[40:43], v[40:43], 0
v_mfma_f32_16x16x32_bf16 v[236:239], a[164:167], v[124:127], v[236:239]
v_cvt_pk_bf16_f32 v88, v204, v180
v_cvt_pk_bf16_f32 v89, v181, v182
v_cvt_pk_bf16_f32 v90, v209, v185
v_cvt_pk_bf16_f32 v91, v186, v187
ds_read_b64_tr_b16 v[32:33], v64 offset:4096
v_mfma_f32_16x16x32_bf16 v[220:223], a[120:123], v[128:131], v[220:223]
v_cvt_pk_bf16_f32 v92, v214, v190
v_cvt_pk_bf16_f32 v93, v191, v192
v_cvt_pk_bf16_f32 v94, v219, v195
v_cvt_pk_bf16_f32 v95, v196, v197
ds_read_b64_tr_b16 v[34:35], v64 offset:4608
v_mfma_f32_16x16x32_bf16 v[224:227], a[132:135], v[128:131], v[224:227]
ds_write_b128 v244, v[88:91] offset:9216
ds_write_b128 v244, v[92:95] offset:9232
v_cvt_pk_bf16_f32 v112, v183, v184
v_cvt_pk_bf16_f32 v114, v188, v189
ds_read_b64_tr_b16 v[36:37], v64 offset:12288
v_mfma_f32_16x16x32_bf16 v[228:231], a[144:147], v[128:131], v[228:231]
v_cvt_pk_bf16_f32 v116, v193, v194
v_cvt_pk_bf16_f32 v118, v198, v199
v_mov_b32 v113, v108
v_mov_b32 v115, v109
ds_read_b64_tr_b16 v[38:39], v64 offset:12800
v_mfma_f32_16x16x32_bf16 v[232:235], a[156:159], v[128:131], v[232:235]
v_mov_b32 v117, 0x3f80
v_mov_b32 v119, 0
ds_write_b128 v244, v[112:115] offset:17408
ds_write_b128 v244, v[116:119] offset:17424
ds_read_b64_tr_b16 v[40:41], v64 offset:20480
v_mfma_f32_16x16x32_bf16 v[236:239], a[168:171], v[128:131], v[236:239]
v_mul_f32 v140, 1.4426950408889634, v253
v_sub_f32 v142, 0, v140
v_max3_f32 v150, v220, v221, v222
v_min3_f32 v151, v220, v221, v222
ds_read_b64_tr_b16 v[42:43], v64 offset:20992
v_max3_f32 v150, v150, v223, v224
v_min3_f32 v151, v151, v223, v224
v_max3_f32 v150, v150, v225, v226
v_min3_f32 v151, v151, v225, v226
v_max3_f32 v150, v150, v227, v228
ds_read_b64_tr_b16 v[44:45], v64 offset:28672
v_min3_f32 v151, v151, v227, v228
v_max3_f32 v150, v150, v229, v230
v_min3_f32 v151, v151, v229, v230
v_max3_f32 v150, v150, v231, v232
v_min3_f32 v151, v151, v231, v232
ds_read_b64_tr_b16 v[46:47], v64 offset:29184
v_max3_f32 v150, v150, v233, v234
v_min3_f32 v151, v151, v233, v234
v_max3_f32 v150, v150, v235, v236
v_min3_f32 v151, v151, v235, v236
s_waitcnt lgkmcnt(0)
v_max3_f32 v150, v150, v237, v238
v_min3_f32 v151, v151, v237, v238
v_max_f32 v150, v150, v239
v_min_f32 v151, v151, v239
v_mul_f32 v144, v150, v142
v_mfma_f32_16x16x32_bf16 v[0:3], v[48:51], v[60:63], v[0:3]
v_mul_f32 v146, v151, v140
v_pk_fma_f32 v[180:181], v[220:221], v[142:143], v[146:147] op_sel_hi:[1,0,0]
v_pk_fma_f32 v[182:183], v[222:223], v[142:143], v[146:147] op_sel_hi:[1,0,0]
v_pk_fma_f32 v[184:185], v[224:225], v[142:143], v[146:147] op_sel_hi:[1,0,0]
v_pk_fma_f32 v[186:187], v[226:227], v[142:143], v[146:147] op_sel_hi:[1,0,0]
v_mfma_f32_16x16x32_bf16 v[4:7], v[48:51], v[56:59], v[4:7]
v_pk_fma_f32 v[188:189], v[228:229], v[142:143], v[146:147] op_sel_hi:[1,0,0]
v_pk_fma_f32 v[190:191], v[230:231], v[142:143], v[146:147] op_sel_hi:[1,0,0]
v_pk_fma_f32 v[192:193], v[232:233], v[142:143], v[146:147] op_sel_hi:[1,0,0]
v_pk_fma_f32 v[194:195], v[234:235], v[142:143], v[146:147] op_sel_hi:[1,0,0]
v_pk_fma_f32 v[196:197], v[236:237], v[142:143], v[146:147] op_sel_hi:[1,0,0]
v_mfma_f32_16x16x32_bf16 v[8:11], v[52:55], v[60:63], v[8:11]
v_pk_fma_f32 v[198:199], v[238:239], v[142:143], v[146:147] op_sel_hi:[1,0,0]
v_pk_fma_f32 v[220:221], v[220:221], v[140:141], v[144:145] op_sel_hi:[1,0,0]
v_pk_fma_f32 v[222:223], v[222:223], v[140:141], v[144:145] op_sel_hi:[1,0,0]
v_pk_fma_f32 v[224:225], v[224:225], v[140:141], v[144:145] op_sel_hi:[1,0,0]
v_pk_fma_f32 v[226:227], v[226:227], v[140:141], v[144:145] op_sel_hi:[1,0,0]
v_mfma_f32_16x16x32_bf16 v[12:15], v[52:55], v[56:59], v[12:15]
v_pk_fma_f32 v[228:229], v[228:229], v[140:141], v[144:145] op_sel_hi:[1,0,0]
v_pk_fma_f32 v[230:231], v[230:231], v[140:141], v[144:145] op_sel_hi:[1,0,0]
v_pk_fma_f32 v[232:233], v[232:233], v[140:141], v[144:145] op_sel_hi:[1,0,0]
v_pk_fma_f32 v[234:235], v[234:235], v[140:141], v[144:145] op_sel_hi:[1,0,0]
v_pk_fma_f32 v[236:237], v[236:237], v[140:141], v[144:145] op_sel_hi:[1,0,0]
v_mfma_f32_16x16x32_bf16 v[16:19], v[56:59], v[60:63], v[16:19]
v_pk_fma_f32 v[238:239], v[238:239], v[140:141], v[144:145] op_sel_hi:[1,0,0]
v_exp_f32 v180, v180
v_exp_f32 v181, v181
v_exp_f32 v182, v182
v_exp_f32 v183, v183
v_mfma_f32_16x16x32_bf16 v[20:23], v[56:59], v[56:59], v[20:23]
v_exp_f32 v184, v184
v_exp_f32 v185, v185
v_exp_f32 v186, v186
v_exp_f32 v187, v187
v_exp_f32 v188, v188
ds_read_b64_tr_b16 v[48:49], v64 offset:6144
v_exp_f32 v189, v189
v_exp_f32 v190, v190
v_exp_f32 v191, v191
v_exp_f32 v192, v192
v_exp_f32 v193, v193
ds_read_b64_tr_b16 v[50:51], v64 offset:6656
v_exp_f32 v194, v194
v_exp_f32 v195, v195
v_exp_f32 v196, v196
v_exp_f32 v197, v197
v_exp_f32 v198, v198
ds_read_b64_tr_b16 v[52:53], v64 offset:14336
v_exp_f32 v199, v199
v_exp_f32 v220, v220
v_exp_f32 v221, v221
v_exp_f32 v222, v222
v_exp_f32 v223, v223
ds_read_b64_tr_b16 v[54:55], v64 offset:14848
v_exp_f32 v224, v224
v_exp_f32 v225, v225
v_exp_f32 v226, v226
v_exp_f32 v227, v227
v_exp_f32 v228, v228
ds_read_b64_tr_b16 v[56:57], v64 offset:22528
v_exp_f32 v229, v229
v_exp_f32 v230, v230
v_exp_f32 v231, v231
v_exp_f32 v232, v232
v_exp_f32 v233, v233
ds_read_b64_tr_b16 v[58:59], v64 offset:23040
v_exp_f32 v234, v234
v_exp_f32 v235, v235
v_exp_f32 v236, v236
v_exp_f32 v237, v237
v_exp_f32 v238, v238
ds_read_b64_tr_b16 v[60:61], v64 offset:30720
v_exp_f32 v239, v239
v_pk_add_f32 v[154:155], v[180:181], v[182:183]
v_pk_add_f32 v[152:153], v[220:221], v[222:223]
v_pk_add_f32 v[154:155], v[154:155], v[184:185]
ds_read_b64_tr_b16 v[62:63], v64 offset:31232
v_pk_add_f32 v[152:153], v[152:153], v[224:225]
v_pk_add_f32 v[154:155], v[154:155], v[186:187]
v_pk_add_f32 v[152:153], v[152:153], v[226:227]
v_pk_add_f32 v[154:155], v[154:155], v[188:189]
v_pk_add_f32 v[152:153], v[152:153], v[228:229]
s_waitcnt lgkmcnt(0)
v_pk_add_f32 v[154:155], v[154:155], v[190:191]
v_pk_add_f32 v[152:153], v[152:153], v[230:231]
v_pk_add_f32 v[154:155], v[154:155], v[192:193]
v_pk_add_f32 v[152:153], v[152:153], v[232:233]
v_pk_add_f32 v[154:155], v[154:155], v[194:195]
v_mfma_f32_16x16x32_bf16 v[0:3], v[32:35], v[44:47], v[0:3]
v_pk_add_f32 v[152:153], v[152:153], v[234:235]
v_pk_add_f32 v[154:155], v[154:155], v[196:197]
v_pk_add_f32 v[152:153], v[152:153], v[236:237]
v_pk_add_f32 v[154:155], v[154:155], v[198:199]
v_pk_add_f32 v[152:153], v[152:153], v[238:239]
v_mfma_f32_16x16x32_bf16 v[4:7], v[32:35], v[40:43], v[4:7]
v_add_f32 v154, v154, v155
v_add_f32 v152, v152, v153
v_rcp_f32 v154, v154
v_rcp_f32 v152, v152
v_pk_mul_f32 v[180:181], v[180:181], v[154:155] op_sel_hi:[1,0]
v_mfma_f32_16x16x32_bf16 v[8:11], v[36:39], v[44:47], v[8:11]
v_pk_mul_f32 v[220:221], v[220:221], v[152:153] op_sel_hi:[1,0]
v_pk_mul_f32 v[182:183], v[182:183], v[154:155] op_sel_hi:[1,0]
v_pk_mul_f32 v[222:223], v[222:223], v[152:153] op_sel_hi:[1,0]
v_pk_mul_f32 v[184:185], v[184:185], v[154:155] op_sel_hi:[1,0]
v_pk_mul_f32 v[224:225], v[224:225], v[152:153] op_sel_hi:[1,0]
v_mfma_f32_16x16x32_bf16 v[12:15], v[36:39], v[40:43], v[12:15]
v_pk_mul_f32 v[186:187], v[186:187], v[154:155] op_sel_hi:[1,0]
v_pk_mul_f32 v[226:227], v[226:227], v[152:153] op_sel_hi:[1,0]
v_pk_mul_f32 v[188:189], v[188:189], v[154:155] op_sel_hi:[1,0]
v_pk_mul_f32 v[228:229], v[228:229], v[152:153] op_sel_hi:[1,0]
v_pk_mul_f32 v[190:191], v[190:191], v[154:155] op_sel_hi:[1,0]
v_mfma_f32_16x16x32_bf16 v[16:19], v[40:43], v[44:47], v[16:19]
v_pk_mul_f32 v[230:231], v[230:231], v[152:153] op_sel_hi:[1,0]
v_pk_mul_f32 v[192:193], v[192:193], v[154:155] op_sel_hi:[1,0]
v_pk_mul_f32 v[232:233], v[232:233], v[152:153] op_sel_hi:[1,0]
v_pk_mul_f32 v[194:195], v[194:195], v[154:155] op_sel_hi:[1,0]
v_pk_mul_f32 v[234:235], v[234:235], v[152:153] op_sel_hi:[1,0]
v_mfma_f32_16x16x32_bf16 v[20:23], v[40:43], v[40:43], v[20:23]
v_pk_mul_f32 v[196:197], v[196:197], v[154:155] op_sel_hi:[1,0]
v_pk_mul_f32 v[236:237], v[236:237], v[152:153] op_sel_hi:[1,0]
v_pk_mul_f32 v[198:199], v[198:199], v[154:155] op_sel_hi:[1,0]
v_pk_mul_f32 v[238:239], v[238:239], v[152:153] op_sel_hi:[1,0]
v_cvt_pk_bf16_f32 v120, v220, v221
s_waitcnt lgkmcnt(0)
v_cvt_pk_bf16_f32 v121, v222, v223
v_cvt_pk_bf16_f32 v122, v225, v226
v_cvt_pk_bf16_f32 v123, v227, v228
v_cvt_pk_bf16_f32 v124, v230, v231
v_cvt_pk_bf16_f32 v125, v232, v233
v_mfma_f32_16x16x32_bf16 v[0:3], v[48:51], v[60:63], v[0:3]
v_cvt_pk_bf16_f32 v126, v235, v236
v_cvt_pk_bf16_f32 v127, v237, v238
ds_write_b128 v244, v[120:123] offset:1536
ds_write_b128 v244, v[124:127] offset:1552
v_cvt_pk_bf16_f32 v128, v224, v180
v_mfma_f32_16x16x32_bf16 v[4:7], v[48:51], v[56:59], v[4:7]
v_cvt_pk_bf16_f32 v129, v181, v182
v_cvt_pk_bf16_f32 v130, v229, v185
v_cvt_pk_bf16_f32 v131, v186, v187
v_cvt_pk_bf16_f32 v132, v234, v190
v_cvt_pk_bf16_f32 v133, v191, v192
v_mfma_f32_16x16x32_bf16 v[8:11], v[52:55], v[60:63], v[8:11]
v_cvt_pk_bf16_f32 v134, v239, v195
v_cvt_pk_bf16_f32 v135, v196, v197
ds_write_b128 v244, v[128:131] offset:9728
ds_write_b128 v244, v[132:135] offset:9744
v_cvt_pk_bf16_f32 v152, v183, v184
v_mfma_f32_16x16x32_bf16 v[12:15], v[52:55], v[56:59], v[12:15]
v_cvt_pk_bf16_f32 v154, v188, v189
v_cvt_pk_bf16_f32 v156, v193, v194
v_cvt_pk_bf16_f32 v158, v198, v199
v_mov_b32 v153, v148
v_mov_b32 v155, v149
v_mfma_f32_16x16x32_bf16 v[16:19], v[56:59], v[60:63], v[16:19]
v_mov_b32 v157, 0x3f80
v_mov_b32 v159, 0
ds_write_b128 v244, v[152:155] offset:17920
ds_write_b128 v244, v[156:159] offset:17936
v_mfma_f32_16x16x32_bf16 v[20:23], v[56:59], v[56:59], v[20:23]
s_waitcnt lgkmcnt(0)
s_barrier
ds_read_b64_tr_b16 v[32:33], v64 offset:1024
ds_read_b64_tr_b16 v[34:35], v64 offset:1536
ds_read_b64_tr_b16 v[36:37], v64 offset:9216
ds_read_b64_tr_b16 v[38:39], v64 offset:9728
ds_read_b64_tr_b16 v[40:41], v64 offset:17408
ds_read_b64_tr_b16 v[42:43], v64 offset:17920
ds_read_b64_tr_b16 v[44:45], v64 offset:25600
ds_read_b64_tr_b16 v[46:47], v64 offset:26112
ds_read_b64_tr_b16 v[48:49], v64 offset:3072
ds_read_b64_tr_b16 v[50:51], v64 offset:3584
ds_read_b64_tr_b16 v[52:53], v64 offset:11264
ds_read_b64_tr_b16 v[54:55], v64 offset:11776
ds_read_b64_tr_b16 v[56:57], v64 offset:19456
ds_read_b64_tr_b16 v[58:59], v64 offset:19968
ds_read_b64_tr_b16 v[60:61], v64 offset:27648
ds_read_b64_tr_b16 v[62:63], v64 offset:28160
s_waitcnt lgkmcnt(8)
v_mfma_f32_16x16x32_bf16 v[0:3], v[32:35], v[44:47], v[0:3]
v_mfma_f32_16x16x32_bf16 v[4:7], v[32:35], v[40:43], v[4:7]
v_mfma_f32_16x16x32_bf16 v[8:11], v[36:39], v[44:47], v[8:11]
v_mfma_f32_16x16x32_bf16 v[12:15], v[36:39], v[40:43], v[12:15]
v_mfma_f32_16x16x32_bf16 v[16:19], v[40:43], v[44:47], v[16:19]
v_mfma_f32_16x16x32_bf16 v[20:23], v[40:43], v[40:43], v[20:23]
ds_read_b64_tr_b16 v[32:33], v64 offset:5120
ds_read_b64_tr_b16 v[34:35], v64 offset:5632
ds_read_b64_tr_b16 v[36:37], v64 offset:13312
ds_read_b64_tr_b16 v[38:39], v64 offset:13824
ds_read_b64_tr_b16 v[40:41], v64 offset:21504
ds_read_b64_tr_b16 v[42:43], v64 offset:22016
ds_read_b64_tr_b16 v[44:45], v64 offset:29696
ds_read_b64_tr_b16 v[46:47], v64 offset:30208
s_waitcnt lgkmcnt(8)
v_mfma_f32_16x16x32_bf16 v[0:3], v[48:51], v[60:63], v[0:3]
v_mfma_f32_16x16x32_bf16 v[4:7], v[48:51], v[56:59], v[4:7]
v_mfma_f32_16x16x32_bf16 v[8:11], v[52:55], v[60:63], v[8:11]
v_mfma_f32_16x16x32_bf16 v[12:15], v[52:55], v[56:59], v[12:15]
v_mfma_f32_16x16x32_bf16 v[16:19], v[56:59], v[60:63], v[16:19]
v_mfma_f32_16x16x32_bf16 v[20:23], v[56:59], v[56:59], v[20:23]
ds_read_b64_tr_b16 v[48:49], v64 offset:7168
ds_read_b64_tr_b16 v[50:51], v64 offset:7680
ds_read_b64_tr_b16 v[52:53], v64 offset:15360
ds_read_b64_tr_b16 v[54:55], v64 offset:15872
ds_read_b64_tr_b16 v[56:57], v64 offset:23552
ds_read_b64_tr_b16 v[58:59], v64 offset:24064
ds_read_b64_tr_b16 v[60:61], v64 offset:31744
ds_read_b64_tr_b16 v[62:63], v64 offset:32256
s_waitcnt lgkmcnt(8)
v_mfma_f32_16x16x32_bf16 v[0:3], v[32:35], v[44:47], v[0:3]
v_mfma_f32_16x16x32_bf16 v[4:7], v[32:35], v[40:43], v[4:7]
v_mfma_f32_16x16x32_bf16 v[8:11], v[36:39], v[44:47], v[8:11]
v_mfma_f32_16x16x32_bf16 v[12:15], v[36:39], v[40:43], v[12:15]
v_mfma_f32_16x16x32_bf16 v[16:19], v[40:43], v[44:47], v[16:19]
v_mfma_f32_16x16x32_bf16 v[20:23], v[40:43], v[40:43], v[20:23]
s_waitcnt lgkmcnt(0)
v_mfma_f32_16x16x32_bf16 v[0:3], v[48:51], v[60:63], v[0:3]
v_mfma_f32_16x16x32_bf16 v[4:7], v[48:51], v[56:59], v[4:7]
v_mfma_f32_16x16x32_bf16 v[8:11], v[52:55], v[60:63], v[8:11]
v_mfma_f32_16x16x32_bf16 v[12:15], v[52:55], v[56:59], v[12:15]
v_mfma_f32_16x16x32_bf16 v[16:19], v[56:59], v[60:63], v[16:19]
v_mfma_f32_16x16x32_bf16 v[20:23], v[56:59], v[56:59], v[20:23]
s_lshl_b32 s30, s25, 5
s_lshl_b32 s31, s26, 2
s_add_u32 s30, s30, s31
s_add_u32 s30, s30, s24
s_mul_i32 s30, s30, 5120
s_add_u32 s30, s30, 16252928
v_lshlrev_b32 v201, 5, v255
v_lshlrev_b32 v202, 3, v255
buffer_store_dwordx4 v[0:3], v201, s[20:23], s30 offen
buffer_store_dwordx4 v[8:11], v201, s[20:23], s30 offen offset:16
buffer_store_dwordx2 v[16:17], v202, s[20:23], s30 offen offset:2048
s_add_u32 s30, s30, 2560
buffer_store_dwordx4 v[4:7], v201, s[20:23], s30 offen
buffer_store_dwordx4 v[12:15], v201, s[20:23], s30 offen offset:16
buffer_store_dwordx2 v[20:21], v202, s[20:23], s30 offen offset:2048
s_endpgm
K1_end:
s_endpgm
.section .rodata,"a"
.p2align 6
.amdhsa_kernel k1_kernel
  .amdhsa_next_free_vgpr 512
  .amdhsa_next_free_sgpr 102
  .amdhsa_accum_offset 256
  .amdhsa_group_segment_fixed_size 0
  .amdhsa_kernarg_size 88
  .amdhsa_user_sgpr_count 2
  .amdhsa_user_sgpr_kernarg_segment_ptr 1
  .amdhsa_system_sgpr_workgroup_id_x 1
.end_amdhsa_kernel
.text
.globl k2_kernel
.p2align 8
.type k2_kernel,@function
k2_kernel:
s_cmp_ge_u32 s2, 256
s_cbranch_scc1 K2_end
s_load_dwordx2 s[4:5], s[0:1], 0
s_load_dwordx2 s[6:7], s[0:1], 80
s_load_dwordx2 s[34:35], s[0:1], 64
s_load_dwordx2 s[36:37], s[0:1], 72
s_load_dwordx2 s[38:39], s[0:1], 16
v_lshrrev_b32 v1, 6, v0
v_and_b32 v175, 63, v0
v_readfirstlane_b32 s33, v1
s_waitcnt lgkmcnt(0)
s_mov_b32 s16, s36
s_and_b32 s17, s37, 0xffff
s_mov_b32 s18, 256
s_mov_b32 s19, 0x20000
s_and_b32 s40, s2, 7
s_lshr_b32 s41, s2, 3
s_lshr_b32 s42, s40, 1
s_lshl_b32 s42, s42, 3
s_lshr_b32 s43, s41, 2
s_add_u32 s25, s42, s43
s_and_b32 s42, s40, 1
s_lshl_b32 s42, s42, 2
s_and_b32 s43, s41, 3
s_add_u32 s26, s42, s43
s_lshl_b32 s42, s40, 2
s_and_b32 s43, s41, 3
s_add_u32 s27, s42, s43
s_lshr_b32 s32, s2, 5
s_and_b32 s24, s33, 3
s_mov_b32 s20, s6
s_and_b32 s21, s7, 0xffff
s_mov_b32 s22, 268435456
s_mov_b32 s23, 0x20000
s_cmp_ge_u32 s33, 4
s_cbranch_scc1 K2_OW
v_lshlrev_b32 v144, 4, v175
v_add_u32 v145, 4096, v144
v_lshlrev_b32 v171, 3, v175
s_mul_i32 s44, s25, 68
s_lshl_b32 s44, s44, 12
s_add_u32 s44, s44, 3145728
s_mul_i32 s45, s26, 348160
s_add_u32 s45, s45, 131072
s_mul_i32 s46, s24, 49152
s_add_u32 s46, s46, s44
s_mul_i32 s47, s24, 61440
s_add_u32 s47, s47, s45
s_mul_i32 s48, s24, 20480
s_add_u32 s48, s48, s44
s_add_u32 s48, s48, 196608
s_mul_i32 s49, s24, 25600
s_add_u32 s49, s49, s45
s_add_u32 s49, s49, 245760
s_and_b32 s40, s26, 3
s_and_b32 s41, s25, 7
s_mov_b32 s43, s40
s_mul_i32 s40, s40, 3
s_mov_b32 s40, 0
s_mov_b32 s43, 0
s_add_u32 s80, s46, 49152
s_add_u32 s81, s47, 61440
s_add_u32 s82, s48, 20480
s_add_u32 s83, s49, 25600
s_mul_i32 s41, s40, 4096
s_add_u32 s46, s46, s41
s_mul_i32 s41, s40, 5120
s_add_u32 s47, s47, s41
s_mul_i32 s41, s43, 4096
s_add_u32 s48, s48, s41
s_mul_i32 s41, s43, 5120
s_add_u32 s49, s49, s41
s_barrier
buffer_load_dwordx4 v[0:3], v144, s[20:23], s46 offen offset:0
buffer_load_dwordx4 v[4:7], v144, s[20:23], s46 offen offset:1024
buffer_load_dwordx4 v[8:11], v144, s[20:23], s46 offen offset:2048
buffer_load_dwordx4 v[12:15], v144, s[20:23], s46 offen offset:3072
s_add_u32 s46, s46, 4096
s_cmp_ge_u32 s46, s80
s_cselect_b32 s79, 49152, 0
s_sub_u32 s46, s46, s79
buffer_load_dwordx4 v[16:19], v144, s[20:23], s47 offen offset:0
buffer_load_dwordx4 v[20:23], v144, s[20:23], s47 offen offset:1024
buffer_load_dwordx4 v[24:27], v144, s[20:23], s47 offen offset:2048
buffer_load_dwordx4 v[28:31], v144, s[20:23], s47 offen offset:3072
buffer_load_dwordx4 v[32:35], v145, s[20:23], s47 offen
s_add_u32 s47, s47, 5120
s_cmp_ge_u32 s47, s81
s_cselect_b32 s79, 61440, 0
s_sub_u32 s47, s47, s79
buffer_load_dwordx4 v[36:39], v144, s[20:23], s46 offen offset:0
buffer_load_dwordx4 v[40:43], v144, s[20:23], s46 offen offset:1024
buffer_load_dwordx4 v[44:47], v144, s[20:23], s46 offen offset:2048
buffer_load_dwordx4 v[48:51], v144, s[20:23], s46 offen offset:3072
s_add_u32 s46, s46, 4096
s_cmp_ge_u32 s46, s80
s_cselect_b32 s79, 49152, 0
s_sub_u32 s46, s46, s79
buffer_load_dwordx4 v[52:55], v144, s[20:23], s47 offen offset:0
buffer_load_dwordx4 v[56:59], v144, s[20:23], s47 offen offset:1024
buffer_load_dwordx4 v[60:63], v144, s[20:23], s47 offen offset:2048
buffer_load_dwordx4 v[64:67], v144, s[20:23], s47 offen offset:3072
buffer_load_dwordx4 v[68:71], v145, s[20:23], s47 offen
s_add_u32 s47, s47, 5120
s_cmp_ge_u32 s47, s81
s_cselect_b32 s79, 61440, 0
s_sub_u32 s47, s47, s79
buffer_load_dwordx4 v[72:75], v144, s[20:23], s46 offen offset:0
buffer_load_dwordx4 v[76:79], v144, s[20:23], s46 offen offset:1024
buffer_load_dwordx4 v[80:83], v144, s[20:23], s46 offen offset:2048
buffer_load_dwordx4 v[84:87], v144, s[20:23], s46 offen offset:3072
s_add_u32 s46, s46, 4096
s_cmp_ge_u32 s46, s80
s_cselect_b32 s79, 49152, 0
s_sub_u32 s46, s46, s79
buffer_load_dwordx4 v[88:91], v144, s[20:23], s47 offen offset:0
buffer_load_dwordx4 v[92:95], v144, s[20:23], s47 offen offset:1024
buffer_load_dwordx4 v[96:99], v144, s[20:23], s47 offen offset:2048
buffer_load_dwordx4 v[100:103], v144, s[20:23], s47 offen offset:3072
buffer_load_dwordx4 v[104:107], v145, s[20:23], s47 offen
s_add_u32 s47, s47, 5120
s_cmp_ge_u32 s47, s81
s_cselect_b32 s79, 61440, 0
s_sub_u32 s47, s47, s79
v_accvgpr_write_b32 a0, 0
v_accvgpr_write_b32 a1, 0
v_accvgpr_write_b32 a2, 0
v_accvgpr_write_b32 a3, 0
v_accvgpr_write_b32 a4, 0
v_accvgpr_write_b32 a5, 0
v_accvgpr_write_b32 a6, 0
v_accvgpr_write_b32 a7, 0
v_accvgpr_write_b32 a8, 0
v_accvgpr_write_b32 a9, 0
v_accvgpr_write_b32 a10, 0
v_accvgpr_write_b32 a11, 0
v_accvgpr_write_b32 a12, 0
v_accvgpr_write_b32 a13, 0
v_accvgpr_write_b32 a14, 0
v_accvgpr_write_b32 a15, 0
v_accvgpr_write_b32 a16, 0
v_accvgpr_write_b32 a17, 0
v_accvgpr_write_b32 a18, 0
v_accvgpr_write_b32 a19, 0
v_accvgpr_write_b32 a20, 0
v_accvgpr_write_b32 a21, 0
v_accvgpr_write_b32 a22, 0
v_accvgpr_write_b32 a23, 0
v_accvgpr_write_b32 a24, 0
v_accvgpr_write_b32 a25, 0
v_accvgpr_write_b32 a26, 0
v_accvgpr_write_b32 a27, 0
v_accvgpr_write_b32 a28, 0
v_accvgpr_write_b32 a29, 0
v_accvgpr_write_b32 a30, 0
v_accvgpr_write_b32 a31, 0
v_accvgpr_write_b32 a32, 0
v_accvgpr_write_b32 a33, 0
v_accvgpr_write_b32 a34, 0
v_accvgpr_write_b32 a35, 0
v_accvgpr_write_b32 a36, 0
v_accvgpr_write_b32 a37, 0
v_accvgpr_write_b32 a38, 0
v_accvgpr_write_b32 a39, 0
v_accvgpr_write_b32 a40, 0
v_accvgpr_write_b32 a41, 0
v_accvgpr_write_b32 a42, 0
v_accvgpr_write_b32 a43, 0
v_accvgpr_write_b32 a44, 0
v_accvgpr_write_b32 a45, 0
v_accvgpr_write_b32 a46, 0
v_accvgpr_write_b32 a47, 0
v_accvgpr_write_b32 a48, 0
v_accvgpr_write_b32 a49, 0
v_accvgpr_write_b32 a50, 0
v_accvgpr_write_b32 a51, 0
v_accvgpr_write_b32 a52, 0
v_accvgpr_write_b32 a53, 0
v_accvgpr_write_b32 a54, 0
v_accvgpr_write_b32 a55, 0
v_accvgpr_write_b32 a56, 0
v_accvgpr_write_b32 a57, 0
v_accvgpr_write_b32 a58, 0
v_accvgpr_write_b32 a59, 0
v_accvgpr_write_b32 a60, 0
v_accvgpr_write_b32 a61, 0
v_accvgpr_write_b32 a62, 0
v_accvgpr_write_b32 a63, 0
v_accvgpr_write_b32 a64, 0
v_accvgpr_write_b32 a65, 0
v_accvgpr_write_b32 a66, 0
v_accvgpr_write_b32 a67, 0
v_accvgpr_write_b32 a68, 0
v_accvgpr_write_b32 a69, 0
v_accvgpr_write_b32 a70, 0
v_accvgpr_write_b32 a71, 0
v_accvgpr_write_b32 a72, 0
v_accvgpr_write_b32 a73, 0
v_accvgpr_write_b32 a74, 0
v_accvgpr_write_b32 a75, 0
v_accvgpr_write_b32 a76, 0
v_accvgpr_write_b32 a77, 0
v_accvgpr_write_b32 a78, 0
v_accvgpr_write_b32 a79, 0
s_mov_b32 s8, s4
s_and_b32 s9, s5, 0xffff
s_mov_b32 s10, 2621440
s_mov_b32 s11, 0x20000
s_mov_b32 s12, s34
s_and_b32 s13, s35, 0xffff
s_mov_b32 s14, 2621440
s_mov_b32 s15, 0x20000
s_mov_b32 s53, s48
s_waitcnt vmcnt(18)
v_mfma_f32_16x16x32_bf16 a[0:3], v[16:19], v[0:3], a[0:3]
buffer_load_dwordx4 v[108:111], v144, s[20:23], s46 offen offset:0
v_mfma_f32_16x16x32_bf16 a[4:7], v[20:23], v[0:3], a[4:7]
v_mfma_f32_16x16x32_bf16 a[8:11], v[24:27], v[0:3], a[8:11]
buffer_load_dwordx4 v[112:115], v144, s[20:23], s46 offen offset:1024
v_mfma_f32_16x16x32_bf16 a[12:15], v[28:31], v[0:3], a[12:15]
v_mfma_f32_16x16x32_bf16 a[16:19], v[32:35], v[0:3], a[16:19]
buffer_load_dwordx4 v[116:119], v144, s[20:23], s46 offen offset:2048
v_mfma_f32_16x16x32_bf16 a[20:23], v[16:19], v[4:7], a[20:23]
v_mfma_f32_16x16x32_bf16 a[24:27], v[20:23], v[4:7], a[24:27]
buffer_load_dwordx4 v[120:123], v144, s[20:23], s46 offen offset:3072
v_mfma_f32_16x16x32_bf16 a[28:31], v[24:27], v[4:7], a[28:31]
v_mfma_f32_16x16x32_bf16 a[32:35], v[28:31], v[4:7], a[32:35]
s_add_u32 s46, s46, 4096
s_cmp_ge_u32 s46, s80
s_cselect_b32 s79, 49152, 0
s_sub_u32 s46, s46, s79
v_mfma_f32_16x16x32_bf16 a[36:39], v[32:35], v[4:7], a[36:39]
v_mfma_f32_16x16x32_bf16 a[40:43], v[16:19], v[8:11], a[40:43]
buffer_load_dwordx4 v[124:127], v144, s[20:23], s47 offen offset:0
v_mfma_f32_16x16x32_bf16 a[44:47], v[20:23], v[8:11], a[44:47]
buffer_load_dwordx4 v[128:131], v144, s[20:23], s47 offen offset:1024
v_mfma_f32_16x16x32_bf16 a[48:51], v[24:27], v[8:11], a[48:51]
v_mfma_f32_16x16x32_bf16 a[52:55], v[28:31], v[8:11], a[52:55]
buffer_load_dwordx4 v[132:135], v144, s[20:23], s47 offen offset:2048
v_mfma_f32_16x16x32_bf16 a[56:59], v[32:35], v[8:11], a[56:59]
v_mfma_f32_16x16x32_bf16 a[60:63], v[16:19], v[12:15], a[60:63]
buffer_load_dwordx4 v[136:139], v144, s[20:23], s47 offen offset:3072
v_mfma_f32_16x16x32_bf16 a[64:67], v[20:23], v[12:15], a[64:67]
v_mfma_f32_16x16x32_bf16 a[68:71], v[24:27], v[12:15], a[68:71]
buffer_load_dwordx4 v[140:143], v145, s[20:23], s47 offen
v_mfma_f32_16x16x32_bf16 a[72:75], v[28:31], v[12:15], a[72:75]
v_mfma_f32_16x16x32_bf16 a[76:79], v[32:35], v[12:15], a[76:79]
s_add_u32 s47, s47, 5120
s_cmp_ge_u32 s47, s81
s_cselect_b32 s79, 61440, 0
s_sub_u32 s47, s47, s79
s_waitcnt vmcnt(18)
v_mfma_f32_16x16x32_bf16 a[0:3], v[52:55], v[36:39], a[0:3]
buffer_load_dwordx4 v[0:3], v144, s[20:23], s46 offen offset:0
v_mfma_f32_16x16x32_bf16 a[4:7], v[56:59], v[36:39], a[4:7]
v_mfma_f32_16x16x32_bf16 a[8:11], v[60:63], v[36:39], a[8:11]
buffer_load_dwordx4 v[4:7], v144, s[20:23], s46 offen offset:1024
v_mfma_f32_16x16x32_bf16 a[12:15], v[64:67], v[36:39], a[12:15]
v_mfma_f32_16x16x32_bf16 a[16:19], v[68:71], v[36:39], a[16:19]
buffer_load_dwordx4 v[8:11], v144, s[20:23], s46 offen offset:2048
v_mfma_f32_16x16x32_bf16 a[20:23], v[52:55], v[40:43], a[20:23]
v_mfma_f32_16x16x32_bf16 a[24:27], v[56:59], v[40:43], a[24:27]
buffer_load_dwordx4 v[12:15], v144, s[20:23], s46 offen offset:3072
v_mfma_f32_16x16x32_bf16 a[28:31], v[60:63], v[40:43], a[28:31]
v_mfma_f32_16x16x32_bf16 a[32:35], v[64:67], v[40:43], a[32:35]
s_add_u32 s46, s46, 4096
s_cmp_ge_u32 s46, s80
s_cselect_b32 s79, 49152, 0
s_sub_u32 s46, s46, s79
v_mfma_f32_16x16x32_bf16 a[36:39], v[68:71], v[40:43], a[36:39]
v_mfma_f32_16x16x32_bf16 a[40:43], v[52:55], v[44:47], a[40:43]
buffer_load_dwordx4 v[16:19], v144, s[20:23], s47 offen offset:0
v_mfma_f32_16x16x32_bf16 a[44:47], v[56:59], v[44:47], a[44:47]
buffer_load_dwordx4 v[20:23], v144, s[20:23], s47 offen offset:1024
v_mfma_f32_16x16x32_bf16 a[48:51], v[60:63], v[44:47], a[48:51]
v_mfma_f32_16x16x32_bf16 a[52:55], v[64:67], v[44:47], a[52:55]
buffer_load_dwordx4 v[24:27], v144, s[20:23], s47 offen offset:2048
v_mfma_f32_16x16x32_bf16 a[56:59], v[68:71], v[44:47], a[56:59]
v_mfma_f32_16x16x32_bf16 a[60:63], v[52:55], v[48:51], a[60:63]
buffer_load_dwordx4 v[28:31], v144, s[20:23], s47 offen offset:3072
v_mfma_f32_16x16x32_bf16 a[64:67], v[56:59], v[48:51], a[64:67]
v_mfma_f32_16x16x32_bf16 a[68:71], v[60:63], v[48:51], a[68:71]
buffer_load_dwordx4 v[32:35], v145, s[20:23], s47 offen
v_mfma_f32_16x16x32_bf16 a[72:75], v[64:67], v[48:51], a[72:75]
v_mfma_f32_16x16x32_bf16 a[76:79], v[68:71], v[48:51], a[76:79]
s_add_u32 s47, s47, 5120
s_cmp_ge_u32 s47, s81
s_cselect_b32 s79, 61440, 0
s_sub_u32 s47, s47, s79
s_waitcnt vmcnt(18)
v_mfma_f32_16x16x32_bf16 a[0:3], v[88:91], v[72:75], a[0:3]
buffer_load_dwordx4 v[36:39], v144, s[20:23], s46 offen offset:0
v_mfma_f32_16x16x32_bf16 a[4:7], v[92:95], v[72:75], a[4:7]
v_mfma_f32_16x16x32_bf16 a[8:11], v[96:99], v[72:75], a[8:11]
buffer_load_dwordx4 v[40:43], v144, s[20:23], s46 offen offset:1024
v_mfma_f32_16x16x32_bf16 a[12:15], v[100:103], v[72:75], a[12:15]
v_mfma_f32_16x16x32_bf16 a[16:19], v[104:107], v[72:75], a[16:19]
buffer_load_dwordx4 v[44:47], v144, s[20:23], s46 offen offset:2048
v_mfma_f32_16x16x32_bf16 a[20:23], v[88:91], v[76:79], a[20:23]
v_mfma_f32_16x16x32_bf16 a[24:27], v[92:95], v[76:79], a[24:27]
buffer_load_dwordx4 v[48:51], v144, s[20:23], s46 offen offset:3072
v_mfma_f32_16x16x32_bf16 a[28:31], v[96:99], v[76:79], a[28:31]
v_mfma_f32_16x16x32_bf16 a[32:35], v[100:103], v[76:79], a[32:35]
s_add_u32 s46, s46, 4096
s_cmp_ge_u32 s46, s80
s_cselect_b32 s79, 49152, 0
s_sub_u32 s46, s46, s79
v_mfma_f32_16x16x32_bf16 a[36:39], v[104:107], v[76:79], a[36:39]
v_mfma_f32_16x16x32_bf16 a[40:43], v[88:91], v[80:83], a[40:43]
buffer_load_dwordx4 v[52:55], v144, s[20:23], s47 offen offset:0
v_mfma_f32_16x16x32_bf16 a[44:47], v[92:95], v[80:83], a[44:47]
buffer_load_dwordx4 v[56:59], v144, s[20:23], s47 offen offset:1024
v_mfma_f32_16x16x32_bf16 a[48:51], v[96:99], v[80:83], a[48:51]
v_mfma_f32_16x16x32_bf16 a[52:55], v[100:103], v[80:83], a[52:55]
buffer_load_dwordx4 v[60:63], v144, s[20:23], s47 offen offset:2048
v_mfma_f32_16x16x32_bf16 a[56:59], v[104:107], v[80:83], a[56:59]
v_mfma_f32_16x16x32_bf16 a[60:63], v[88:91], v[84:87], a[60:63]
buffer_load_dwordx4 v[64:67], v144, s[20:23], s47 offen offset:3072
v_mfma_f32_16x16x32_bf16 a[64:67], v[92:95], v[84:87], a[64:67]
v_mfma_f32_16x16x32_bf16 a[68:71], v[96:99], v[84:87], a[68:71]
buffer_load_dwordx4 v[68:71], v145, s[20:23], s47 offen
v_mfma_f32_16x16x32_bf16 a[72:75], v[100:103], v[84:87], a[72:75]
v_mfma_f32_16x16x32_bf16 a[76:79], v[104:107], v[84:87], a[76:79]
s_add_u32 s47, s47, 5120
s_cmp_ge_u32 s47, s81
s_cselect_b32 s79, 61440, 0
s_sub_u32 s47, s47, s79
s_waitcnt vmcnt(18)
v_mfma_f32_16x16x32_bf16 a[0:3], v[124:127], v[108:111], a[0:3]
buffer_load_dwordx4 v[72:75], v144, s[20:23], s46 offen offset:0
v_mfma_f32_16x16x32_bf16 a[4:7], v[128:131], v[108:111], a[4:7]
v_mfma_f32_16x16x32_bf16 a[8:11], v[132:135], v[108:111], a[8:11]
buffer_load_dwordx4 v[76:79], v144, s[20:23], s46 offen offset:1024
v_mfma_f32_16x16x32_bf16 a[12:15], v[136:139], v[108:111], a[12:15]
v_mfma_f32_16x16x32_bf16 a[16:19], v[140:143], v[108:111], a[16:19]
buffer_load_dwordx4 v[80:83], v144, s[20:23], s46 offen offset:2048
v_mfma_f32_16x16x32_bf16 a[20:23], v[124:127], v[112:115], a[20:23]
v_mfma_f32_16x16x32_bf16 a[24:27], v[128:131], v[112:115], a[24:27]
buffer_load_dwordx4 v[84:87], v144, s[20:23], s46 offen offset:3072
v_mfma_f32_16x16x32_bf16 a[28:31], v[132:135], v[112:115], a[28:31]
v_mfma_f32_16x16x32_bf16 a[32:35], v[136:139], v[112:115], a[32:35]
s_add_u32 s46, s46, 4096
s_cmp_ge_u32 s46, s80
s_cselect_b32 s79, 49152, 0
s_sub_u32 s46, s46, s79
v_mfma_f32_16x16x32_bf16 a[36:39], v[140:143], v[112:115], a[36:39]
v_mfma_f32_16x16x32_bf16 a[40:43], v[124:127], v[116:119], a[40:43]
buffer_load_dwordx4 v[88:91], v144, s[20:23], s47 offen offset:0
v_mfma_f32_16x16x32_bf16 a[44:47], v[128:131], v[116:119], a[44:47]
buffer_load_dwordx4 v[92:95], v144, s[20:23], s47 offen offset:1024
v_mfma_f32_16x16x32_bf16 a[48:51], v[132:135], v[116:119], a[48:51]
v_mfma_f32_16x16x32_bf16 a[52:55], v[136:139], v[116:119], a[52:55]
buffer_load_dwordx4 v[96:99], v144, s[20:23], s47 offen offset:2048
v_mfma_f32_16x16x32_bf16 a[56:59], v[140:143], v[116:119], a[56:59]
v_mfma_f32_16x16x32_bf16 a[60:63], v[124:127], v[120:123], a[60:63]
buffer_load_dwordx4 v[100:103], v144, s[20:23], s47 offen offset:3072
v_mfma_f32_16x16x32_bf16 a[64:67], v[128:131], v[120:123], a[64:67]
v_mfma_f32_16x16x32_bf16 a[68:71], v[132:135], v[120:123], a[68:71]
buffer_load_dwordx4 v[104:107], v145, s[20:23], s47 offen
v_mfma_f32_16x16x32_bf16 a[72:75], v[136:139], v[120:123], a[72:75]
v_mfma_f32_16x16x32_bf16 a[76:79], v[140:143], v[120:123], a[76:79]
s_add_u32 s47, s47, 5120
s_cmp_ge_u32 s47, s81
s_cselect_b32 s79, 61440, 0
s_sub_u32 s47, s47, s79
s_waitcnt vmcnt(18)
v_mfma_f32_16x16x32_bf16 a[0:3], v[16:19], v[0:3], a[0:3]
buffer_load_dwordx4 v[108:111], v144, s[20:23], s46 offen offset:0
v_mfma_f32_16x16x32_bf16 a[4:7], v[20:23], v[0:3], a[4:7]
v_mfma_f32_16x16x32_bf16 a[8:11], v[24:27], v[0:3], a[8:11]
buffer_load_dwordx4 v[112:115], v144, s[20:23], s46 offen offset:1024
v_mfma_f32_16x16x32_bf16 a[12:15], v[28:31], v[0:3], a[12:15]
v_mfma_f32_16x16x32_bf16 a[16:19], v[32:35], v[0:3], a[16:19]
buffer_load_dwordx4 v[116:119], v144, s[20:23], s46 offen offset:2048
v_mfma_f32_16x16x32_bf16 a[20:23], v[16:19], v[4:7], a[20:23]
v_mfma_f32_16x16x32_bf16 a[24:27], v[20:23], v[4:7], a[24:27]
buffer_load_dwordx4 v[120:123], v144, s[20:23], s46 offen offset:3072
v_mfma_f32_16x16x32_bf16 a[28:31], v[24:27], v[4:7], a[28:31]
v_mfma_f32_16x16x32_bf16 a[32:35], v[28:31], v[4:7], a[32:35]
s_add_u32 s46, s46, 4096
s_cmp_ge_u32 s46, s80
s_cselect_b32 s79, 49152, 0
s_sub_u32 s46, s46, s79
v_mfma_f32_16x16x32_bf16 a[36:39], v[32:35], v[4:7], a[36:39]
v_mfma_f32_16x16x32_bf16 a[40:43], v[16:19], v[8:11], a[40:43]
buffer_load_dwordx4 v[124:127], v144, s[20:23], s47 offen offset:0
v_mfma_f32_16x16x32_bf16 a[44:47], v[20:23], v[8:11], a[44:47]
buffer_load_dwordx4 v[128:131], v144, s[20:23], s47 offen offset:1024
v_mfma_f32_16x16x32_bf16 a[48:51], v[24:27], v[8:11], a[48:51]
v_mfma_f32_16x16x32_bf16 a[52:55], v[28:31], v[8:11], a[52:55]
buffer_load_dwordx4 v[132:135], v144, s[20:23], s47 offen offset:2048
v_mfma_f32_16x16x32_bf16 a[56:59], v[32:35], v[8:11], a[56:59]
v_mfma_f32_16x16x32_bf16 a[60:63], v[16:19], v[12:15], a[60:63]
buffer_load_dwordx4 v[136:139], v144, s[20:23], s47 offen offset:3072
v_mfma_f32_16x16x32_bf16 a[64:67], v[20:23], v[12:15], a[64:67]
v_mfma_f32_16x16x32_bf16 a[68:71], v[24:27], v[12:15], a[68:71]
buffer_load_dwordx4 v[140:143], v145, s[20:23], s47 offen
v_mfma_f32_16x16x32_bf16 a[72:75], v[28:31], v[12:15], a[72:75]
v_mfma_f32_16x16x32_bf16 a[76:79], v[32:35], v[12:15], a[76:79]
s_add_u32 s47, s47, 5120
s_cmp_ge_u32 s47, s81
s_cselect_b32 s79, 61440, 0
s_sub_u32 s47, s47, s79
s_waitcnt vmcnt(18)
v_mfma_f32_16x16x32_bf16 a[0:3], v[52:55], v[36:39], a[0:3]
buffer_load_dwordx4 v[0:3], v144, s[20:23], s46 offen offset:0
v_mfma_f32_16x16x32_bf16 a[4:7], v[56:59], v[36:39], a[4:7]
v_mfma_f32_16x16x32_bf16 a[8:11], v[60:63], v[36:39], a[8:11]
buffer_load_dwordx4 v[4:7], v144, s[20:23], s46 offen offset:1024
v_mfma_f32_16x16x32_bf16 a[12:15], v[64:67], v[36:39], a[12:15]
v_mfma_f32_16x16x32_bf16 a[16:19], v[68:71], v[36:39], a[16:19]
buffer_load_dwordx4 v[8:11], v144, s[20:23], s46 offen offset:2048
v_mfma_f32_16x16x32_bf16 a[20:23], v[52:55], v[40:43], a[20:23]
v_mfma_f32_16x16x32_bf16 a[24:27], v[56:59], v[40:43], a[24:27]
buffer_load_dwordx4 v[12:15], v144, s[20:23], s46 offen offset:3072
v_mfma_f32_16x16x32_bf16 a[28:31], v[60:63], v[40:43], a[28:31]
v_mfma_f32_16x16x32_bf16 a[32:35], v[64:67], v[40:43], a[32:35]
s_add_u32 s46, s46, 4096
s_cmp_ge_u32 s46, s80
s_cselect_b32 s79, 49152, 0
s_sub_u32 s46, s46, s79
v_mfma_f32_16x16x32_bf16 a[36:39], v[68:71], v[40:43], a[36:39]
v_mfma_f32_16x16x32_bf16 a[40:43], v[52:55], v[44:47], a[40:43]
buffer_load_dwordx4 v[16:19], v144, s[20:23], s47 offen offset:0
v_mfma_f32_16x16x32_bf16 a[44:47], v[56:59], v[44:47], a[44:47]
buffer_load_dwordx4 v[20:23], v144, s[20:23], s47 offen offset:1024
v_mfma_f32_16x16x32_bf16 a[48:51], v[60:63], v[44:47], a[48:51]
v_mfma_f32_16x16x32_bf16 a[52:55], v[64:67], v[44:47], a[52:55]
buffer_load_dwordx4 v[24:27], v144, s[20:23], s47 offen offset:2048
v_mfma_f32_16x16x32_bf16 a[56:59], v[68:71], v[44:47], a[56:59]
v_mfma_f32_16x16x32_bf16 a[60:63], v[52:55], v[48:51], a[60:63]
buffer_load_dwordx4 v[28:31], v144, s[20:23], s47 offen offset:3072
v_mfma_f32_16x16x32_bf16 a[64:67], v[56:59], v[48:51], a[64:67]
v_mfma_f32_16x16x32_bf16 a[68:71], v[60:63], v[48:51], a[68:71]
buffer_load_dwordx4 v[32:35], v145, s[20:23], s47 offen
v_mfma_f32_16x16x32_bf16 a[72:75], v[64:67], v[48:51], a[72:75]
v_mfma_f32_16x16x32_bf16 a[76:79], v[68:71], v[48:51], a[76:79]
s_add_u32 s47, s47, 5120
s_cmp_ge_u32 s47, s81
s_cselect_b32 s79, 61440, 0
s_sub_u32 s47, s47, s79
s_waitcnt vmcnt(18)
v_mfma_f32_16x16x32_bf16 a[0:3], v[88:91], v[72:75], a[0:3]
buffer_load_dwordx4 v[36:39], v144, s[20:23], s46 offen offset:0
v_mfma_f32_16x16x32_bf16 a[4:7], v[92:95], v[72:75], a[4:7]
v_mfma_f32_16x16x32_bf16 a[8:11], v[96:99], v[72:75], a[8:11]
buffer_load_dwordx4 v[40:43], v144, s[20:23], s46 offen offset:1024
v_mfma_f32_16x16x32_bf16 a[12:15], v[100:103], v[72:75], a[12:15]
v_mfma_f32_16x16x32_bf16 a[16:19], v[104:107], v[72:75], a[16:19]
buffer_load_dwordx4 v[44:47], v144, s[20:23], s46 offen offset:2048
v_mfma_f32_16x16x32_bf16 a[20:23], v[88:91], v[76:79], a[20:23]
v_mfma_f32_16x16x32_bf16 a[24:27], v[92:95], v[76:79], a[24:27]
buffer_load_dwordx4 v[48:51], v144, s[20:23], s46 offen offset:3072
v_mfma_f32_16x16x32_bf16 a[28:31], v[96:99], v[76:79], a[28:31]
v_mfma_f32_16x16x32_bf16 a[32:35], v[100:103], v[76:79], a[32:35]
s_add_u32 s46, s46, 4096
s_cmp_ge_u32 s46, s80
s_cselect_b32 s79, 49152, 0
s_sub_u32 s46, s46, s79
v_mfma_f32_16x16x32_bf16 a[36:39], v[104:107], v[76:79], a[36:39]
v_mfma_f32_16x16x32_bf16 a[40:43], v[88:91], v[80:83], a[40:43]
buffer_load_dwordx4 v[52:55], v144, s[20:23], s47 offen offset:0
v_mfma_f32_16x16x32_bf16 a[44:47], v[92:95], v[80:83], a[44:47]
buffer_load_dwordx4 v[56:59], v144, s[20:23], s47 offen offset:1024
v_mfma_f32_16x16x32_bf16 a[48:51], v[96:99], v[80:83], a[48:51]
v_mfma_f32_16x16x32_bf16 a[52:55], v[100:103], v[80:83], a[52:55]
buffer_load_dwordx4 v[60:63], v144, s[20:23], s47 offen offset:2048
v_mfma_f32_16x16x32_bf16 a[56:59], v[104:107], v[80:83], a[56:59]
v_mfma_f32_16x16x32_bf16 a[60:63], v[88:91], v[84:87], a[60:63]
buffer_load_dwordx4 v[64:67], v144, s[20:23], s47 offen offset:3072
v_mfma_f32_16x16x32_bf16 a[64:67], v[92:95], v[84:87], a[64:67]
v_mfma_f32_16x16x32_bf16 a[68:71], v[96:99], v[84:87], a[68:71]
buffer_load_dwordx4 v[68:71], v145, s[20:23], s47 offen
v_mfma_f32_16x16x32_bf16 a[72:75], v[100:103], v[84:87], a[72:75]
v_mfma_f32_16x16x32_bf16 a[76:79], v[104:107], v[84:87], a[76:79]
s_add_u32 s47, s47, 5120
s_cmp_ge_u32 s47, s81
s_cselect_b32 s79, 61440, 0
s_sub_u32 s47, s47, s79
s_waitcnt vmcnt(18)
v_mfma_f32_16x16x32_bf16 a[0:3], v[124:127], v[108:111], a[0:3]
buffer_load_dwordx4 v[72:75], v144, s[20:23], s46 offen offset:0
v_mfma_f32_16x16x32_bf16 a[4:7], v[128:131], v[108:111], a[4:7]
v_mfma_f32_16x16x32_bf16 a[8:11], v[132:135], v[108:111], a[8:11]
buffer_load_dwordx4 v[76:79], v144, s[20:23], s46 offen offset:1024
v_mfma_f32_16x16x32_bf16 a[12:15], v[136:139], v[108:111], a[12:15]
v_mfma_f32_16x16x32_bf16 a[16:19], v[140:143], v[108:111], a[16:19]
buffer_load_dwordx4 v[80:83], v144, s[20:23], s46 offen offset:2048
v_mfma_f32_16x16x32_bf16 a[20:23], v[124:127], v[112:115], a[20:23]
v_mfma_f32_16x16x32_bf16 a[24:27], v[128:131], v[112:115], a[24:27]
buffer_load_dwordx4 v[84:87], v144, s[20:23], s46 offen offset:3072
v_mfma_f32_16x16x32_bf16 a[28:31], v[132:135], v[112:115], a[28:31]
v_mfma_f32_16x16x32_bf16 a[32:35], v[136:139], v[112:115], a[32:35]
s_add_u32 s46, s46, 4096
s_cmp_ge_u32 s46, s80
s_cselect_b32 s79, 49152, 0
s_sub_u32 s46, s46, s79
v_mfma_f32_16x16x32_bf16 a[36:39], v[140:143], v[112:115], a[36:39]
v_mfma_f32_16x16x32_bf16 a[40:43], v[124:127], v[116:119], a[40:43]
buffer_load_dwordx4 v[88:91], v144, s[20:23], s47 offen offset:0
v_mfma_f32_16x16x32_bf16 a[44:47], v[128:131], v[116:119], a[44:47]
buffer_load_dwordx4 v[92:95], v144, s[20:23], s47 offen offset:1024
v_mfma_f32_16x16x32_bf16 a[48:51], v[132:135], v[116:119], a[48:51]
v_mfma_f32_16x16x32_bf16 a[52:55], v[136:139], v[116:119], a[52:55]
buffer_load_dwordx4 v[96:99], v144, s[20:23], s47 offen offset:2048
v_mfma_f32_16x16x32_bf16 a[56:59], v[140:143], v[116:119], a[56:59]
v_mfma_f32_16x16x32_bf16 a[60:63], v[124:127], v[120:123], a[60:63]
buffer_load_dwordx4 v[100:103], v144, s[20:23], s47 offen offset:3072
v_mfma_f32_16x16x32_bf16 a[64:67], v[128:131], v[120:123], a[64:67]
v_mfma_f32_16x16x32_bf16 a[68:71], v[132:135], v[120:123], a[68:71]
buffer_load_dwordx4 v[104:107], v145, s[20:23], s47 offen
v_mfma_f32_16x16x32_bf16 a[72:75], v[136:139], v[120:123], a[72:75]
v_mfma_f32_16x16x32_bf16 a[76:79], v[140:143], v[120:123], a[76:79]
s_add_u32 s47, s47, 5120
s_cmp_ge_u32 s47, s81
s_cselect_b32 s79, 61440, 0
s_sub_u32 s47, s47, s79
s_waitcnt vmcnt(18)
v_mfma_f32_16x16x32_bf16 a[0:3], v[16:19], v[0:3], a[0:3]
buffer_load_dwordx4 v[108:111], v144, s[20:23], s46 offen offset:0
v_mfma_f32_16x16x32_bf16 a[4:7], v[20:23], v[0:3], a[4:7]
v_mfma_f32_16x16x32_bf16 a[8:11], v[24:27], v[0:3], a[8:11]
buffer_load_dwordx4 v[112:115], v144, s[20:23], s46 offen offset:1024
v_mfma_f32_16x16x32_bf16 a[12:15], v[28:31], v[0:3], a[12:15]
v_mfma_f32_16x16x32_bf16 a[16:19], v[32:35], v[0:3], a[16:19]
buffer_load_dwordx4 v[116:119], v144, s[20:23], s46 offen offset:2048
v_mfma_f32_16x16x32_bf16 a[20:23], v[16:19], v[4:7], a[20:23]
v_mfma_f32_16x16x32_bf16 a[24:27], v[20:23], v[4:7], a[24:27]
buffer_load_dwordx4 v[120:123], v144, s[20:23], s46 offen offset:3072
v_mfma_f32_16x16x32_bf16 a[28:31], v[24:27], v[4:7], a[28:31]
v_mfma_f32_16x16x32_bf16 a[32:35], v[28:31], v[4:7], a[32:35]
s_add_u32 s46, s46, 4096
s_cmp_ge_u32 s46, s80
s_cselect_b32 s79, 49152, 0
s_sub_u32 s46, s46, s79
v_mfma_f32_16x16x32_bf16 a[36:39], v[32:35], v[4:7], a[36:39]
v_mfma_f32_16x16x32_bf16 a[40:43], v[16:19], v[8:11], a[40:43]
buffer_load_dwordx4 v[124:127], v144, s[20:23], s47 offen offset:0
v_mfma_f32_16x16x32_bf16 a[44:47], v[20:23], v[8:11], a[44:47]
buffer_load_dwordx4 v[128:131], v144, s[20:23], s47 offen offset:1024
v_mfma_f32_16x16x32_bf16 a[48:51], v[24:27], v[8:11], a[48:51]
v_mfma_f32_16x16x32_bf16 a[52:55], v[28:31], v[8:11], a[52:55]
buffer_load_dwordx4 v[132:135], v144, s[20:23], s47 offen offset:2048
v_mfma_f32_16x16x32_bf16 a[56:59], v[32:35], v[8:11], a[56:59]
v_mfma_f32_16x16x32_bf16 a[60:63], v[16:19], v[12:15], a[60:63]
buffer_load_dwordx4 v[136:139], v144, s[20:23], s47 offen offset:3072
v_mfma_f32_16x16x32_bf16 a[64:67], v[20:23], v[12:15], a[64:67]
v_mfma_f32_16x16x32_bf16 a[68:71], v[24:27], v[12:15], a[68:71]
buffer_load_dwordx4 v[140:143], v145, s[20:23], s47 offen
v_mfma_f32_16x16x32_bf16 a[72:75], v[28:31], v[12:15], a[72:75]
v_mfma_f32_16x16x32_bf16 a[76:79], v[32:35], v[12:15], a[76:79]
s_add_u32 s47, s47, 5120
s_cmp_ge_u32 s47, s81
s_cselect_b32 s79, 61440, 0
s_sub_u32 s47, s47, s79
s_waitcnt vmcnt(18)
v_mfma_f32_16x16x32_bf16 a[0:3], v[52:55], v[36:39], a[0:3]
s_mov_b32 s84, s48
v_mfma_f32_16x16x32_bf16 a[4:7], v[56:59], v[36:39], a[4:7]
buffer_load_dwordx2 v[0:1], v171, s[20:23], s48 offen offset:0 sc1
v_mfma_f32_16x16x32_bf16 a[8:11], v[60:63], v[36:39], a[8:11]
v_mfma_f32_16x16x32_bf16 a[12:15], v[64:67], v[36:39], a[12:15]
buffer_load_dwordx2 v[2:3], v171, s[20:23], s48 offen offset:512 sc1
v_mfma_f32_16x16x32_bf16 a[16:19], v[68:71], v[36:39], a[16:19]
buffer_load_dwordx2 v[4:5], v171, s[20:23], s48 offen offset:1024 sc1
v_mfma_f32_16x16x32_bf16 a[20:23], v[52:55], v[40:43], a[20:23]
buffer_load_dwordx2 v[6:7], v171, s[20:23], s48 offen offset:1536 sc1
v_mfma_f32_16x16x32_bf16 a[24:27], v[56:59], v[40:43], a[24:27]
buffer_load_dwordx2 v[8:9], v171, s[20:23], s48 offen offset:2048 sc1
v_mfma_f32_16x16x32_bf16 a[28:31], v[60:63], v[40:43], a[28:31]
v_mfma_f32_16x16x32_bf16 a[32:35], v[64:67], v[40:43], a[32:35]
buffer_load_dwordx2 v[10:11], v171, s[20:23], s48 offen offset:2560 sc1
v_mfma_f32_16x16x32_bf16 a[36:39], v[68:71], v[40:43], a[36:39]
buffer_load_dwordx2 v[12:13], v171, s[20:23], s48 offen offset:3072 sc1
v_mfma_f32_16x16x32_bf16 a[40:43], v[52:55], v[44:47], a[40:43]
buffer_load_dwordx2 v[14:15], v171, s[20:23], s48 offen offset:3584 sc1
v_mfma_f32_16x16x32_bf16 a[44:47], v[56:59], v[44:47], a[44:47]
s_add_u32 s48, s48, 4096
s_cmp_ge_u32 s48, s82
s_cselect_b32 s79, 20480, 0
s_sub_u32 s48, s48, s79
v_mfma_f32_16x16x32_bf16 a[48:51], v[60:63], v[44:47], a[48:51]
v_mfma_f32_16x16x32_bf16 a[52:55], v[64:67], v[44:47], a[52:55]
buffer_load_dwordx4 v[16:19], v144, s[20:23], s49 offen offset:0
v_mfma_f32_16x16x32_bf16 a[56:59], v[68:71], v[44:47], a[56:59]
buffer_load_dwordx4 v[20:23], v144, s[20:23], s49 offen offset:1024
v_mfma_f32_16x16x32_bf16 a[60:63], v[52:55], v[48:51], a[60:63]
buffer_load_dwordx4 v[24:27], v144, s[20:23], s49 offen offset:2048
v_mfma_f32_16x16x32_bf16 a[64:67], v[56:59], v[48:51], a[64:67]
buffer_load_dwordx4 v[28:31], v144, s[20:23], s49 offen offset:3072
v_mfma_f32_16x16x32_bf16 a[68:71], v[60:63], v[48:51], a[68:71]
v_mfma_f32_16x16x32_bf16 a[72:75], v[64:67], v[48:51], a[72:75]
buffer_load_dwordx4 v[32:35], v145, s[20:23], s49 offen
v_mfma_f32_16x16x32_bf16 a[76:79], v[68:71], v[48:51], a[76:79]
s_add_u32 s49, s49, 5120
s_cmp_ge_u32 s49, s83
s_cselect_b32 s79, 25600, 0
s_sub_u32 s49, s49, s79
s_waitcnt vmcnt(22)
v_mfma_f32_16x16x32_bf16 a[0:3], v[88:91], v[72:75], a[0:3]
s_mov_b32 s85, s48
v_mfma_f32_16x16x32_bf16 a[4:7], v[92:95], v[72:75], a[4:7]
buffer_load_dwordx2 v[36:37], v171, s[20:23], s48 offen offset:0 sc1
v_mfma_f32_16x16x32_bf16 a[8:11], v[96:99], v[72:75], a[8:11]
v_mfma_f32_16x16x32_bf16 a[12:15], v[100:103], v[72:75], a[12:15]
buffer_load_dwordx2 v[38:39], v171, s[20:23], s48 offen offset:512 sc1
v_mfma_f32_16x16x32_bf16 a[16:19], v[104:107], v[72:75], a[16:19]
buffer_load_dwordx2 v[40:41], v171, s[20:23], s48 offen offset:1024 sc1
v_mfma_f32_16x16x32_bf16 a[20:23], v[88:91], v[76:79], a[20:23]
buffer_load_dwordx2 v[42:43], v171, s[20:23], s48 offen offset:1536 sc1
v_mfma_f32_16x16x32_bf16 a[24:27], v[92:95], v[76:79], a[24:27]
buffer_load_dwordx2 v[44:45], v171, s[20:23], s48 offen offset:2048 sc1
v_mfma_f32_16x16x32_bf16 a[28:31], v[96:99], v[76:79], a[28:31]
v_mfma_f32_16x16x32_bf16 a[32:35], v[100:103], v[76:79], a[32:35]
buffer_load_dwordx2 v[46:47], v171, s[20:23], s48 offen offset:2560 sc1
v_mfma_f32_16x16x32_bf16 a[36:39], v[104:107], v[76:79], a[36:39]
buffer_load_dwordx2 v[48:49], v171, s[20:23], s48 offen offset:3072 sc1
v_mfma_f32_16x16x32_bf16 a[40:43], v[88:91], v[80:83], a[40:43]
buffer_load_dwordx2 v[50:51], v171, s[20:23], s48 offen offset:3584 sc1
v_mfma_f32_16x16x32_bf16 a[44:47], v[92:95], v[80:83], a[44:47]
s_add_u32 s48, s48, 4096
s_cmp_ge_u32 s48, s82
s_cselect_b32 s79, 20480, 0
s_sub_u32 s48, s48, s79
v_mfma_f32_16x16x32_bf16 a[48:51], v[96:99], v[80:83], a[48:51]
v_mfma_f32_16x16x32_bf16 a[52:55], v[100:103], v[80:83], a[52:55]
buffer_load_dwordx4 v[52:55], v144, s[20:23], s49 offen offset:0
v_mfma_f32_16x16x32_bf16 a[56:59], v[104:107], v[80:83], a[56:59]
buffer_load_dwordx4 v[56:59], v144, s[20:23], s49 offen offset:1024
v_mfma_f32_16x16x32_bf16 a[60:63], v[88:91], v[84:87], a[60:63]
buffer_load_dwordx4 v[60:63], v144, s[20:23], s49 offen offset:2048
v_mfma_f32_16x16x32_bf16 a[64:67], v[92:95], v[84:87], a[64:67]
buffer_load_dwordx4 v[64:67], v144, s[20:23], s49 offen offset:3072
v_mfma_f32_16x16x32_bf16 a[68:71], v[96:99], v[84:87], a[68:71]
v_mfma_f32_16x16x32_bf16 a[72:75], v[100:103], v[84:87], a[72:75]
buffer_load_dwordx4 v[68:71], v145, s[20:23], s49 offen
v_mfma_f32_16x16x32_bf16 a[76:79], v[104:107], v[84:87], a[76:79]
s_add_u32 s49, s49, 5120
s_cmp_ge_u32 s49, s83
s_cselect_b32 s79, 25600, 0
s_sub_u32 s49, s49, s79
s_waitcnt vmcnt(26)
v_mfma_f32_16x16x32_bf16 a[0:3], v[124:127], v[108:111], a[0:3]
s_mov_b32 s86, s48
v_mfma_f32_16x16x32_bf16 a[4:7], v[128:131], v[108:111], a[4:7]
buffer_load_dwordx2 v[72:73], v171, s[20:23], s48 offen offset:0 sc1
v_mfma_f32_16x16x32_bf16 a[8:11], v[132:135], v[108:111], a[8:11]
v_mfma_f32_16x16x32_bf16 a[12:15], v[136:139], v[108:111], a[12:15]
buffer_load_dwordx2 v[74:75], v171, s[20:23], s48 offen offset:512 sc1
v_mfma_f32_16x16x32_bf16 a[16:19], v[140:143], v[108:111], a[16:19]
buffer_load_dwordx2 v[76:77], v171, s[20:23], s48 offen offset:1024 sc1
v_mfma_f32_16x16x32_bf16 a[20:23], v[124:127], v[112:115], a[20:23]
buffer_load_dwordx2 v[78:79], v171, s[20:23], s48 offen offset:1536 sc1
v_mfma_f32_16x16x32_bf16 a[24:27], v[128:131], v[112:115], a[24:27]
buffer_load_dwordx2 v[80:81], v171, s[20:23], s48 offen offset:2048 sc1
v_mfma_f32_16x16x32_bf16 a[28:31], v[132:135], v[112:115], a[28:31]
v_mfma_f32_16x16x32_bf16 a[32:35], v[136:139], v[112:115], a[32:35]
buffer_load_dwordx2 v[82:83], v171, s[20:23], s48 offen offset:2560 sc1
v_mfma_f32_16x16x32_bf16 a[36:39], v[140:143], v[112:115], a[36:39]
buffer_load_dwordx2 v[84:85], v171, s[20:23], s48 offen offset:3072 sc1
v_mfma_f32_16x16x32_bf16 a[40:43], v[124:127], v[116:119], a[40:43]
buffer_load_dwordx2 v[86:87], v171, s[20:23], s48 offen offset:3584 sc1
v_mfma_f32_16x16x32_bf16 a[44:47], v[128:131], v[116:119], a[44:47]
s_add_u32 s48, s48, 4096
s_cmp_ge_u32 s48, s82
s_cselect_b32 s79, 20480, 0
s_sub_u32 s48, s48, s79
v_mfma_f32_16x16x32_bf16 a[48:51], v[132:135], v[116:119], a[48:51]
v_mfma_f32_16x16x32_bf16 a[52:55], v[136:139], v[116:119], a[52:55]
buffer_load_dwordx4 v[88:91], v144, s[20:23], s49 offen offset:0
v_mfma_f32_16x16x32_bf16 a[56:59], v[140:143], v[116:119], a[56:59]
buffer_load_dwordx4 v[92:95], v144, s[20:23], s49 offen offset:1024
v_mfma_f32_16x16x32_bf16 a[60:63], v[124:127], v[120:123], a[60:63]
buffer_load_dwordx4 v[96:99], v144, s[20:23], s49 offen offset:2048
v_mfma_f32_16x16x32_bf16 a[64:67], v[128:131], v[120:123], a[64:67]
buffer_load_dwordx4 v[100:103], v144, s[20:23], s49 offen offset:3072
v_mfma_f32_16x16x32_bf16 a[68:71], v[132:135], v[120:123], a[68:71]
v_mfma_f32_16x16x32_bf16 a[72:75], v[136:139], v[120:123], a[72:75]
buffer_load_dwordx4 v[104:107], v145, s[20:23], s49 offen
v_mfma_f32_16x16x32_bf16 a[76:79], v[140:143], v[120:123], a[76:79]
s_add_u32 s49, s49, 5120
s_cmp_ge_u32 s49, s83
s_cselect_b32 s79, 25600, 0
s_sub_u32 s49, s49, s79
s_mov_b32 s43, 0xCCCD
s_lshl_b32 s41, s25, 6
s_lshl_b32 s42, s24, 4
s_add_u32 s41, s41, s42
s_mul_i32 s44, s26, 160
v_add_u32 v166, 0, v175
v_mul_lo_u32 v167, v166, s43
v_lshrrev_b32 v167, 20, v167
v_mul_u32_u24 v168, 20, v167
v_sub_u32 v168, v166, v168
v_add_u32 v169, s41, v167
v_mul_u32_u24 v169, 1280, v169
v_lshlrev_b32 v170, 3, v168
v_add_u32 v169, v169, v170
v_add_u32 v156, s44, v169
v_add_u32 v169, s42, v167
v_mul_u32_u24 v169, 336, v169
v_lshlrev_b32 v170, 4, v168
v_add_u32 v161, v169, v170
buffer_load_dwordx2 v[146:147], v156, s[8:11], 0 offen
v_add_u32 v166, 64, v175
v_mul_lo_u32 v167, v166, s43
v_lshrrev_b32 v167, 20, v167
v_mul_u32_u24 v168, 20, v167
v_sub_u32 v168, v166, v168
v_add_u32 v169, s41, v167
v_mul_u32_u24 v169, 1280, v169
v_lshlrev_b32 v170, 3, v168
v_add_u32 v169, v169, v170
v_add_u32 v157, s44, v169
v_add_u32 v169, s42, v167
v_mul_u32_u24 v169, 336, v169
v_lshlrev_b32 v170, 4, v168
v_add_u32 v162, v169, v170
buffer_load_dwordx2 v[148:149], v157, s[8:11], 0 offen
v_add_u32 v166, 128, v175
v_mul_lo_u32 v167, v166, s43
v_lshrrev_b32 v167, 20, v167
v_mul_u32_u24 v168, 20, v167
v_sub_u32 v168, v166, v168
v_add_u32 v169, s41, v167
v_mul_u32_u24 v169, 1280, v169
v_lshlrev_b32 v170, 3, v168
v_add_u32 v169, v169, v170
v_add_u32 v158, s44, v169
v_add_u32 v169, s42, v167
v_mul_u32_u24 v169, 336, v169
v_lshlrev_b32 v170, 4, v168
v_add_u32 v163, v169, v170
buffer_load_dwordx2 v[150:151], v158, s[8:11], 0 offen
v_add_u32 v166, 192, v175
v_mul_lo_u32 v167, v166, s43
v_lshrrev_b32 v167, 20, v167
v_mul_u32_u24 v168, 20, v167
v_sub_u32 v168, v166, v168
v_add_u32 v169, s41, v167
v_mul_u32_u24 v169, 1280, v169
v_lshlrev_b32 v170, 3, v168
v_add_u32 v169, v169, v170
v_add_u32 v159, s44, v169
v_add_u32 v169, s42, v167
v_mul_u32_u24 v169, 336, v169
v_lshlrev_b32 v170, 4, v168
v_add_u32 v164, v169, v170
buffer_load_dwordx2 v[152:153], v159, s[8:11], 0 offen
v_add_u32 v166, 256, v175
v_mul_lo_u32 v167, v166, s43
v_lshrrev_b32 v167, 20, v167
v_mul_u32_u24 v168, 20, v167
v_sub_u32 v168, v166, v168
v_add_u32 v169, s41, v167
v_mul_u32_u24 v169, 1280, v169
v_lshlrev_b32 v170, 3, v168
v_add_u32 v169, v169, v170
v_add_u32 v160, s44, v169
v_add_u32 v169, s42, v167
v_mul_u32_u24 v169, 336, v169
v_lshlrev_b32 v170, 4, v168
v_add_u32 v165, v169, v170
buffer_load_dwordx2 v[154:155], v160, s[8:11], 0 offen
s_waitcnt vmcnt(31)
s_mov_b32 s50, 0
K2_v_6849_1:
v_max3_u32 v172, v0, v1, v2
v_max3_u32 v172, v172, v3, v4
v_max3_u32 v172, v172, v5, v6
v_max3_u32 v172, v172, v7, v8
v_max3_u32 v172, v172, v9, v10
v_max3_u32 v172, v172, v11, v12
v_max3_u32 v172, v172, v13, v14
v_max_u32 v172, v172, v15
v_cmp_eq_u32 vcc, -1, v172
s_cbranch_vccz K2_vo_6849_2
s_add_u32 s50, s50, 1
s_cmp_ge_u32 s50, 0x20000
s_cbranch_scc1 K2_vo_6849_2
s_mov_b32 s51, s84
buffer_load_dwordx2 v[0:1], v171, s[20:23], s51 offen offset:0 sc1
buffer_load_dwordx2 v[2:3], v171, s[20:23], s51 offen offset:512 sc1
buffer_load_dwordx2 v[4:5], v171, s[20:23], s51 offen offset:1024 sc1
buffer_load_dwordx2 v[6:7], v171, s[20:23], s51 offen offset:1536 sc1
buffer_load_dwordx2 v[8:9], v171, s[20:23], s51 offen offset:2048 sc1
buffer_load_dwordx2 v[10:11], v171, s[20:23], s51 offen offset:2560 sc1
buffer_load_dwordx2 v[12:13], v171, s[20:23], s51 offen offset:3072 sc1
buffer_load_dwordx2 v[14:15], v171, s[20:23], s51 offen offset:3584 sc1
s_waitcnt vmcnt(0)
s_branch K2_v_6849_1
K2_vo_6849_2:
v_mfma_f32_16x16x32_bf16 a[0:3], v[16:19], v[0:3], a[0:3]
s_mov_b32 s87, s48
v_mfma_f32_16x16x32_bf16 a[4:7], v[20:23], v[0:3], a[4:7]
buffer_load_dwordx2 v[108:109], v171, s[20:23], s48 offen offset:0 sc1
v_mfma_f32_16x16x32_bf16 a[8:11], v[24:27], v[0:3], a[8:11]
v_mfma_f32_16x16x32_bf16 a[12:15], v[28:31], v[0:3], a[12:15]
buffer_load_dwordx2 v[110:111], v171, s[20:23], s48 offen offset:512 sc1
v_mfma_f32_16x16x32_bf16 a[16:19], v[32:35], v[0:3], a[16:19]
buffer_load_dwordx2 v[112:113], v171, s[20:23], s48 offen offset:1024 sc1
v_mfma_f32_16x16x32_bf16 a[20:23], v[16:19], v[4:7], a[20:23]
buffer_load_dwordx2 v[114:115], v171, s[20:23], s48 offen offset:1536 sc1
v_mfma_f32_16x16x32_bf16 a[24:27], v[20:23], v[4:7], a[24:27]
buffer_load_dwordx2 v[116:117], v171, s[20:23], s48 offen offset:2048 sc1
v_mfma_f32_16x16x32_bf16 a[28:31], v[24:27], v[4:7], a[28:31]
v_mfma_f32_16x16x32_bf16 a[32:35], v[28:31], v[4:7], a[32:35]
buffer_load_dwordx2 v[118:119], v171, s[20:23], s48 offen offset:2560 sc1
v_mfma_f32_16x16x32_bf16 a[36:39], v[32:35], v[4:7], a[36:39]
buffer_load_dwordx2 v[120:121], v171, s[20:23], s48 offen offset:3072 sc1
v_mfma_f32_16x16x32_bf16 a[40:43], v[16:19], v[8:11], a[40:43]
buffer_load_dwordx2 v[122:123], v171, s[20:23], s48 offen offset:3584 sc1
v_mfma_f32_16x16x32_bf16 a[44:47], v[20:23], v[8:11], a[44:47]
s_add_u32 s48, s48, 4096
s_cmp_ge_u32 s48, s82
s_cselect_b32 s79, 20480, 0
s_sub_u32 s48, s48, s79
v_mfma_f32_16x16x32_bf16 a[48:51], v[24:27], v[8:11], a[48:51]
v_mfma_f32_16x16x32_bf16 a[52:55], v[28:31], v[8:11], a[52:55]
buffer_load_dwordx4 v[124:127], v144, s[20:23], s49 offen offset:0
v_mfma_f32_16x16x32_bf16 a[56:59], v[32:35], v[8:11], a[56:59]
buffer_load_dwordx4 v[128:131], v144, s[20:23], s49 offen offset:1024
v_mfma_f32_16x16x32_bf16 a[60:63], v[16:19], v[12:15], a[60:63]
buffer_load_dwordx4 v[132:135], v144, s[20:23], s49 offen offset:2048
v_mfma_f32_16x16x32_bf16 a[64:67], v[20:23], v[12:15], a[64:67]
buffer_load_dwordx4 v[136:139], v144, s[20:23], s49 offen offset:3072
v_mfma_f32_16x16x32_bf16 a[68:71], v[24:27], v[12:15], a[68:71]
v_mfma_f32_16x16x32_bf16 a[72:75], v[28:31], v[12:15], a[72:75]
buffer_load_dwordx4 v[140:143], v145, s[20:23], s49 offen
v_mfma_f32_16x16x32_bf16 a[76:79], v[32:35], v[12:15], a[76:79]
s_add_u32 s49, s49, 5120
s_cmp_ge_u32 s49, s83
s_cselect_b32 s79, 25600, 0
s_sub_u32 s49, s49, s79
s_waitcnt vmcnt(31)
s_mov_b32 s50, 0
K2_v_6849_3:
v_max3_u32 v172, v36, v37, v38
v_max3_u32 v172, v172, v39, v40
v_max3_u32 v172, v172, v41, v42
v_max3_u32 v172, v172, v43, v44
v_max3_u32 v172, v172, v45, v46
v_max3_u32 v172, v172, v47, v48
v_max3_u32 v172, v172, v49, v50
v_max_u32 v172, v172, v51
v_cmp_eq_u32 vcc, -1, v172
s_cbranch_vccz K2_vo_6849_4
s_add_u32 s50, s50, 1
s_cmp_ge_u32 s50, 0x20000
s_cbranch_scc1 K2_vo_6849_4
s_mov_b32 s51, s85
buffer_load_dwordx2 v[36:37], v171, s[20:23], s51 offen offset:0 sc1
buffer_load_dwordx2 v[38:39], v171, s[20:23], s51 offen offset:512 sc1
buffer_load_dwordx2 v[40:41], v171, s[20:23], s51 offen offset:1024 sc1
buffer_load_dwordx2 v[42:43], v171, s[20:23], s51 offen offset:1536 sc1
buffer_load_dwordx2 v[44:45], v171, s[20:23], s51 offen offset:2048 sc1
buffer_load_dwordx2 v[46:47], v171, s[20:23], s51 offen offset:2560 sc1
buffer_load_dwordx2 v[48:49], v171, s[20:23], s51 offen offset:3072 sc1
buffer_load_dwordx2 v[50:51], v171, s[20:23], s51 offen offset:3584 sc1
s_waitcnt vmcnt(0)
s_branch K2_v_6849_3
K2_vo_6849_4:
v_mfma_f32_16x16x32_bf16 a[0:3], v[52:55], v[36:39], a[0:3]
s_mov_b32 s88, s48
v_mfma_f32_16x16x32_bf16 a[4:7], v[56:59], v[36:39], a[4:7]
buffer_load_dwordx2 v[0:1], v171, s[20:23], s48 offen offset:0 sc1
v_mfma_f32_16x16x32_bf16 a[8:11], v[60:63], v[36:39], a[8:11]
v_mfma_f32_16x16x32_bf16 a[12:15], v[64:67], v[36:39], a[12:15]
buffer_load_dwordx2 v[2:3], v171, s[20:23], s48 offen offset:512 sc1
v_mfma_f32_16x16x32_bf16 a[16:19], v[68:71], v[36:39], a[16:19]
buffer_load_dwordx2 v[4:5], v171, s[20:23], s48 offen offset:1024 sc1
v_mfma_f32_16x16x32_bf16 a[20:23], v[52:55], v[40:43], a[20:23]
buffer_load_dwordx2 v[6:7], v171, s[20:23], s48 offen offset:1536 sc1
v_mfma_f32_16x16x32_bf16 a[24:27], v[56:59], v[40:43], a[24:27]
buffer_load_dwordx2 v[8:9], v171, s[20:23], s48 offen offset:2048 sc1
v_mfma_f32_16x16x32_bf16 a[28:31], v[60:63], v[40:43], a[28:31]
v_mfma_f32_16x16x32_bf16 a[32:35], v[64:67], v[40:43], a[32:35]
buffer_load_dwordx2 v[10:11], v171, s[20:23], s48 offen offset:2560 sc1
v_mfma_f32_16x16x32_bf16 a[36:39], v[68:71], v[40:43], a[36:39]
buffer_load_dwordx2 v[12:13], v171, s[20:23], s48 offen offset:3072 sc1
v_mfma_f32_16x16x32_bf16 a[40:43], v[52:55], v[44:47], a[40:43]
buffer_load_dwordx2 v[14:15], v171, s[20:23], s48 offen offset:3584 sc1
v_mfma_f32_16x16x32_bf16 a[44:47], v[56:59], v[44:47], a[44:47]
s_add_u32 s48, s48, 4096
s_cmp_ge_u32 s48, s82
s_cselect_b32 s79, 20480, 0
s_sub_u32 s48, s48, s79
v_mfma_f32_16x16x32_bf16 a[48:51], v[60:63], v[44:47], a[48:51]
v_mfma_f32_16x16x32_bf16 a[52:55], v[64:67], v[44:47], a[52:55]
buffer_load_dwordx4 v[16:19], v144, s[20:23], s49 offen offset:0
v_mfma_f32_16x16x32_bf16 a[56:59], v[68:71], v[44:47], a[56:59]
buffer_load_dwordx4 v[20:23], v144, s[20:23], s49 offen offset:1024
v_mfma_f32_16x16x32_bf16 a[60:63], v[52:55], v[48:51], a[60:63]
buffer_load_dwordx4 v[24:27], v144, s[20:23], s49 offen offset:2048
v_mfma_f32_16x16x32_bf16 a[64:67], v[56:59], v[48:51], a[64:67]
buffer_load_dwordx4 v[28:31], v144, s[20:23], s49 offen offset:3072
v_mfma_f32_16x16x32_bf16 a[68:71], v[60:63], v[48:51], a[68:71]
v_mfma_f32_16x16x32_bf16 a[72:75], v[64:67], v[48:51], a[72:75]
buffer_load_dwordx4 v[32:35], v145, s[20:23], s49 offen
v_mfma_f32_16x16x32_bf16 a[76:79], v[68:71], v[48:51], a[76:79]
s_add_u32 s49, s49, 5120
s_cmp_ge_u32 s49, s83
s_cselect_b32 s79, 25600, 0
s_sub_u32 s49, s49, s79
s_waitcnt vmcnt(31)
s_mov_b32 s50, 0
K2_v_6849_5:
v_max3_u32 v172, v72, v73, v74
v_max3_u32 v172, v172, v75, v76
v_max3_u32 v172, v172, v77, v78
v_max3_u32 v172, v172, v79, v80
v_max3_u32 v172, v172, v81, v82
v_max3_u32 v172, v172, v83, v84
v_max3_u32 v172, v172, v85, v86
v_max_u32 v172, v172, v87
v_cmp_eq_u32 vcc, -1, v172
s_cbranch_vccz K2_vo_6849_6
s_add_u32 s50, s50, 1
s_cmp_ge_u32 s50, 0x20000
s_cbranch_scc1 K2_vo_6849_6
s_mov_b32 s51, s86
buffer_load_dwordx2 v[72:73], v171, s[20:23], s51 offen offset:0 sc1
buffer_load_dwordx2 v[74:75], v171, s[20:23], s51 offen offset:512 sc1
buffer_load_dwordx2 v[76:77], v171, s[20:23], s51 offen offset:1024 sc1
buffer_load_dwordx2 v[78:79], v171, s[20:23], s51 offen offset:1536 sc1
buffer_load_dwordx2 v[80:81], v171, s[20:23], s51 offen offset:2048 sc1
buffer_load_dwordx2 v[82:83], v171, s[20:23], s51 offen offset:2560 sc1
buffer_load_dwordx2 v[84:85], v171, s[20:23], s51 offen offset:3072 sc1
buffer_load_dwordx2 v[86:87], v171, s[20:23], s51 offen offset:3584 sc1
s_waitcnt vmcnt(0)
s_branch K2_v_6849_5
K2_vo_6849_6:
v_mfma_f32_16x16x32_bf16 a[0:3], v[88:91], v[72:75], a[0:3]
v_mfma_f32_16x16x32_bf16 a[4:7], v[92:95], v[72:75], a[4:7]
v_mfma_f32_16x16x32_bf16 a[8:11], v[96:99], v[72:75], a[8:11]
v_mfma_f32_16x16x32_bf16 a[12:15], v[100:103], v[72:75], a[12:15]
v_mfma_f32_16x16x32_bf16 a[16:19], v[104:107], v[72:75], a[16:19]
v_mfma_f32_16x16x32_bf16 a[20:23], v[88:91], v[76:79], a[20:23]
v_mfma_f32_16x16x32_bf16 a[24:27], v[92:95], v[76:79], a[24:27]
v_mfma_f32_16x16x32_bf16 a[28:31], v[96:99], v[76:79], a[28:31]
v_mfma_f32_16x16x32_bf16 a[32:35], v[100:103], v[76:79], a[32:35]
v_mfma_f32_16x16x32_bf16 a[36:39], v[104:107], v[76:79], a[36:39]
v_mfma_f32_16x16x32_bf16 a[40:43], v[88:91], v[80:83], a[40:43]
v_mfma_f32_16x16x32_bf16 a[44:47], v[92:95], v[80:83], a[44:47]
v_mfma_f32_16x16x32_bf16 a[48:51], v[96:99], v[80:83], a[48:51]
v_mfma_f32_16x16x32_bf16 a[52:55], v[100:103], v[80:83], a[52:55]
v_mfma_f32_16x16x32_bf16 a[56:59], v[104:107], v[80:83], a[56:59]
v_mfma_f32_16x16x32_bf16 a[60:63], v[88:91], v[84:87], a[60:63]
v_mfma_f32_16x16x32_bf16 a[64:67], v[92:95], v[84:87], a[64:67]
v_mfma_f32_16x16x32_bf16 a[68:71], v[96:99], v[84:87], a[68:71]
v_mfma_f32_16x16x32_bf16 a[72:75], v[100:103], v[84:87], a[72:75]
v_mfma_f32_16x16x32_bf16 a[76:79], v[104:107], v[84:87], a[76:79]
s_waitcnt vmcnt(13)
s_mov_b32 s50, 0
K2_v_6849_7:
v_max3_u32 v172, v108, v109, v110
v_max3_u32 v172, v172, v111, v112
v_max3_u32 v172, v172, v113, v114
v_max3_u32 v172, v172, v115, v116
v_max3_u32 v172, v172, v117, v118
v_max3_u32 v172, v172, v119, v120
v_max3_u32 v172, v172, v121, v122
v_max_u32 v172, v172, v123
v_cmp_eq_u32 vcc, -1, v172
s_cbranch_vccz K2_vo_6849_8
s_add_u32 s50, s50, 1
s_cmp_ge_u32 s50, 0x20000
s_cbranch_scc1 K2_vo_6849_8
s_mov_b32 s51, s87
buffer_load_dwordx2 v[108:109], v171, s[20:23], s51 offen offset:0 sc1
buffer_load_dwordx2 v[110:111], v171, s[20:23], s51 offen offset:512 sc1
buffer_load_dwordx2 v[112:113], v171, s[20:23], s51 offen offset:1024 sc1
buffer_load_dwordx2 v[114:115], v171, s[20:23], s51 offen offset:1536 sc1
buffer_load_dwordx2 v[116:117], v171, s[20:23], s51 offen offset:2048 sc1
buffer_load_dwordx2 v[118:119], v171, s[20:23], s51 offen offset:2560 sc1
buffer_load_dwordx2 v[120:121], v171, s[20:23], s51 offen offset:3072 sc1
buffer_load_dwordx2 v[122:123], v171, s[20:23], s51 offen offset:3584 sc1
s_waitcnt vmcnt(0)
s_branch K2_v_6849_7
K2_vo_6849_8:
v_mfma_f32_16x16x32_bf16 a[0:3], v[124:127], v[108:111], a[0:3]
v_mfma_f32_16x16x32_bf16 a[4:7], v[128:131], v[108:111], a[4:7]
v_mfma_f32_16x16x32_bf16 a[8:11], v[132:135], v[108:111], a[8:11]
v_mfma_f32_16x16x32_bf16 a[12:15], v[136:139], v[108:111], a[12:15]
v_mfma_f32_16x16x32_bf16 a[16:19], v[140:143], v[108:111], a[16:19]
v_mfma_f32_16x16x32_bf16 a[20:23], v[124:127], v[112:115], a[20:23]
v_mfma_f32_16x16x32_bf16 a[24:27], v[128:131], v[112:115], a[24:27]
v_mfma_f32_16x16x32_bf16 a[28:31], v[132:135], v[112:115], a[28:31]
v_mfma_f32_16x16x32_bf16 a[32:35], v[136:139], v[112:115], a[32:35]
v_mfma_f32_16x16x32_bf16 a[36:39], v[140:143], v[112:115], a[36:39]
v_mfma_f32_16x16x32_bf16 a[40:43], v[124:127], v[116:119], a[40:43]
v_mfma_f32_16x16x32_bf16 a[44:47], v[128:131], v[116:119], a[44:47]
v_mfma_f32_16x16x32_bf16 a[48:51], v[132:135], v[116:119], a[48:51]
v_mfma_f32_16x16x32_bf16 a[52:55], v[136:139], v[116:119], a[52:55]
v_mfma_f32_16x16x32_bf16 a[56:59], v[140:143], v[116:119], a[56:59]
v_mfma_f32_16x16x32_bf16 a[60:63], v[124:127], v[120:123], a[60:63]
v_mfma_f32_16x16x32_bf16 a[64:67], v[128:131], v[120:123], a[64:67]
v_mfma_f32_16x16x32_bf16 a[68:71], v[132:135], v[120:123], a[68:71]
v_mfma_f32_16x16x32_bf16 a[72:75], v[136:139], v[120:123], a[72:75]
v_mfma_f32_16x16x32_bf16 a[76:79], v[140:143], v[120:123], a[76:79]
s_waitcnt vmcnt(0)
s_mov_b32 s50, 0
K2_v_6849_9:
v_max3_u32 v172, v0, v1, v2
v_max3_u32 v172, v172, v3, v4
v_max3_u32 v172, v172, v5, v6
v_max3_u32 v172, v172, v7, v8
v_max3_u32 v172, v172, v9, v10
v_max3_u32 v172, v172, v11, v12
v_max3_u32 v172, v172, v13, v14
v_max_u32 v172, v172, v15
v_cmp_eq_u32 vcc, -1, v172
s_cbranch_vccz K2_vo_6849_10
s_add_u32 s50, s50, 1
s_cmp_ge_u32 s50, 0x20000
s_cbranch_scc1 K2_vo_6849_10
s_mov_b32 s51, s88
buffer_load_dwordx2 v[0:1], v171, s[20:23], s51 offen offset:0 sc1
buffer_load_dwordx2 v[2:3], v171, s[20:23], s51 offen offset:512 sc1
buffer_load_dwordx2 v[4:5], v171, s[20:23], s51 offen offset:1024 sc1
buffer_load_dwordx2 v[6:7], v171, s[20:23], s51 offen offset:1536 sc1
buffer_load_dwordx2 v[8:9], v171, s[20:23], s51 offen offset:2048 sc1
buffer_load_dwordx2 v[10:11], v171, s[20:23], s51 offen offset:2560 sc1
buffer_load_dwordx2 v[12:13], v171, s[20:23], s51 offen offset:3072 sc1
buffer_load_dwordx2 v[14:15], v171, s[20:23], s51 offen offset:3584 sc1
s_waitcnt vmcnt(0)
s_branch K2_v_6849_9
K2_vo_6849_10:
v_mfma_f32_16x16x32_bf16 a[0:3], v[16:19], v[0:3], a[0:3]
v_mfma_f32_16x16x32_bf16 a[4:7], v[20:23], v[0:3], a[4:7]
v_mfma_f32_16x16x32_bf16 a[8:11], v[24:27], v[0:3], a[8:11]
v_mfma_f32_16x16x32_bf16 a[12:15], v[28:31], v[0:3], a[12:15]
v_mfma_f32_16x16x32_bf16 a[16:19], v[32:35], v[0:3], a[16:19]
v_mfma_f32_16x16x32_bf16 a[20:23], v[16:19], v[4:7], a[20:23]
v_mfma_f32_16x16x32_bf16 a[24:27], v[20:23], v[4:7], a[24:27]
v_mfma_f32_16x16x32_bf16 a[28:31], v[24:27], v[4:7], a[28:31]
v_mfma_f32_16x16x32_bf16 a[32:35], v[28:31], v[4:7], a[32:35]
v_mfma_f32_16x16x32_bf16 a[36:39], v[32:35], v[4:7], a[36:39]
v_mfma_f32_16x16x32_bf16 a[40:43], v[16:19], v[8:11], a[40:43]
v_mfma_f32_16x16x32_bf16 a[44:47], v[20:23], v[8:11], a[44:47]
v_mfma_f32_16x16x32_bf16 a[48:51], v[24:27], v[8:11], a[48:51]
v_mfma_f32_16x16x32_bf16 a[52:55], v[28:31], v[8:11], a[52:55]
v_mfma_f32_16x16x32_bf16 a[56:59], v[32:35], v[8:11], a[56:59]
v_mfma_f32_16x16x32_bf16 a[60:63], v[16:19], v[12:15], a[60:63]
v_mfma_f32_16x16x32_bf16 a[64:67], v[20:23], v[12:15], a[64:67]
v_mfma_f32_16x16x32_bf16 a[68:71], v[24:27], v[12:15], a[68:71]
v_mfma_f32_16x16x32_bf16 a[72:75], v[28:31], v[12:15], a[72:75]
v_mfma_f32_16x16x32_bf16 a[76:79], v[32:35], v[12:15], a[76:79]
v_and_b32 v166, 15, v175
v_lshrrev_b32 v167, 4, v175
v_mul_u32_u24 v166, 336, v166
v_lshlrev_b32 v167, 4, v167
v_add_u32 v166, v166, v167
s_mul_i32 s41, s24, 21504
v_add_u32 v166, s41, v166
s_nop 7
ds_write_b128 v166, a[0:3] offset:0
ds_write_b128 v166, a[4:7] offset:64
ds_write_b128 v166, a[8:11] offset:128
ds_write_b128 v166, a[12:15] offset:192
ds_write_b128 v166, a[16:19] offset:256
ds_write_b128 v166, a[20:23] offset:5376
ds_write_b128 v166, a[24:27] offset:5440
ds_write_b128 v166, a[28:31] offset:5504
ds_write_b128 v166, a[32:35] offset:5568
ds_write_b128 v166, a[36:39] offset:5632
ds_write_b128 v166, a[40:43] offset:10752
ds_write_b128 v166, a[44:47] offset:10816
ds_write_b128 v166, a[48:51] offset:10880
ds_write_b128 v166, a[52:55] offset:10944
ds_write_b128 v166, a[56:59] offset:11008
ds_write_b128 v166, a[60:63] offset:16128
ds_write_b128 v166, a[64:67] offset:16192
ds_write_b128 v166, a[68:71] offset:16256
ds_write_b128 v166, a[72:75] offset:16320
ds_write_b128 v166, a[76:79] offset:16384
s_waitcnt lgkmcnt(0)
s_barrier
ds_read_b128 v[0:3], v161 offset:0
ds_read_b128 v[4:7], v161 offset:21504
ds_read_b128 v[8:11], v161 offset:43008
ds_read_b128 v[12:15], v161 offset:64512
ds_read_b128 v[16:19], v162 offset:0
ds_read_b128 v[20:23], v162 offset:21504
ds_read_b128 v[24:27], v162 offset:43008
ds_read_b128 v[28:31], v162 offset:64512
ds_read_b128 v[32:35], v163 offset:0
ds_read_b128 v[36:39], v163 offset:21504
ds_read_b128 v[40:43], v163 offset:43008
ds_read_b128 v[44:47], v163 offset:64512
ds_read_b128 v[48:51], v164 offset:0
ds_read_b128 v[52:55], v164 offset:21504
ds_read_b128 v[56:59], v164 offset:43008
ds_read_b128 v[60:63], v164 offset:64512
ds_read_b128 v[64:67], v165 offset:0
ds_read_b128 v[68:71], v165 offset:21504
ds_read_b128 v[72:75], v165 offset:43008
ds_read_b128 v[76:79], v165 offset:64512
s_waitcnt lgkmcnt(15)
v_pk_add_f32 v[0:1], v[0:1], v[4:5]
v_pk_add_f32 v[2:3], v[2:3], v[6:7]
v_pk_add_f32 v[0:1], v[0:1], v[8:9]
v_pk_add_f32 v[2:3], v[2:3], v[10:11]
v_pk_add_f32 v[0:1], v[0:1], v[12:13]
v_pk_add_f32 v[2:3], v[2:3], v[14:15]
v_lshlrev_b32 v100, 16, v146
v_and_b32 v101, 0xffff0000, v146
v_lshlrev_b32 v102, 16, v147
v_and_b32 v103, 0xffff0000, v147
v_pk_add_f32 v[0:1], v[0:1], v[100:101]
v_pk_add_f32 v[2:3], v[2:3], v[102:103]
v_cvt_pk_bf16_f32 v4, v0, v1
v_cvt_pk_bf16_f32 v5, v2, v3
buffer_store_dwordx2 v[4:5], v156, s[12:15], 0 offen
s_waitcnt lgkmcnt(12)
v_pk_add_f32 v[16:17], v[16:17], v[20:21]
v_pk_add_f32 v[18:19], v[18:19], v[22:23]
v_pk_add_f32 v[16:17], v[16:17], v[24:25]
v_pk_add_f32 v[18:19], v[18:19], v[26:27]
v_pk_add_f32 v[16:17], v[16:17], v[28:29]
v_pk_add_f32 v[18:19], v[18:19], v[30:31]
v_lshlrev_b32 v100, 16, v148
v_and_b32 v101, 0xffff0000, v148
v_lshlrev_b32 v102, 16, v149
v_and_b32 v103, 0xffff0000, v149
v_pk_add_f32 v[16:17], v[16:17], v[100:101]
v_pk_add_f32 v[18:19], v[18:19], v[102:103]
v_cvt_pk_bf16_f32 v20, v16, v17
v_cvt_pk_bf16_f32 v21, v18, v19
buffer_store_dwordx2 v[20:21], v157, s[12:15], 0 offen
s_waitcnt lgkmcnt(8)
v_pk_add_f32 v[32:33], v[32:33], v[36:37]
v_pk_add_f32 v[34:35], v[34:35], v[38:39]
v_pk_add_f32 v[32:33], v[32:33], v[40:41]
v_pk_add_f32 v[34:35], v[34:35], v[42:43]
v_pk_add_f32 v[32:33], v[32:33], v[44:45]
v_pk_add_f32 v[34:35], v[34:35], v[46:47]
v_lshlrev_b32 v100, 16, v150
v_and_b32 v101, 0xffff0000, v150
v_lshlrev_b32 v102, 16, v151
v_and_b32 v103, 0xffff0000, v151
v_pk_add_f32 v[32:33], v[32:33], v[100:101]
v_pk_add_f32 v[34:35], v[34:35], v[102:103]
v_cvt_pk_bf16_f32 v36, v32, v33
v_cvt_pk_bf16_f32 v37, v34, v35
buffer_store_dwordx2 v[36:37], v158, s[12:15], 0 offen
s_waitcnt lgkmcnt(4)
v_pk_add_f32 v[48:49], v[48:49], v[52:53]
v_pk_add_f32 v[50:51], v[50:51], v[54:55]
v_pk_add_f32 v[48:49], v[48:49], v[56:57]
v_pk_add_f32 v[50:51], v[50:51], v[58:59]
v_pk_add_f32 v[48:49], v[48:49], v[60:61]
v_pk_add_f32 v[50:51], v[50:51], v[62:63]
v_lshlrev_b32 v100, 16, v152
v_and_b32 v101, 0xffff0000, v152
v_lshlrev_b32 v102, 16, v153
v_and_b32 v103, 0xffff0000, v153
v_pk_add_f32 v[48:49], v[48:49], v[100:101]
v_pk_add_f32 v[50:51], v[50:51], v[102:103]
v_cvt_pk_bf16_f32 v52, v48, v49
v_cvt_pk_bf16_f32 v53, v50, v51
buffer_store_dwordx2 v[52:53], v159, s[12:15], 0 offen
s_waitcnt lgkmcnt(0)
v_pk_add_f32 v[64:65], v[64:65], v[68:69]
v_pk_add_f32 v[66:67], v[66:67], v[70:71]
v_pk_add_f32 v[64:65], v[64:65], v[72:73]
v_pk_add_f32 v[66:67], v[66:67], v[74:75]
v_pk_add_f32 v[64:65], v[64:65], v[76:77]
v_pk_add_f32 v[66:67], v[66:67], v[78:79]
v_lshlrev_b32 v100, 16, v154
v_and_b32 v101, 0xffff0000, v154
v_lshlrev_b32 v102, 16, v155
v_and_b32 v103, 0xffff0000, v155
v_pk_add_f32 v[64:65], v[64:65], v[100:101]
v_pk_add_f32 v[66:67], v[66:67], v[102:103]
v_cvt_pk_bf16_f32 v68, v64, v65
v_cvt_pk_bf16_f32 v69, v66, v67
buffer_store_dwordx2 v[68:69], v160, s[12:15], 0 offen
s_endpgm
K2_OW:
s_setprio 3
v_and_b32 v144, 15, v175
v_lshrrev_b32 v145, 4, v175
v_lshlrev_b32 v146, 5, v175
v_lshlrev_b32 v147, 3, v175
v_lshlrev_b32 v148, 4, v175
s_lshl_b32 s40, s24, 1
s_add_u32 s41, s40, 0
s_lshl_b32 s41, s41, 5
s_add_u32 s41, s41, s27
s_mul_i32 s41, s41, 5120
s_add_u32 s41, s41, 16252928
buffer_load_dwordx4 v[0:3], v146, s[20:23], s41 offen
buffer_load_dwordx4 v[4:7], v146, s[20:23], s41 offen offset:16
buffer_load_dwordx2 v[8:9], v147, s[20:23], s41 offen offset:2048
s_add_u32 s41, s41, 2560
buffer_load_dwordx4 v[12:15], v146, s[20:23], s41 offen
buffer_load_dwordx4 v[16:19], v146, s[20:23], s41 offen offset:16
buffer_load_dwordx2 v[20:21], v147, s[20:23], s41 offen offset:2048
s_add_u32 s41, s40, 1
s_lshl_b32 s41, s41, 5
s_add_u32 s41, s41, s27
s_mul_i32 s41, s41, 5120
s_add_u32 s41, s41, 16252928
buffer_load_dwordx4 v[24:27], v146, s[20:23], s41 offen
buffer_load_dwordx4 v[28:31], v146, s[20:23], s41 offen offset:16
buffer_load_dwordx2 v[32:33], v147, s[20:23], s41 offen offset:2048
s_add_u32 s41, s41, 2560
buffer_load_dwordx4 v[36:39], v146, s[20:23], s41 offen
buffer_load_dwordx4 v[40:43], v146, s[20:23], s41 offen offset:16
buffer_load_dwordx2 v[44:45], v147, s[20:23], s41 offen offset:2048
v_lshlrev_b32 v149, 4, v144
v_min_u32 v150, 2, v145
v_lshlrev_b32 v150, 8, v150
v_add_u32 v150, v150, v149
s_lshl_b32 s41, s27, 7
s_lshl_b32 s42, s32, 4
s_add_u32 s41, s41, s42
s_lshl_b32 s42, s24, 2
s_add_u32 s41, s41, s42
s_mul_i32 s41, s41, 768
s_add_u32 s41, s41, 12582912
buffer_load_dwordx4 v[48:51], v150, s[20:23], s41 offen offset:0
buffer_load_dwordx4 v[52:55], v150, s[20:23], s41 offen offset:768
buffer_load_dwordx4 v[56:59], v150, s[20:23], s41 offen offset:1536
buffer_load_dwordx4 v[60:63], v150, s[20:23], s41 offen offset:2304
s_mov_b32 s28, s38
s_and_b32 s29, s39, 0xffff
s_mov_b32 s30, 25600
s_mov_b32 s31, 0x20000
s_cmp_eq_u32 s24, 0
s_cbranch_scc0 K2_nophi
s_mul_i32 s41, s27, 800
s_mov_b32 m0, 86016
s_mov_b32 exec_hi, 0x3ffff
buffer_load_dwordx4 v148, s[28:31], s41 offen lds
s_mov_b64 exec, -1
v_mov_b32 v152, 0
v_mov_b32 v153, 0
v_mov_b32 v154, 0
v_mov_b32 v155, 0
v_add_u32 v151, 86816, v148
s_mov_b32 exec_hi, 0x3
ds_write_b128 v151, v[152:155]
s_mov_b64 exec, 1
s_nop 0
v_mov_b32 v151, 112640
ds_write_b128 v151, v[152:155]
s_mov_b64 exec, -1
s_waitcnt lgkmcnt(0)
K2_nophi:
s_barrier
v_mul_u32_u24 v156, 48, v175
s_mul_i32 s41, s24, 6144
s_add_u32 s41, s41, 88064
v_add_u32 v156, s41, v156
v_mul_u32_u24 v157, 48, v175
v_add_u32 v157, 88064, v157
v_and_b32 v158, 1, v144
v_and_b32 v159, 2, v144
v_lshlrev_b32 v159, 1, v159
v_add_u32 v158, v158, v159
v_add_u32 v158, 2, v158
v_lshlrev_b32 v159, 4, v145
v_add_u32 v158, v158, v159
v_mul_u32_u24 v158, 48, v158
v_add_u32 v158, 91136, v158
v_add_u32 v159, 10, v159
v_mul_u32_u24 v159, 48, v159
v_add_u32 v159, 91136, v159
v_lshrrev_b32 v160, 2, v144
v_mul_u32_u24 v160, 5, v160
v_and_b32 v161, 3, v144
v_add_u32 v161, v161, v160
v_add_u32 v162, 4, v160
v_mul_u32_u24 v160, 320, v145
v_lshlrev_b32 v161, 1, v161
v_add_u32 v161, v161, v160
v_add_u32 v161, 86016, v161
v_lshlrev_b32 v162, 1, v162
v_add_u32 v162, v162, v160
v_add_u32 v162, 86016, v162
s_mul_i32 s41, s27, 5
v_add_u32 v165, s41, v145
v_lshrrev_b32 v166, 3, v165
v_lshlrev_b32 v166, 12, v166
v_and_b32 v167, 7, v165
v_lshlrev_b32 v167, 7, v167
v_add_u32 v166, v166, v167
v_lshlrev_b32 v167, 3, v144
v_add_u32 v163, v166, v167
s_add_u32 s42, s41, 4
v_mov_b32 v165, s42
v_lshrrev_b32 v166, 3, v165
v_lshlrev_b32 v166, 12, v166
v_and_b32 v167, 7, v165
v_lshlrev_b32 v167, 7, v167
v_add_u32 v166, v166, v167
v_lshlrev_b32 v167, 3, v144
v_add_u32 v164, v166, v167
s_lshl_b32 s52, s32, 2
s_add_u32 s52, s52, s24
s_mul_i32 s52, s52, 68
s_add_u32 s52, s52, 48
s_lshl_b32 s52, s52, 12
s_add_u32 s52, s52, 3145728
v_mov_b32 v168, 112640
v_mov_b32 v169, 1
s_waitcnt vmcnt(4)
v_pk_add_f32 v[0:1], v[0:1], v[24:25]
v_pk_add_f32 v[2:3], v[2:3], v[26:27]
v_pk_add_f32 v[4:5], v[4:5], v[28:29]
v_pk_add_f32 v[6:7], v[6:7], v[30:31]
v_pk_add_f32 v[8:9], v[8:9], v[32:33]
v_pk_add_f32 v[12:13], v[12:13], v[36:37]
v_pk_add_f32 v[14:15], v[14:15], v[38:39]
v_pk_add_f32 v[16:17], v[16:17], v[40:41]
v_pk_add_f32 v[18:19], v[18:19], v[42:43]
v_pk_add_f32 v[20:21], v[20:21], v[44:45]
ds_write_b128 v156, v[0:3] offset:0
ds_write_b128 v156, v[4:7] offset:16
ds_write_b128 v156, v[8:11] offset:32
ds_write_b128 v156, v[12:15] offset:3072
ds_write_b128 v156, v[16:19] offset:3088
ds_write_b128 v156, v[20:23] offset:3104
s_waitcnt vmcnt(0) lgkmcnt(0)
s_mov_b64 exec, 1
ds_add_u32 v168, v169
s_mov_b64 exec, -1
K2_ospin:
ds_read_b32 v170, v168
s_waitcnt lgkmcnt(0)
v_readfirstlane_b32 s42, v170
s_nop 0
s_cmp_ge_u32 s42, 4
s_cbranch_scc0 K2_ospin
ds_read_b128 v[64:67], v157 offset:0
ds_read_b128 v[68:71], v157 offset:16
ds_read_b128 v[72:75], v157 offset:32
ds_read_b128 v[100:103], v157 offset:6144
ds_read_b128 v[104:107], v157 offset:6160
ds_read_b128 v[108:111], v157 offset:6176
ds_read_b128 v[112:115], v157 offset:12288
ds_read_b128 v[116:119], v157 offset:12304
ds_read_b128 v[120:123], v157 offset:12320
ds_read_b128 v[124:127], v157 offset:18432
ds_read_b128 v[128:131], v157 offset:18448
ds_read_b128 v[132:135], v157 offset:18464
s_waitcnt lgkmcnt(0)
v_pk_add_f32 v[64:65], v[64:65], v[100:101]
v_pk_add_f32 v[66:67], v[66:67], v[102:103]
v_pk_add_f32 v[68:69], v[68:69], v[104:105]
v_pk_add_f32 v[70:71], v[70:71], v[106:107]
v_pk_add_f32 v[72:73], v[72:73], v[108:109]
v_pk_add_f32 v[64:65], v[64:65], v[112:113]
v_pk_add_f32 v[66:67], v[66:67], v[114:115]
v_pk_add_f32 v[68:69], v[68:69], v[116:117]
v_pk_add_f32 v[70:71], v[70:71], v[118:119]
v_pk_add_f32 v[72:73], v[72:73], v[120:121]
v_pk_add_f32 v[64:65], v[64:65], v[124:125]
v_pk_add_f32 v[66:67], v[66:67], v[126:127]
v_pk_add_f32 v[68:69], v[68:69], v[128:129]
v_pk_add_f32 v[70:71], v[70:71], v[130:131]
v_pk_add_f32 v[72:73], v[72:73], v[132:133]
ds_read_b128 v[76:79], v158 offset:0
ds_read_b128 v[80:83], v158 offset:16
ds_read_b128 v[84:87], v158 offset:32
ds_read_b128 v[100:103], v158 offset:6144
ds_read_b128 v[104:107], v158 offset:6160
ds_read_b128 v[108:111], v158 offset:6176
ds_read_b128 v[112:115], v158 offset:12288
ds_read_b128 v[116:119], v158 offset:12304
ds_read_b128 v[120:123], v158 offset:12320
ds_read_b128 v[124:127], v158 offset:18432
ds_read_b128 v[128:131], v158 offset:18448
ds_read_b128 v[132:135], v158 offset:18464
s_waitcnt lgkmcnt(0)
v_pk_add_f32 v[76:77], v[76:77], v[100:101]
v_pk_add_f32 v[78:79], v[78:79], v[102:103]
v_pk_add_f32 v[80:81], v[80:81], v[104:105]
v_pk_add_f32 v[82:83], v[82:83], v[106:107]
v_pk_add_f32 v[84:85], v[84:85], v[108:109]
v_pk_add_f32 v[76:77], v[76:77], v[112:113]
v_pk_add_f32 v[78:79], v[78:79], v[114:115]
v_pk_add_f32 v[80:81], v[80:81], v[116:117]
v_pk_add_f32 v[82:83], v[82:83], v[118:119]
v_pk_add_f32 v[84:85], v[84:85], v[120:121]
v_pk_add_f32 v[76:77], v[76:77], v[124:125]
v_pk_add_f32 v[78:79], v[78:79], v[126:127]
v_pk_add_f32 v[80:81], v[80:81], v[128:129]
v_pk_add_f32 v[82:83], v[82:83], v[130:131]
v_pk_add_f32 v[84:85], v[84:85], v[132:133]
ds_read_b128 v[88:91], v159 offset:0
ds_read_b128 v[92:95], v159 offset:16
ds_read_b128 v[96:99], v159 offset:32
ds_read_b128 v[100:103], v159 offset:6144
ds_read_b128 v[104:107], v159 offset:6160
ds_read_b128 v[108:111], v159 offset:6176
ds_read_b128 v[112:115], v159 offset:12288
ds_read_b128 v[116:119], v159 offset:12304
ds_read_b128 v[120:123], v159 offset:12320
ds_read_b128 v[124:127], v159 offset:18432
ds_read_b128 v[128:131], v159 offset:18448
ds_read_b128 v[132:135], v159 offset:18464
s_waitcnt lgkmcnt(0)
v_pk_add_f32 v[88:89], v[88:89], v[100:101]
v_pk_add_f32 v[90:91], v[90:91], v[102:103]
v_pk_add_f32 v[92:93], v[92:93], v[104:105]
v_pk_add_f32 v[94:95], v[94:95], v[106:107]
v_pk_add_f32 v[96:97], v[96:97], v[108:109]
v_pk_add_f32 v[88:89], v[88:89], v[112:113]
v_pk_add_f32 v[90:91], v[90:91], v[114:115]
v_pk_add_f32 v[92:93], v[92:93], v[116:117]
v_pk_add_f32 v[94:95], v[94:95], v[118:119]
v_pk_add_f32 v[96:97], v[96:97], v[120:121]
v_pk_add_f32 v[88:89], v[88:89], v[124:125]
v_pk_add_f32 v[90:91], v[90:91], v[126:127]
v_pk_add_f32 v[92:93], v[92:93], v[128:129]
v_pk_add_f32 v[94:95], v[94:95], v[130:131]
v_pk_add_f32 v[96:97], v[96:97], v[132:133]
ds_read_u16 v100, v161 offset:0
ds_read_u16 v101, v161 offset:40
ds_read_u16 v102, v161 offset:80
ds_read_u16 v103, v161 offset:120
ds_read_u16 v104, v161 offset:160
ds_read_u16 v105, v161 offset:200
ds_read_u16 v106, v161 offset:240
ds_read_u16 v107, v161 offset:280
ds_read_u16 v108, v162 offset:0
ds_read_u16 v109, v162 offset:40
ds_read_u16 v110, v162 offset:80
ds_read_u16 v111, v162 offset:120
ds_read_u16 v112, v162 offset:160
ds_read_u16 v113, v162 offset:200
ds_read_u16 v114, v162 offset:240
ds_read_u16 v115, v162 offset:280
v_cvt_pk_bf16_f32 v0, v64, v65
v_cvt_pk_bf16_f32 v1, v66, v67
v_cvt_pk_bf16_f32 v2, v68, v69
v_cvt_pk_bf16_f32 v3, v70, v71
v_cvt_pk_bf16_f32 v4, v72, v73
v_mov_b32 v5, 0
v_mov_b32 v6, 0
v_mov_b32 v7, 0
v_cvt_pk_bf16_f32 v8, v76, v77
v_cvt_pk_bf16_f32 v9, v78, v79
v_cvt_pk_bf16_f32 v10, v80, v81
v_cvt_pk_bf16_f32 v11, v82, v83
v_cvt_pk_bf16_f32 v12, v84, v85
v_mov_b32 v13, 0
v_mov_b32 v14, 0
v_mov_b32 v15, 0
v_cvt_pk_bf16_f32 v16, v88, v89
v_cvt_pk_bf16_f32 v17, v90, v91
v_cvt_pk_bf16_f32 v18, v92, v93
v_cvt_pk_bf16_f32 v19, v94, v95
v_cvt_pk_bf16_f32 v20, v96, v97
v_mov_b32 v21, 0
v_mov_b32 v22, 0
v_mov_b32 v23, 0
s_waitcnt lgkmcnt(0)
v_lshl_or_b32 v24, v101, 16, v100
v_lshl_or_b32 v25, v103, 16, v102
v_lshl_or_b32 v26, v105, 16, v104
v_lshl_or_b32 v27, v107, 16, v106
v_lshl_or_b32 v28, v109, 16, v108
v_lshl_or_b32 v29, v111, 16, v110
v_lshl_or_b32 v30, v113, 16, v112
v_lshl_or_b32 v31, v115, 16, v114
v_mov_b32 v32, 1.4426950408889634
v_mfma_f32_16x16x32_bf16 v[64:67], v[24:27], v[48:51], 0
v_mfma_f32_16x16x32_bf16 v[104:107], v[24:27], v[52:55], 0
v_mfma_f32_16x16x32_bf16 v[68:71], v[28:31], v[48:51], 0
v_mfma_f32_16x16x32_bf16 v[108:111], v[28:31], v[52:55], 0
s_nop 4
v_max3_f32 v78, v64, v65, v66
v_max3_f32 v118, v104, v105, v106
v_min3_f32 v79, v64, v65, v66
v_min3_f32 v119, v104, v105, v106
v_max3_f32 v78, v78, v67, v68
v_max3_f32 v118, v118, v107, v108
v_min3_f32 v79, v79, v67, v68
v_min3_f32 v119, v119, v107, v108
v_mov_b32 v80, v78
v_mov_b32 v120, v118
v_mov_b32 v81, v79
v_mov_b32 v121, v119
v_permlane16_swap_b32 v78, v80
v_permlane16_swap_b32 v118, v120
v_permlane16_swap_b32 v79, v81
v_permlane16_swap_b32 v119, v121
v_max_f32 v78, v78, v80
v_max_f32 v118, v118, v120
v_min_f32 v79, v79, v81
v_min_f32 v119, v119, v121
v_mov_b32 v80, v78
v_mov_b32 v120, v118
v_mov_b32 v81, v79
v_mov_b32 v121, v119
v_permlane32_swap_b32 v78, v80
v_permlane32_swap_b32 v118, v120
v_permlane32_swap_b32 v79, v81
v_permlane32_swap_b32 v119, v121
v_max_f32 v78, v78, v80
v_max_f32 v118, v118, v120
v_min_f32 v79, v79, v81
v_min_f32 v119, v119, v121
v_mul_f32 v78, -1.4426950408889634, v78
v_mul_f32 v118, -1.4426950408889634, v118
v_mul_f32 v79, 1.4426950408889634, v79
v_mul_f32 v119, 1.4426950408889634, v119
v_fma_f32 v72, -v64, v32, v79
v_fma_f32 v112, -v104, v32, v119
v_fma_f32 v73, -v65, v32, v79
v_fma_f32 v113, -v105, v32, v119
v_fma_f32 v74, -v66, v32, v79
v_fma_f32 v114, -v106, v32, v119
v_fma_f32 v75, -v67, v32, v79
v_fma_f32 v115, -v107, v32, v119
v_fma_f32 v76, -v68, v32, v79
v_fma_f32 v116, -v108, v32, v119
v_fma_f32 v64, v64, v32, v78
v_fma_f32 v104, v104, v32, v118
v_fma_f32 v65, v65, v32, v78
v_fma_f32 v105, v105, v32, v118
v_fma_f32 v66, v66, v32, v78
v_fma_f32 v106, v106, v32, v118
v_fma_f32 v67, v67, v32, v78
v_fma_f32 v107, v107, v32, v118
v_fma_f32 v68, v68, v32, v78
v_fma_f32 v108, v108, v32, v118
v_exp_f32 v64, v64
v_exp_f32 v104, v104
v_exp_f32 v65, v65
v_exp_f32 v105, v105
v_exp_f32 v66, v66
v_exp_f32 v106, v106
v_exp_f32 v67, v67
v_exp_f32 v107, v107
v_exp_f32 v68, v68
v_exp_f32 v108, v108
v_exp_f32 v72, v72
v_exp_f32 v112, v112
v_exp_f32 v73, v73
v_exp_f32 v113, v113
v_exp_f32 v74, v74
v_exp_f32 v114, v114
v_exp_f32 v75, v75
v_exp_f32 v115, v115
v_exp_f32 v76, v76
v_exp_f32 v116, v116
v_add_f32 v78, v64, v65
v_add_f32 v118, v104, v105
v_add_f32 v79, v72, v73
v_add_f32 v119, v112, v113
v_add_f32 v78, v78, v66
v_add_f32 v118, v118, v106
v_add_f32 v79, v79, v74
v_add_f32 v119, v119, v114
v_add_f32 v78, v78, v67
v_add_f32 v118, v118, v107
v_add_f32 v79, v79, v75
v_add_f32 v119, v119, v115
v_add_f32 v78, v78, v68
v_add_f32 v118, v118, v108
v_add_f32 v79, v79, v76
v_add_f32 v119, v119, v116
v_mov_b32 v80, v78
v_mov_b32 v120, v118
v_mov_b32 v81, v79
v_mov_b32 v121, v119
v_permlane16_swap_b32 v78, v80
v_permlane16_swap_b32 v118, v120
v_permlane16_swap_b32 v79, v81
v_permlane16_swap_b32 v119, v121
v_add_f32 v78, v78, v80
v_add_f32 v118, v118, v120
v_add_f32 v79, v79, v81
v_add_f32 v119, v119, v121
v_mov_b32 v80, v78
v_mov_b32 v120, v118
v_mov_b32 v81, v79
v_mov_b32 v121, v119
v_permlane32_swap_b32 v78, v80
v_permlane32_swap_b32 v118, v120
v_permlane32_swap_b32 v79, v81
v_permlane32_swap_b32 v119, v121
v_add_f32 v78, v78, v80
v_add_f32 v118, v118, v120
v_add_f32 v79, v79, v81
v_add_f32 v119, v119, v121
v_rcp_f32 v78, v78
v_rcp_f32 v118, v118
v_rcp_f32 v79, v79
v_rcp_f32 v119, v119
v_mul_f32 v64, v64, v78
v_mul_f32 v104, v104, v118
v_mul_f32 v65, v65, v78
v_mul_f32 v105, v105, v118
v_mul_f32 v66, v66, v78
v_mul_f32 v106, v106, v118
v_mul_f32 v67, v67, v78
v_mul_f32 v107, v107, v118
v_mul_f32 v68, v68, v78
v_mul_f32 v108, v108, v118
v_mul_f32 v72, v72, v79
v_mul_f32 v112, v112, v119
v_mul_f32 v73, v73, v79
v_mul_f32 v113, v113, v119
v_mul_f32 v74, v74, v79
v_mul_f32 v114, v114, v119
v_mul_f32 v75, v75, v79
v_mul_f32 v115, v115, v119
v_mul_f32 v76, v76, v79
v_mul_f32 v116, v116, v119
v_cvt_pk_bf16_f32 v84, v64, v65
v_cvt_pk_bf16_f32 v124, v104, v105
v_cvt_pk_bf16_f32 v85, v66, v67
v_cvt_pk_bf16_f32 v125, v106, v107
v_cvt_pk_bf16_f32 v86, v68, v72
v_cvt_pk_bf16_f32 v126, v108, v112
v_cvt_pk_bf16_f32 v87, v73, v74
v_cvt_pk_bf16_f32 v127, v113, v114
v_cvt_pk_bf16_f32 v88, v75, v76
v_cvt_pk_bf16_f32 v128, v115, v116
v_mov_b32 v89, 0
v_mov_b32 v129, 0
v_mov_b32 v90, 0
v_mov_b32 v130, 0
v_mov_b32 v91, 0
v_mov_b32 v131, 0
v_mfma_f32_16x16x32_bf16 v[92:95], v[0:3], v[84:87], 0
v_mfma_f32_16x16x32_bf16 v[132:135], v[0:3], v[124:127], 0
v_mfma_f32_16x16x32_bf16 v[96:99], v[8:11], v[84:87], 0
v_mfma_f32_16x16x32_bf16 v[136:139], v[8:11], v[124:127], 0
v_mfma_f32_16x16x32_bf16 v[100:103], v[16:19], v[84:87], 0
v_mfma_f32_16x16x32_bf16 v[140:143], v[16:19], v[124:127], 0
v_mfma_f32_16x16x32_bf16 v[92:95], v[4:7], v[88:91], v[92:95]
v_mfma_f32_16x16x32_bf16 v[132:135], v[4:7], v[128:131], v[132:135]
v_mfma_f32_16x16x32_bf16 v[96:99], v[12:15], v[88:91], v[96:99]
v_mfma_f32_16x16x32_bf16 v[136:139], v[12:15], v[128:131], v[136:139]
v_mfma_f32_16x16x32_bf16 v[100:103], v[20:23], v[88:91], v[100:103]
v_mfma_f32_16x16x32_bf16 v[140:143], v[20:23], v[128:131], v[140:143]
s_nop 6
v_add_f32 v100, 1e-06, v100
v_add_f32 v140, 1e-06, v140
v_rcp_f32 v100, v100
v_rcp_f32 v140, v140
v_mul_f32 v92, v92, v100
v_mul_f32 v132, v132, v140
v_mul_f32 v93, v93, v100
v_mul_f32 v133, v133, v140
v_mul_f32 v94, v94, v100
v_mul_f32 v134, v134, v140
v_mul_f32 v95, v95, v100
v_mul_f32 v135, v135, v140
v_mul_f32 v96, v96, v100
v_mul_f32 v136, v136, v140
v_mul_f32 v97, v97, v100
v_mul_f32 v137, v137, v140
v_mul_f32 v98, v98, v100
v_mul_f32 v138, v138, v140
v_mul_f32 v99, v99, v100
v_mul_f32 v139, v139, v140
v_cvt_pk_bf16_f32 v64, v92, v93
v_cvt_pk_bf16_f32 v104, v132, v133
v_cvt_pk_bf16_f32 v65, v94, v95
v_cvt_pk_bf16_f32 v105, v134, v135
v_cvt_pk_bf16_f32 v66, v96, v97
v_cvt_pk_bf16_f32 v106, v136, v137
v_cvt_pk_bf16_f32 v67, v98, v99
v_cvt_pk_bf16_f32 v107, v138, v139
s_add_u32 s41, s52, 0
buffer_store_dwordx2 v[64:65], v163, s[20:23], s41 offen sc1
s_mov_b64 exec, 0xffff
buffer_store_dwordx2 v[66:67], v164, s[20:23], s41 offen sc1
s_mov_b64 exec, -1
s_add_u32 s41, s52, 1024
buffer_store_dwordx2 v[104:105], v163, s[20:23], s41 offen sc1
s_mov_b64 exec, 0xffff
buffer_store_dwordx2 v[106:107], v164, s[20:23], s41 offen sc1
s_mov_b64 exec, -1
v_mfma_f32_16x16x32_bf16 v[64:67], v[24:27], v[56:59], 0
v_mfma_f32_16x16x32_bf16 v[104:107], v[24:27], v[60:63], 0
v_mfma_f32_16x16x32_bf16 v[68:71], v[28:31], v[56:59], 0
v_mfma_f32_16x16x32_bf16 v[108:111], v[28:31], v[60:63], 0
s_nop 4
v_max3_f32 v78, v64, v65, v66
v_max3_f32 v118, v104, v105, v106
v_min3_f32 v79, v64, v65, v66
v_min3_f32 v119, v104, v105, v106
v_max3_f32 v78, v78, v67, v68
v_max3_f32 v118, v118, v107, v108
v_min3_f32 v79, v79, v67, v68
v_min3_f32 v119, v119, v107, v108
v_mov_b32 v80, v78
v_mov_b32 v120, v118
v_mov_b32 v81, v79
v_mov_b32 v121, v119
v_permlane16_swap_b32 v78, v80
v_permlane16_swap_b32 v118, v120
v_permlane16_swap_b32 v79, v81
v_permlane16_swap_b32 v119, v121
v_max_f32 v78, v78, v80
v_max_f32 v118, v118, v120
v_min_f32 v79, v79, v81
v_min_f32 v119, v119, v121
v_mov_b32 v80, v78
v_mov_b32 v120, v118
v_mov_b32 v81, v79
v_mov_b32 v121, v119
v_permlane32_swap_b32 v78, v80
v_permlane32_swap_b32 v118, v120
v_permlane32_swap_b32 v79, v81
v_permlane32_swap_b32 v119, v121
v_max_f32 v78, v78, v80
v_max_f32 v118, v118, v120
v_min_f32 v79, v79, v81
v_min_f32 v119, v119, v121
v_mul_f32 v78, -1.4426950408889634, v78
v_mul_f32 v118, -1.4426950408889634, v118
v_mul_f32 v79, 1.4426950408889634, v79
v_mul_f32 v119, 1.4426950408889634, v119
v_fma_f32 v72, -v64, v32, v79
v_fma_f32 v112, -v104, v32, v119
v_fma_f32 v73, -v65, v32, v79
v_fma_f32 v113, -v105, v32, v119
v_fma_f32 v74, -v66, v32, v79
v_fma_f32 v114, -v106, v32, v119
v_fma_f32 v75, -v67, v32, v79
v_fma_f32 v115, -v107, v32, v119
v_fma_f32 v76, -v68, v32, v79
v_fma_f32 v116, -v108, v32, v119
v_fma_f32 v64, v64, v32, v78
v_fma_f32 v104, v104, v32, v118
v_fma_f32 v65, v65, v32, v78
v_fma_f32 v105, v105, v32, v118
v_fma_f32 v66, v66, v32, v78
v_fma_f32 v106, v106, v32, v118
v_fma_f32 v67, v67, v32, v78
v_fma_f32 v107, v107, v32, v118
v_fma_f32 v68, v68, v32, v78
v_fma_f32 v108, v108, v32, v118
v_exp_f32 v64, v64
v_exp_f32 v104, v104
v_exp_f32 v65, v65
v_exp_f32 v105, v105
v_exp_f32 v66, v66
v_exp_f32 v106, v106
v_exp_f32 v67, v67
v_exp_f32 v107, v107
v_exp_f32 v68, v68
v_exp_f32 v108, v108
v_exp_f32 v72, v72
v_exp_f32 v112, v112
v_exp_f32 v73, v73
v_exp_f32 v113, v113
v_exp_f32 v74, v74
v_exp_f32 v114, v114
v_exp_f32 v75, v75
v_exp_f32 v115, v115
v_exp_f32 v76, v76
v_exp_f32 v116, v116
v_add_f32 v78, v64, v65
v_add_f32 v118, v104, v105
v_add_f32 v79, v72, v73
v_add_f32 v119, v112, v113
v_add_f32 v78, v78, v66
v_add_f32 v118, v118, v106
v_add_f32 v79, v79, v74
v_add_f32 v119, v119, v114
v_add_f32 v78, v78, v67
v_add_f32 v118, v118, v107
v_add_f32 v79, v79, v75
v_add_f32 v119, v119, v115
v_add_f32 v78, v78, v68
v_add_f32 v118, v118, v108
v_add_f32 v79, v79, v76
v_add_f32 v119, v119, v116
v_mov_b32 v80, v78
v_mov_b32 v120, v118
v_mov_b32 v81, v79
v_mov_b32 v121, v119
v_permlane16_swap_b32 v78, v80
v_permlane16_swap_b32 v118, v120
v_permlane16_swap_b32 v79, v81
v_permlane16_swap_b32 v119, v121
v_add_f32 v78, v78, v80
v_add_f32 v118, v118, v120
v_add_f32 v79, v79, v81
v_add_f32 v119, v119, v121
v_mov_b32 v80, v78
v_mov_b32 v120, v118
v_mov_b32 v81, v79
v_mov_b32 v121, v119
v_permlane32_swap_b32 v78, v80
v_permlane32_swap_b32 v118, v120
v_permlane32_swap_b32 v79, v81
v_permlane32_swap_b32 v119, v121
v_add_f32 v78, v78, v80
v_add_f32 v118, v118, v120
v_add_f32 v79, v79, v81
v_add_f32 v119, v119, v121
v_rcp_f32 v78, v78
v_rcp_f32 v118, v118
v_rcp_f32 v79, v79
v_rcp_f32 v119, v119
v_mul_f32 v64, v64, v78
v_mul_f32 v104, v104, v118
v_mul_f32 v65, v65, v78
v_mul_f32 v105, v105, v118
v_mul_f32 v66, v66, v78
v_mul_f32 v106, v106, v118
v_mul_f32 v67, v67, v78
v_mul_f32 v107, v107, v118
v_mul_f32 v68, v68, v78
v_mul_f32 v108, v108, v118
v_mul_f32 v72, v72, v79
v_mul_f32 v112, v112, v119
v_mul_f32 v73, v73, v79
v_mul_f32 v113, v113, v119
v_mul_f32 v74, v74, v79
v_mul_f32 v114, v114, v119
v_mul_f32 v75, v75, v79
v_mul_f32 v115, v115, v119
v_mul_f32 v76, v76, v79
v_mul_f32 v116, v116, v119
v_cvt_pk_bf16_f32 v84, v64, v65
v_cvt_pk_bf16_f32 v124, v104, v105
v_cvt_pk_bf16_f32 v85, v66, v67
v_cvt_pk_bf16_f32 v125, v106, v107
v_cvt_pk_bf16_f32 v86, v68, v72
v_cvt_pk_bf16_f32 v126, v108, v112
v_cvt_pk_bf16_f32 v87, v73, v74
v_cvt_pk_bf16_f32 v127, v113, v114
v_cvt_pk_bf16_f32 v88, v75, v76
v_cvt_pk_bf16_f32 v128, v115, v116
v_mov_b32 v89, 0
v_mov_b32 v129, 0
v_mov_b32 v90, 0
v_mov_b32 v130, 0
v_mov_b32 v91, 0
v_mov_b32 v131, 0
v_mfma_f32_16x16x32_bf16 v[92:95], v[0:3], v[84:87], 0
v_mfma_f32_16x16x32_bf16 v[132:135], v[0:3], v[124:127], 0
v_mfma_f32_16x16x32_bf16 v[96:99], v[8:11], v[84:87], 0
v_mfma_f32_16x16x32_bf16 v[136:139], v[8:11], v[124:127], 0
v_mfma_f32_16x16x32_bf16 v[100:103], v[16:19], v[84:87], 0
v_mfma_f32_16x16x32_bf16 v[140:143], v[16:19], v[124:127], 0
v_mfma_f32_16x16x32_bf16 v[92:95], v[4:7], v[88:91], v[92:95]
v_mfma_f32_16x16x32_bf16 v[132:135], v[4:7], v[128:131], v[132:135]
v_mfma_f32_16x16x32_bf16 v[96:99], v[12:15], v[88:91], v[96:99]
v_mfma_f32_16x16x32_bf16 v[136:139], v[12:15], v[128:131], v[136:139]
v_mfma_f32_16x16x32_bf16 v[100:103], v[20:23], v[88:91], v[100:103]
v_mfma_f32_16x16x32_bf16 v[140:143], v[20:23], v[128:131], v[140:143]
s_nop 6
v_add_f32 v100, 1e-06, v100
v_add_f32 v140, 1e-06, v140
v_rcp_f32 v100, v100
v_rcp_f32 v140, v140
v_mul_f32 v92, v92, v100
v_mul_f32 v132, v132, v140
v_mul_f32 v93, v93, v100
v_mul_f32 v133, v133, v140
v_mul_f32 v94, v94, v100
v_mul_f32 v134, v134, v140
v_mul_f32 v95, v95, v100
v_mul_f32 v135, v135, v140
v_mul_f32 v96, v96, v100
v_mul_f32 v136, v136, v140
v_mul_f32 v97, v97, v100
v_mul_f32 v137, v137, v140
v_mul_f32 v98, v98, v100
v_mul_f32 v138, v138, v140
v_mul_f32 v99, v99, v100
v_mul_f32 v139, v139, v140
v_cvt_pk_bf16_f32 v64, v92, v93
v_cvt_pk_bf16_f32 v104, v132, v133
v_cvt_pk_bf16_f32 v65, v94, v95
v_cvt_pk_bf16_f32 v105, v134, v135
v_cvt_pk_bf16_f32 v66, v96, v97
v_cvt_pk_bf16_f32 v106, v136, v137
v_cvt_pk_bf16_f32 v67, v98, v99
v_cvt_pk_bf16_f32 v107, v138, v139
s_add_u32 s41, s52, 2048
buffer_store_dwordx2 v[64:65], v163, s[20:23], s41 offen sc1
s_mov_b64 exec, 0xffff
buffer_store_dwordx2 v[66:67], v164, s[20:23], s41 offen sc1
s_mov_b64 exec, -1
s_add_u32 s41, s52, 3072
buffer_store_dwordx2 v[104:105], v163, s[20:23], s41 offen sc1
s_mov_b64 exec, 0xffff
buffer_store_dwordx2 v[106:107], v164, s[20:23], s41 offen sc1
s_mov_b64 exec, -1
K2_end:
CODE_END:
s_endpgm
.section .rodata,"a"
.p2align 6
.amdhsa_kernel k2_kernel
  .amdhsa_next_free_vgpr 256
  .amdhsa_next_free_sgpr 102
  .amdhsa_accum_offset 176
  .amdhsa_group_segment_fixed_size 0
  .amdhsa_kernarg_size 88
  .amdhsa_user_sgpr_count 2
  .amdhsa_user_sgpr_kernarg_segment_ptr 1
  .amdhsa_system_sgpr_workgroup_id_x 1
.end_amdhsa_kernel
```
